```python
import torch

def _softmax(x, axis=-1):
    return torch.softmax(x, dim=axis)

def _gelu(x):
    return torch.nn.functional.gelu(x, approximate='tanh')

def _silu(x):
    return torch.nn.functional.silu(x)

def _sigmoid(x):
    return torch.sigmoid(x)

def _layernorm(x, axis=-1, eps=1e-05):
    m = x.mean(dim=axis, keepdim=True)
    v = x.var(dim=axis, keepdim=True, unbiased=False)
    return (x - m) / torch.sqrt(v + eps)

def _scatter_add(tgt, idx, src, axis=0):
    return tgt.clone().index_add_(axis, idx, src)

def _segment_sum(src, seg, n):
    out = torch.zeros((n,) + src.shape[1:], dtype=src.dtype)
    return out.index_add_(0, seg, src)

def _pad(x, pw):
    flat = tuple((v for pair in reversed(pw) for v in pair))
    return torch.nn.functional.pad(x, flat)
kernel_name = 'adaLN_cond__softmax_full_mha__mixer_gmlp__prompt'

def setup_inputs():

    _w = lambda a: (lambda t: t.to(torch.bfloat16) if t.is_floating_point() else t)(torch.as_tensor(a))

    def _A_setup():
        B, S, D = (1, 2048, 512)
        return {'x': _w((lambda *s: torch.randn(*s, dtype=torch.bfloat16) * 0.05)(B, S, D)), 'wqkv': _w((lambda *s: torch.randn(*s, dtype=torch.bfloat16) * 0.05)(D, 3 * D)), 'wo': _w((lambda *s: torch.randn(*s, dtype=torch.bfloat16) * 0.05)(D, D))}
    _A_in = _A_setup()

    def _B_setup():
        B, S, D, F = (1, 2048, 512, 1792)
        Fh = F // 2
        return {'x': _w((lambda *s: torch.randn(*s, dtype=torch.bfloat16) * 0.05)(B, S, D)), 'w_in': _w((lambda *s: torch.randn(*s, dtype=torch.bfloat16) * 0.4)(D, 2 * Fh)), 'w_sp': _w(0.01 * (lambda *s: torch.randn(*s, dtype=torch.bfloat16) * 0.4)(S, S)), 'b_sp': _w(1.0 + 0.01 * (lambda *s: torch.randn(*s, dtype=torch.bfloat16) * 0.05)(S)), 'w_out': _w((lambda *s: torch.randn(*s, dtype=torch.bfloat16) * 0.05)(Fh, D))}
    _B_in = _B_setup()
    return {'A_x': _A_in['x'], 'A_wqkv': _A_in['wqkv'], 'A_wo': _A_in['wo'], 'B_x': _B_in['x'], 'B_w_in': _B_in['w_in'], 'B_w_sp': _B_in['w_sp'], 'B_b_sp': _B_in['b_sp'], 'B_w_out': _B_in['w_out'], 'c': _w((lambda *s: torch.randn(*s, dtype=torch.bfloat16) * 0.1)(1, 512) * 8.0), 'w_mod': _w((lambda *s: torch.randn(*s, dtype=torch.bfloat16) * 0.1)(512, 6 * 512) * 512 ** (-0.5) * 8.0)}

def reference(A_x, A_wqkv, A_wo, B_x, B_w_in, B_w_sp, B_b_sp, B_w_out, c, w_mod):

    def _A_ref(x, wqkv, wo):
        B, S, D = x.shape
        H = 32
        Dh = D // H
        qkv = (lambda x, *d: x.permute(*d))((x @ wqkv).reshape(B, S, 3, H, Dh), 2, 0, 3, 1, 4)
        q, k, v = (qkv[0], qkv[1], qkv[2])
        scale = Dh ** (-0.5)
        scores = torch.einsum('bhqd,bhkd->bhqk', q, k) * scale
        p = _softmax(scores, axis=-1)
        o = torch.einsum('bhqk,bhkd->bhqd', p, v)
        return (lambda x, *d: x.permute(*d))(o, 0, 2, 1, 3).reshape(B, S, D) @ wo

    def _B_ref(x, w_in, w_sp, b_sp, w_out):
        B, S, D = x.shape
        F = w_in.shape[-1]
        Fh = F // 2
        z = _gelu(torch.einsum('bsd,df->bsf', x, w_in))
        z1 = z[..., :Fh].clone()
        z2 = _layernorm(z[..., Fh:], axis=-1)
        g = torch.einsum('ts,bsf->btf', w_sp, z2) + b_sp[None, :, None]
        return torch.einsum('bsf,fd->bsd', z1 * g, w_out)
    x = A_x
    mod = (_silu(c) @ w_mod).reshape(c.shape[0], 6, 1, -1)
    sa, ca, ga, sb, cb, gb = (mod[:, 0].clone(), mod[:, 1].clone(), mod[:, 2].clone(), mod[:, 3].clone(), mod[:, 4].clone(), mod[:, 5].clone())
    h = _layernorm(x, axis=-1) * (1 + ca) + sa
    x = x + ga * _A_ref(h, A_wqkv, A_wo)
    h = _layernorm(x, axis=-1) * (1 + cb) + sb
    x = x + gb * _B_ref(h, B_w_in, B_w_sp, B_b_sp, B_w_out)
    return x
```

```asm
; @launch grid=(256,1,1) block=(512,1,1) lds=163840
.amdgcn_target "amdgcn-amd-amdhsa--gfx950"
.text
.globl adaLN_cond__softmax_full_mha__mixer_gmlp__prompt_kernel
.p2align 8
.type adaLN_cond__softmax_full_mha__mixer_gmlp__prompt_kernel,@function
adaLN_cond__softmax_full_mha__mixer_gmlp__prompt_kernel:
    s_load_dwordx16 s[16:31], s[0:1], 0
    s_load_dwordx8 s[32:39], s[0:1], 64
    s_load_dwordx2 s[40:41], s[0:1], 96
    s_cmp_ge_u32 s2, 256
    s_cbranch_scc1 L_exit
    v_and_b32 v1, 63, v0
    v_lshrrev_b32 v4, 6, v0
    v_and_b32 v2, 31, v1
    v_readfirstlane_b32 s3, v4
    v_lshrrev_b32 v3, 5, v1
    s_waitcnt lgkmcnt(0)
    s_mov_b32 s4, s40
    s_mov_b32 s5, s41
    s_mov_b32 s6, 0
    s_mov_b32 s7, 0x20000
    s_mov_b32 s8, s40
    s_mov_b32 s9, s41
    s_mov_b32 s10, 0
    s_mov_b32 s11, 0x20000
    s_mov_b32 s12, s40
    s_mov_b32 s13, s41
    s_mov_b32 s14, 0
    s_mov_b32 s15, 0x20000
    v_mov_b32 v10, 0
    v_mov_b32 v184, 0
    v_mov_b32 v185, 0
    v_mov_b32 v186, 0
    v_mov_b32 v187, 0
    v_mov_b32 v188, 0
    v_mov_b32 v189, 0
    v_mov_b32 v232, 0
    v_mov_b32 v240, 0
    v_mov_b32 v241, 0
    v_mov_b32 v242, 0
    v_mov_b32 v243, 0
    v_mov_b32 v244, 0
    v_mov_b32 v245, 0
    v_mov_b32 v246, 0
    s_and_b32 s42, s2, 7
    s_lshl_b32 s42, s42, 2
    s_lshr_b32 s43, s2, 6
    s_add_u32 s42, s42, s43
    s_bfe_u32 s43, s2, 0x30003
    s_cmp_lg_u32 s2, 248
    s_cbranch_scc1 L_nozero_1
    v_lshrrev_b32 v6, 3, v1
    s_mul_i32 s46, s3, 24
    v_add_u32 v6, s46, v6
    v_lshlrev_b32 v6, 8, v6
    v_and_b32 v5, 7, v1
    v_lshl_add_u32 v6, v5, 4, v6
    v_mov_b32 v170, 0
    v_mov_b32 v171, 0
    v_mov_b32 v172, 0
    v_mov_b32 v173, 0
    global_store_dwordx4 v6, v[170:173], s[40:41] sc1
    v_add_u32 v6, 2048, v6
    global_store_dwordx4 v6, v[170:173], s[40:41] sc1
    v_add_u32 v6, 2048, v6
    global_store_dwordx4 v6, v[170:173], s[40:41] sc1
    v_add_u32 v6, 2048, v6
    s_waitcnt vmcnt(0)
    s_barrier
    s_cmp_lg_u32 s3, 6
    s_cbranch_scc1 L_nozero_1
    v_mov_b32 v6, 4
    v_mov_b32 v5, 1
    s_mov_b64 exec, 1
    global_store_dword v6, v5, s[38:39] sc1
    s_mov_b64 exec, -1
L_nozero_1:
    s_lshr_b32 s49, s2, 3
    s_lshl_b32 s59, s49, 2
    s_and_b32 s54, s2, 3
    s_add_u32 s59, s59, s54
    s_mov_b32 s57, 0
    s_bitcmp1_b32 s2, 2
    s_cbranch_scc1 L_notmod_2
    s_mov_b32 s12, s34
    s_mov_b32 s13, s35
    s_mov_b32 s14, 3145728
    s_mov_b32 s15, 0x20000
    s_cmp_ge_u32 s49, 16
    s_cbranch_scc1 L_modrest_3
    s_mov_b32 s57, 1
    s_cmp_ge_u32 s3, 4
    s_cbranch_scc1 L_notmod_2
    v_lshrrev_b32 v5, 3, v0
    v_and_b32 v6, 7, v0
    s_lshr_b32 s46, s59, 4
    s_lshl_b32 s47, s46, 8
    v_lshlrev_b32 v7, 3, v5
    v_add_u32 v7, s47, v7
    global_load_dwordx2 v[136:137], v7, s[32:33]
    v_mul_u32_u24 v5, 24576, v5
    v_lshl_add_u32 v5, v6, 4, v5
    s_mul_i32 s46, s46, 786432
    s_and_b32 s49, s59, 15
    s_lshl_b32 s49, s49, 7
    s_add_u32 s49, s49, s46
    buffer_load_dwordx4 v[104:107], v5, s[12:15], s49 offen
    s_add_u32 s49, s49, 6144
    buffer_load_dwordx4 v[108:111], v5, s[12:15], s49 offen
    s_add_u32 s49, s49, 6144
    buffer_load_dwordx4 v[112:115], v5, s[12:15], s49 offen
    s_add_u32 s49, s49, 6144
    buffer_load_dwordx4 v[116:119], v5, s[12:15], s49 offen
    s_branch L_notmod_2
L_modrest_3:
    s_mov_b32 s57, 2
    s_sub_u32 s59, s59, 32
L_notmod_2:
    v_lshrrev_b32 v4, 4, v1
    v_lshlrev_b32 v4, 10, v4
    v_and_b32 v5, 15, v1
    v_lshl_add_u32 v4, v5, 4, v4
    s_mov_b32 s4, s16
    s_mov_b32 s5, s17
    s_mov_b32 s6, 2097152
    s_mov_b32 s7, 0x20000
    s_lshl_b32 s44, s42, 16
    s_lshl_b32 s45, s3, 13
    s_add_u32 s44, s44, s45
    s_add_u32 s45, s44, 4096
    s_cmp_lg_u32 s57, 1
    s_cbranch_scc1 L_x1_5
    s_cmp_lt_u32 s3, 4
    s_cbranch_scc1 L_x0_4
L_x1_5:
    buffer_load_dwordx4 v[8:11], v4, s[4:7], s44 offen offset:0
    buffer_load_dwordx4 v[12:15], v4, s[4:7], s44 offen offset:256
    buffer_load_dwordx4 v[16:19], v4, s[4:7], s44 offen offset:512
    buffer_load_dwordx4 v[20:23], v4, s[4:7], s44 offen offset:768
    buffer_load_dwordx4 v[24:27], v4, s[4:7], s45 offen offset:0
    buffer_load_dwordx4 v[28:31], v4, s[4:7], s45 offen offset:256
    buffer_load_dwordx4 v[32:35], v4, s[4:7], s45 offen offset:512
    buffer_load_dwordx4 v[36:39], v4, s[4:7], s45 offen offset:768
L_x0_4:
    s_cmp_lg_u32 s3, 3
    s_cbranch_scc1 L_nozs_6
    s_lshl_b32 s46, s42, 3
    s_add_u32 s46, s46, s43
    s_lshl_b32 s46, s46, 10
    s_add_u32 s46, s46, 24117248
    v_lshlrev_b32 v6, 4, v1
    v_add_u32 v6, s46, v6
    v_mov_b32 v170, 0
    v_mov_b32 v171, 0
    v_mov_b32 v172, 0
    v_mov_b32 v173, 0
    global_store_dwordx4 v6, v[170:173], s[40:41] sc1
L_nozs_6:
    s_cmp_lt_u32 s3, 4
    s_cbranch_scc1 L_nold0_7
    v_add_u32 v5, 0, v1
    v_mul_u32_u24 v6, 2731, v5
    v_lshrrev_b32 v6, 16, v6
    v_mul_u32_u24 v7, 24, v6
    v_sub_u32 v5, v5, v7
    v_lshlrev_b32 v7, 1, v6
    v_and_b32 v7, 4, v7
    v_xor_b32 v5, v5, v7
    v_lshrrev_b32 v7, 3, v5
    v_lshlrev_b32 v7, 10, v7
    v_and_b32 v5, 7, v5
    v_lshl_add_u32 v5, v5, 4, v7
    v_mul_u32_u24 v6, 3072, v6
    v_add_u32 v184, v5, v6
    v_add_u32 v5, 64, v1
    v_mul_u32_u24 v6, 2731, v5
    v_lshrrev_b32 v6, 16, v6
    v_mul_u32_u24 v7, 24, v6
    v_sub_u32 v5, v5, v7
    v_lshlrev_b32 v7, 1, v6
    v_and_b32 v7, 4, v7
    v_xor_b32 v5, v5, v7
    v_lshrrev_b32 v7, 3, v5
    v_lshlrev_b32 v7, 10, v7
    v_and_b32 v5, 7, v5
    v_lshl_add_u32 v5, v5, 4, v7
    v_mul_u32_u24 v6, 3072, v6
    v_add_u32 v185, v5, v6
    v_add_u32 v5, 128, v1
    v_mul_u32_u24 v6, 2731, v5
    v_lshrrev_b32 v6, 16, v6
    v_mul_u32_u24 v7, 24, v6
    v_sub_u32 v5, v5, v7
    v_lshlrev_b32 v7, 1, v6
    v_and_b32 v7, 4, v7
    v_xor_b32 v5, v5, v7
    v_lshrrev_b32 v7, 3, v5
    v_lshlrev_b32 v7, 10, v7
    v_and_b32 v5, 7, v5
    v_lshl_add_u32 v5, v5, 4, v7
    v_mul_u32_u24 v6, 3072, v6
    v_add_u32 v186, v5, v6
    v_add_u32 v5, 192, v1
    v_mul_u32_u24 v6, 2731, v5
    v_lshrrev_b32 v6, 16, v6
    v_mul_u32_u24 v7, 24, v6
    v_sub_u32 v5, v5, v7
    v_lshlrev_b32 v7, 1, v6
    v_and_b32 v7, 4, v7
    v_xor_b32 v5, v5, v7
    v_lshrrev_b32 v7, 3, v5
    v_lshlrev_b32 v7, 10, v7
    v_and_b32 v5, 7, v5
    v_lshl_add_u32 v5, v5, 4, v7
    v_mul_u32_u24 v6, 3072, v6
    v_add_u32 v187, v5, v6
    v_add_u32 v5, 256, v1
    v_mul_u32_u24 v6, 2731, v5
    v_lshrrev_b32 v6, 16, v6
    v_mul_u32_u24 v7, 24, v6
    v_sub_u32 v5, v5, v7
    v_lshlrev_b32 v7, 1, v6
    v_and_b32 v7, 4, v7
    v_xor_b32 v5, v5, v7
    v_lshrrev_b32 v7, 3, v5
    v_lshlrev_b32 v7, 10, v7
    v_and_b32 v5, 7, v5
    v_lshl_add_u32 v5, v5, 4, v7
    v_mul_u32_u24 v6, 3072, v6
    v_add_u32 v188, v5, v6
    v_add_u32 v5, 320, v1
    v_mul_u32_u24 v6, 2731, v5
    v_lshrrev_b32 v6, 16, v6
    v_mul_u32_u24 v7, 24, v6
    v_sub_u32 v5, v5, v7
    v_lshlrev_b32 v7, 1, v6
    v_and_b32 v7, 4, v7
    v_xor_b32 v5, v5, v7
    v_lshrrev_b32 v7, 3, v5
    v_lshlrev_b32 v7, 10, v7
    v_and_b32 v5, 7, v5
    v_lshl_add_u32 v5, v5, 4, v7
    v_mul_u32_u24 v6, 3072, v6
    v_add_u32 v189, v5, v6
L_nold0_7:
    s_lshl_b32 s46, s43, 7
    s_add_u32 s8, s18, s46
    s_addc_u32 s9, s19, 0
    s_sub_u32 s10, 1572864, s46
    s_mov_b32 s11, 0x20000
    s_and_b32 s49, s3, 3
    s_mul_i32 s47, s49, 49152
    s_mul_i32 s48, s49, 6144
    s_add_u32 s48, s48, 65536
    s_cmp_eq_u32 s57, 1
    s_cbranch_scc1 L_modcrit_8
    s_cmp_lt_u32 s3, 4
    s_cbranch_scc1 L_nold_12
    s_add_u32 s49, s47, 0
    s_add_u32 m0, s48, 0
    s_nop 0
    buffer_load_dwordx4 v184, s[8:11], s49 offen lds
    s_add_u32 m0, s48, 1024
    s_nop 0
    buffer_load_dwordx4 v185, s[8:11], s49 offen lds
    s_add_u32 m0, s48, 2048
    s_nop 0
    buffer_load_dwordx4 v186, s[8:11], s49 offen lds
    s_add_u32 m0, s48, 3072
    s_nop 0
    buffer_load_dwordx4 v187, s[8:11], s49 offen lds
    s_add_u32 m0, s48, 4096
    s_nop 0
    buffer_load_dwordx4 v188, s[8:11], s49 offen lds
    s_add_u32 m0, s48, 5120
    s_nop 0
    buffer_load_dwordx4 v189, s[8:11], s49 offen lds
    s_add_u32 s49, s47, 196608
    s_add_u32 m0, s48, 24576
    s_nop 0
    buffer_load_dwordx4 v184, s[8:11], s49 offen lds
    s_add_u32 m0, s48, 25600
    s_nop 0
    buffer_load_dwordx4 v185, s[8:11], s49 offen lds
    s_add_u32 m0, s48, 26624
    s_nop 0
    buffer_load_dwordx4 v186, s[8:11], s49 offen lds
    s_add_u32 m0, s48, 27648
    s_nop 0
    buffer_load_dwordx4 v187, s[8:11], s49 offen lds
    s_add_u32 m0, s48, 28672
    s_nop 0
    buffer_load_dwordx4 v188, s[8:11], s49 offen lds
    s_add_u32 m0, s48, 29696
    s_nop 0
    buffer_load_dwordx4 v189, s[8:11], s49 offen lds
L_nold_12:
    s_cmp_lg_u32 s3, 7
    s_cbranch_scc1 L_nopf_13
    s_getpc_b64 s[62:63]
L_pc_14:
    s_sub_u32 s62, s62, (L_pc_14 - adaLN_cond__softmax_full_mha__mixer_gmlp__prompt_kernel)
    s_subb_u32 s63, s63, 0
    s_lshr_b32 s61, s2, 3
    s_lshl_b32 s61, s61, 10
    v_lshlrev_b32 v252, 4, v1
    v_add_u32 v252, s61, v252
    v_min_u32 v253, (L_code_end - adaLN_cond__softmax_full_mha__mixer_gmlp__prompt_kernel - 16), v252
    global_load_dwordx4 v[248:251], v253, s[62:63]
    v_add_u32 v252, 0x8000, v252
    v_min_u32 v253, (L_code_end - adaLN_cond__softmax_full_mha__mixer_gmlp__prompt_kernel - 16), v252
    global_load_dwordx4 v[248:251], v253, s[62:63]
L_nopf_13:
    s_branch L_merge_10
L_modcrit_8:
    s_cmp_ge_u32 s3, 4
    s_cbranch_scc1 L_crity_15
    s_waitcnt vmcnt(4)
    v_lshlrev_b32 v150, 16, v136
    v_and_b32 v151, 0xffff0000, v136
    v_lshlrev_b32 v152, 16, v137
    v_and_b32 v153, 0xffff0000, v137
    v_mul_f32 v160, 0xbfb8aa3b, v150
    v_mul_f32 v161, 0xbfb8aa3b, v151
    v_mul_f32 v162, 0xbfb8aa3b, v152
    v_mul_f32 v163, 0xbfb8aa3b, v153
    v_exp_f32 v160, v160
    v_exp_f32 v161, v161
    v_exp_f32 v162, v162
    v_exp_f32 v163, v163
    s_nop 0
    v_add_f32 v160, 1.0, v160
    v_add_f32 v161, 1.0, v161
    v_add_f32 v162, 1.0, v162
    v_add_f32 v163, 1.0, v163
    v_rcp_f32 v160, v160
    v_rcp_f32 v161, v161
    v_rcp_f32 v162, v162
    v_rcp_f32 v163, v163
    s_nop 0
    v_mul_f32 v150, v150, v160
    v_mul_f32 v151, v151, v161
    v_mul_f32 v152, v152, v162
    v_mul_f32 v153, v153, v163
    v_cvt_pk_bf16_f32 v160, v150, v151
    v_cvt_pk_bf16_f32 v161, v152, v153
    v_lshlrev_b32 v150, 16, v160
    v_and_b32 v151, 0xffff0000, v160
    v_lshlrev_b32 v152, 16, v161
    v_and_b32 v153, 0xffff0000, v161
    v_mov_b32 v140, 0
    v_mov_b32 v141, 0
    v_mov_b32 v142, 0
    v_mov_b32 v143, 0
    v_mov_b32 v144, 0
    v_mov_b32 v145, 0
    v_mov_b32 v146, 0
    v_mov_b32 v147, 0
    s_waitcnt vmcnt(0)
    v_lshlrev_b32 v160, 16, v104
    v_and_b32 v161, 0xffff0000, v104
    v_fmac_f32 v140, v150, v160
    v_fmac_f32 v141, v150, v161
    v_lshlrev_b32 v160, 16, v105
    v_and_b32 v161, 0xffff0000, v105
    v_fmac_f32 v142, v150, v160
    v_fmac_f32 v143, v150, v161
    v_lshlrev_b32 v160, 16, v106
    v_and_b32 v161, 0xffff0000, v106
    v_fmac_f32 v144, v150, v160
    v_fmac_f32 v145, v150, v161
    v_lshlrev_b32 v160, 16, v107
    v_and_b32 v161, 0xffff0000, v107
    v_fmac_f32 v146, v150, v160
    v_fmac_f32 v147, v150, v161
    v_lshlrev_b32 v160, 16, v108
    v_and_b32 v161, 0xffff0000, v108
    v_fmac_f32 v140, v151, v160
    v_fmac_f32 v141, v151, v161
    v_lshlrev_b32 v160, 16, v109
    v_and_b32 v161, 0xffff0000, v109
    v_fmac_f32 v142, v151, v160
    v_fmac_f32 v143, v151, v161
    v_lshlrev_b32 v160, 16, v110
    v_and_b32 v161, 0xffff0000, v110
    v_fmac_f32 v144, v151, v160
    v_fmac_f32 v145, v151, v161
    v_lshlrev_b32 v160, 16, v111
    v_and_b32 v161, 0xffff0000, v111
    v_fmac_f32 v146, v151, v160
    v_fmac_f32 v147, v151, v161
    v_lshlrev_b32 v160, 16, v112
    v_and_b32 v161, 0xffff0000, v112
    v_fmac_f32 v140, v152, v160
    v_fmac_f32 v141, v152, v161
    v_lshlrev_b32 v160, 16, v113
    v_and_b32 v161, 0xffff0000, v113
    v_fmac_f32 v142, v152, v160
    v_fmac_f32 v143, v152, v161
    v_lshlrev_b32 v160, 16, v114
    v_and_b32 v161, 0xffff0000, v114
    v_fmac_f32 v144, v152, v160
    v_fmac_f32 v145, v152, v161
    v_lshlrev_b32 v160, 16, v115
    v_and_b32 v161, 0xffff0000, v115
    v_fmac_f32 v146, v152, v160
    v_fmac_f32 v147, v152, v161
    v_lshlrev_b32 v160, 16, v116
    v_and_b32 v161, 0xffff0000, v116
    v_fmac_f32 v140, v153, v160
    v_fmac_f32 v141, v153, v161
    v_lshlrev_b32 v160, 16, v117
    v_and_b32 v161, 0xffff0000, v117
    v_fmac_f32 v142, v153, v160
    v_fmac_f32 v143, v153, v161
    v_lshlrev_b32 v160, 16, v118
    v_and_b32 v161, 0xffff0000, v118
    v_fmac_f32 v144, v153, v160
    v_fmac_f32 v145, v153, v161
    v_lshlrev_b32 v160, 16, v119
    v_and_b32 v161, 0xffff0000, v119
    v_fmac_f32 v146, v153, v160
    v_fmac_f32 v147, v153, v161
    v_lshrrev_b32 v5, 3, v0
    v_lshlrev_b32 v5, 8, v5
    v_and_b32 v6, 7, v0
    v_lshl_add_u32 v5, v6, 5, v5
    ds_write_b128 v5, v[140:143]
    ds_write_b128 v5, v[144:147] offset:16
    s_lshl_b32 s49, s3, 11
    v_lshlrev_b32 v5, 2, v1
    v_add_u32 v6, s49, v5
    s_waitcnt lgkmcnt(0)
    s_barrier
    ds_read_b32 v160, v6 offset:0
    ds_read_b32 v161, v6 offset:256
    ds_read_b32 v162, v6 offset:512
    ds_read_b32 v163, v6 offset:768
    ds_read_b32 v164, v6 offset:1024
    ds_read_b32 v165, v6 offset:1280
    ds_read_b32 v166, v6 offset:1536
    ds_read_b32 v167, v6 offset:1792
    s_lshl_b32 s49, s3, 8
    v_add_u32 v6, s49, v5
    s_waitcnt lgkmcnt(0)
    v_add_f32 v160, v160, v161
    v_add_f32 v160, v160, v162
    v_add_f32 v160, v160, v163
    v_add_f32 v160, v160, v164
    v_add_f32 v160, v160, v165
    v_add_f32 v160, v160, v166
    v_add_f32 v160, v160, v167
    ds_write_b32 v6, v160 offset:16384
    s_waitcnt lgkmcnt(0)
    s_barrier
    s_cmp_lg_u32 s3, 0
    s_cbranch_scc1 L_modb_16
    ds_read_b32 v160, v5 offset:16384
    ds_read_b32 v161, v5 offset:16640
    ds_read_b32 v162, v5 offset:16896
    ds_read_b32 v163, v5 offset:17152
    s_lshr_b32 s46, s59, 4
    s_lshl_b32 s46, s46, 12
    s_and_b32 s49, s59, 15
    s_lshl_b32 s49, s49, 8
    s_add_u32 s49, s49, s46
    s_add_u32 s49, s49, 81920
    v_add_u32 v5, s49, v5
    s_waitcnt lgkmcnt(0)
    v_add_f32 v160, v160, v161
    v_add_f32 v160, v160, v162
    v_add_f32 v160, v160, v163
    global_store_dword v5, v160, s[40:41] sc1
    v_lshlrev_b32 v170, 8, v1
    v_add_u32 v170, 4, v170
    s_mov_b64 exec, 1
    s_mov_b32 s60, 0x200000
L_poll_17:
    global_load_dword v171, v170, s[38:39] sc1
    s_sub_u32 s60, s60, 1
    s_cbranch_scc1 L_poll_17_out
    s_waitcnt vmcnt(0)
    v_cmp_gt_u32 vcc, 1, v171
    s_cbranch_vccnz L_poll_17
L_poll_17_out:
    s_waitcnt vmcnt(0)
    s_mov_b64 exec, -1
    v_lshlrev_b32 v5, 8, v1
    v_add_u32 v5, 32768, v5
    v_mov_b32 v6, 1
    s_mov_b64 exec, 0xff
    global_atomic_add v5, v6, s[40:41] sc1
    s_mov_b64 exec, -1
L_modb_16:
    s_barrier
    buffer_load_dwordx4 v[8:11], v4, s[4:7], s44 offen offset:0
    buffer_load_dwordx4 v[12:15], v4, s[4:7], s44 offen offset:256
    buffer_load_dwordx4 v[16:19], v4, s[4:7], s44 offen offset:512
    buffer_load_dwordx4 v[20:23], v4, s[4:7], s44 offen offset:768
    buffer_load_dwordx4 v[24:27], v4, s[4:7], s45 offen offset:0
    buffer_load_dwordx4 v[28:31], v4, s[4:7], s45 offen offset:256
    buffer_load_dwordx4 v[32:35], v4, s[4:7], s45 offen offset:512
    buffer_load_dwordx4 v[36:39], v4, s[4:7], s45 offen offset:768
    s_branch L_modx_11
L_crity_15:
    s_barrier
    s_barrier
    s_barrier
L_modx_11:
    s_cmp_lt_u32 s3, 4
    s_cbranch_scc1 L_nold_18
    s_add_u32 s49, s47, 0
    s_add_u32 m0, s48, 0
    s_nop 0
    buffer_load_dwordx4 v184, s[8:11], s49 offen lds
    s_add_u32 m0, s48, 1024
    s_nop 0
    buffer_load_dwordx4 v185, s[8:11], s49 offen lds
    s_add_u32 m0, s48, 2048
    s_nop 0
    buffer_load_dwordx4 v186, s[8:11], s49 offen lds
    s_add_u32 m0, s48, 3072
    s_nop 0
    buffer_load_dwordx4 v187, s[8:11], s49 offen lds
    s_add_u32 m0, s48, 4096
    s_nop 0
    buffer_load_dwordx4 v188, s[8:11], s49 offen lds
    s_add_u32 m0, s48, 5120
    s_nop 0
    buffer_load_dwordx4 v189, s[8:11], s49 offen lds
    s_add_u32 s49, s47, 196608
    s_add_u32 m0, s48, 24576
    s_nop 0
    buffer_load_dwordx4 v184, s[8:11], s49 offen lds
    s_add_u32 m0, s48, 25600
    s_nop 0
    buffer_load_dwordx4 v185, s[8:11], s49 offen lds
    s_add_u32 m0, s48, 26624
    s_nop 0
    buffer_load_dwordx4 v186, s[8:11], s49 offen lds
    s_add_u32 m0, s48, 27648
    s_nop 0
    buffer_load_dwordx4 v187, s[8:11], s49 offen lds
    s_add_u32 m0, s48, 28672
    s_nop 0
    buffer_load_dwordx4 v188, s[8:11], s49 offen lds
    s_add_u32 m0, s48, 29696
    s_nop 0
    buffer_load_dwordx4 v189, s[8:11], s49 offen lds
L_nold_18:
    s_cmp_lg_u32 s3, 7
    s_cbranch_scc1 L_nopf_19
    s_getpc_b64 s[62:63]
L_pc_20:
    s_sub_u32 s62, s62, (L_pc_20 - adaLN_cond__softmax_full_mha__mixer_gmlp__prompt_kernel)
    s_subb_u32 s63, s63, 0
    s_lshr_b32 s61, s2, 3
    s_lshl_b32 s61, s61, 10
    v_lshlrev_b32 v252, 4, v1
    v_add_u32 v252, s61, v252
    v_min_u32 v253, (L_code_end - adaLN_cond__softmax_full_mha__mixer_gmlp__prompt_kernel - 16), v252
    global_load_dwordx4 v[248:251], v253, s[62:63]
    v_add_u32 v252, 0x8000, v252
    v_min_u32 v253, (L_code_end - adaLN_cond__softmax_full_mha__mixer_gmlp__prompt_kernel - 16), v252
    global_load_dwordx4 v[248:251], v253, s[62:63]
L_nopf_19:
L_merge_10:
    s_cmp_lt_u32 s3, 4
    s_cbranch_scc1 L_xw_21
    s_waitcnt vmcnt(12)
    s_branch L_xw2_22
L_xw_21:
    s_waitcnt vmcnt(0)
L_xw2_22:
    s_bitcmp1_b32 s2, 2
    s_cbranch_scc0 L_wmpf_23
    s_cmp_ge_u32 s3, 2
    s_cbranch_scc1 L_wmpf_23
    s_lshr_b32 s46, s2, 3
    s_lshl_b32 s46, s46, 2
    s_and_b32 s49, s2, 3
    s_add_u32 s46, s46, s49
    s_lshl_b32 s46, s46, 1
    s_add_u32 s46, s46, s3
    s_lshl_b32 s46, s46, 6
    v_add_u32 v252, s46, v1
    v_lshrrev_b32 v253, 5, v252
    v_mul_u32_u24 v253, 6144, v253
    v_and_b32 v252, 31, v252
    v_lshl_add_u32 v253, v252, 7, v253
    global_load_dword v251, v253, s[34:35] offset:2048
L_wmpf_23:
    v_mov_b32 v6, 0x3f803f80
    v_mov_b32 v170, 0
    v_mov_b32 v172, 0
    v_mov_b32 v171, 0
    v_mov_b32 v173, 0
    v_dot2_f32_bf16 v170, v8, v6, v170
    v_dot2_f32_bf16 v172, v8, v8, v172
    v_dot2_f32_bf16 v171, v24, v6, v171
    v_dot2_f32_bf16 v173, v24, v24, v173
    v_dot2_f32_bf16 v170, v9, v6, v170
    v_dot2_f32_bf16 v172, v9, v9, v172
    v_dot2_f32_bf16 v171, v25, v6, v171
    v_dot2_f32_bf16 v173, v25, v25, v173
    v_dot2_f32_bf16 v170, v10, v6, v170
    v_dot2_f32_bf16 v172, v10, v10, v172
    v_dot2_f32_bf16 v171, v26, v6, v171
    v_dot2_f32_bf16 v173, v26, v26, v173
    v_dot2_f32_bf16 v170, v11, v6, v170
    v_dot2_f32_bf16 v172, v11, v11, v172
    v_dot2_f32_bf16 v171, v27, v6, v171
    v_dot2_f32_bf16 v173, v27, v27, v173
    v_dot2_f32_bf16 v170, v12, v6, v170
    v_dot2_f32_bf16 v172, v12, v12, v172
    v_dot2_f32_bf16 v171, v28, v6, v171
    v_dot2_f32_bf16 v173, v28, v28, v173
    v_dot2_f32_bf16 v170, v13, v6, v170
    v_dot2_f32_bf16 v172, v13, v13, v172
    v_dot2_f32_bf16 v171, v29, v6, v171
    v_dot2_f32_bf16 v173, v29, v29, v173
    v_dot2_f32_bf16 v170, v14, v6, v170
    v_dot2_f32_bf16 v172, v14, v14, v172
    v_dot2_f32_bf16 v171, v30, v6, v171
    v_dot2_f32_bf16 v173, v30, v30, v173
    v_dot2_f32_bf16 v170, v15, v6, v170
    v_dot2_f32_bf16 v172, v15, v15, v172
    v_dot2_f32_bf16 v171, v31, v6, v171
    v_dot2_f32_bf16 v173, v31, v31, v173
    v_dot2_f32_bf16 v170, v16, v6, v170
    v_dot2_f32_bf16 v172, v16, v16, v172
    v_dot2_f32_bf16 v171, v32, v6, v171
    v_dot2_f32_bf16 v173, v32, v32, v173
    v_dot2_f32_bf16 v170, v17, v6, v170
    v_dot2_f32_bf16 v172, v17, v17, v172
    v_dot2_f32_bf16 v171, v33, v6, v171
    v_dot2_f32_bf16 v173, v33, v33, v173
    v_dot2_f32_bf16 v170, v18, v6, v170
    v_dot2_f32_bf16 v172, v18, v18, v172
    v_dot2_f32_bf16 v171, v34, v6, v171
    v_dot2_f32_bf16 v173, v34, v34, v173
    v_dot2_f32_bf16 v170, v19, v6, v170
    v_dot2_f32_bf16 v172, v19, v19, v172
    v_dot2_f32_bf16 v171, v35, v6, v171
    v_dot2_f32_bf16 v173, v35, v35, v173
    v_dot2_f32_bf16 v170, v20, v6, v170
    v_dot2_f32_bf16 v172, v20, v20, v172
    v_dot2_f32_bf16 v171, v36, v6, v171
    v_dot2_f32_bf16 v173, v36, v36, v173
    v_dot2_f32_bf16 v170, v21, v6, v170
    v_dot2_f32_bf16 v172, v21, v21, v172
    v_dot2_f32_bf16 v171, v37, v6, v171
    v_dot2_f32_bf16 v173, v37, v37, v173
    v_dot2_f32_bf16 v170, v22, v6, v170
    v_dot2_f32_bf16 v172, v22, v22, v172
    v_dot2_f32_bf16 v171, v38, v6, v171
    v_dot2_f32_bf16 v173, v38, v38, v173
    v_dot2_f32_bf16 v170, v23, v6, v170
    v_dot2_f32_bf16 v172, v23, v23, v172
    v_dot2_f32_bf16 v171, v39, v6, v171
    v_dot2_f32_bf16 v173, v39, v39, v173
    s_nop 1
    v_add_f32_dpp v170, v170, v170 row_ror:8 row_mask:0xf bank_mask:0xf
    v_add_f32_dpp v171, v171, v171 row_ror:8 row_mask:0xf bank_mask:0xf
    v_add_f32_dpp v172, v172, v172 row_ror:8 row_mask:0xf bank_mask:0xf
    v_add_f32_dpp v173, v173, v173 row_ror:8 row_mask:0xf bank_mask:0xf
    s_nop 1
    v_add_f32_dpp v170, v170, v170 row_ror:4 row_mask:0xf bank_mask:0xf
    v_add_f32_dpp v171, v171, v171 row_ror:4 row_mask:0xf bank_mask:0xf
    v_add_f32_dpp v172, v172, v172 row_ror:4 row_mask:0xf bank_mask:0xf
    v_add_f32_dpp v173, v173, v173 row_ror:4 row_mask:0xf bank_mask:0xf
    s_nop 1
    v_add_f32_dpp v170, v170, v170 row_ror:2 row_mask:0xf bank_mask:0xf
    v_add_f32_dpp v171, v171, v171 row_ror:2 row_mask:0xf bank_mask:0xf
    v_add_f32_dpp v172, v172, v172 row_ror:2 row_mask:0xf bank_mask:0xf
    v_add_f32_dpp v173, v173, v173 row_ror:2 row_mask:0xf bank_mask:0xf
    s_nop 1
    v_add_f32_dpp v170, v170, v170 row_ror:1 row_mask:0xf bank_mask:0xf
    v_add_f32_dpp v171, v171, v171 row_ror:1 row_mask:0xf bank_mask:0xf
    v_add_f32_dpp v172, v172, v172 row_ror:1 row_mask:0xf bank_mask:0xf
    v_add_f32_dpp v173, v173, v173 row_ror:1 row_mask:0xf bank_mask:0xf
    s_nop 0
    v_mul_f32 v170, 0x3b000000, v170
    v_mul_f32 v172, 0x3b000000, v172
    v_mul_f32 v171, 0x3b000000, v171
    v_mul_f32 v173, 0x3b000000, v173
    v_fma_f32 v172, -v170, v170, v172
    v_fma_f32 v173, -v171, v171, v173
    v_max_f32 v172, 0, v172
    v_max_f32 v173, 0, v173
    v_add_f32 v172, 0x3727c5ac, v172
    v_add_f32 v173, 0x3727c5ac, v173
    v_rsq_f32 v174, v172
    v_rsq_f32 v175, v173
    s_nop 0
    v_mul_f32 v176, v170, v174
    v_mul_f32 v177, v171, v175
    v_sub_f32 v176, 0, v176
    v_sub_f32 v177, 0, v177
    v_lshlrev_b32 v40, 16, v8
    v_and_b32 v41, 0xffff0000, v8
    v_lshlrev_b32 v42, 16, v9
    v_and_b32 v43, 0xffff0000, v9
    v_lshlrev_b32 v44, 16, v10
    v_and_b32 v45, 0xffff0000, v10
    v_lshlrev_b32 v46, 16, v11
    v_and_b32 v47, 0xffff0000, v11
    v_lshlrev_b32 v48, 16, v12
    v_and_b32 v49, 0xffff0000, v12
    v_lshlrev_b32 v50, 16, v13
    v_and_b32 v51, 0xffff0000, v13
    v_lshlrev_b32 v52, 16, v14
    v_and_b32 v53, 0xffff0000, v14
    v_lshlrev_b32 v54, 16, v15
    v_and_b32 v55, 0xffff0000, v15
    v_lshlrev_b32 v56, 16, v16
    v_and_b32 v57, 0xffff0000, v16
    v_lshlrev_b32 v58, 16, v17
    v_and_b32 v59, 0xffff0000, v17
    v_lshlrev_b32 v60, 16, v18
    v_and_b32 v61, 0xffff0000, v18
    v_lshlrev_b32 v62, 16, v19
    v_and_b32 v63, 0xffff0000, v19
    v_lshlrev_b32 v64, 16, v20
    v_and_b32 v65, 0xffff0000, v20
    v_lshlrev_b32 v66, 16, v21
    v_and_b32 v67, 0xffff0000, v21
    v_lshlrev_b32 v68, 16, v22
    v_and_b32 v69, 0xffff0000, v22
    v_lshlrev_b32 v70, 16, v23
    v_and_b32 v71, 0xffff0000, v23
    v_fma_f32 v40, v40, v174, v176
    v_fma_f32 v41, v41, v174, v176
    v_fma_f32 v42, v42, v174, v176
    v_fma_f32 v43, v43, v174, v176
    v_fma_f32 v44, v44, v174, v176
    v_fma_f32 v45, v45, v174, v176
    v_fma_f32 v46, v46, v174, v176
    v_fma_f32 v47, v47, v174, v176
    v_fma_f32 v48, v48, v174, v176
    v_fma_f32 v49, v49, v174, v176
    v_fma_f32 v50, v50, v174, v176
    v_fma_f32 v51, v51, v174, v176
    v_fma_f32 v52, v52, v174, v176
    v_fma_f32 v53, v53, v174, v176
    v_fma_f32 v54, v54, v174, v176
    v_fma_f32 v55, v55, v174, v176
    v_fma_f32 v56, v56, v174, v176
    v_fma_f32 v57, v57, v174, v176
    v_fma_f32 v58, v58, v174, v176
    v_fma_f32 v59, v59, v174, v176
    v_fma_f32 v60, v60, v174, v176
    v_fma_f32 v61, v61, v174, v176
    v_fma_f32 v62, v62, v174, v176
    v_fma_f32 v63, v63, v174, v176
    v_fma_f32 v64, v64, v174, v176
    v_fma_f32 v65, v65, v174, v176
    v_fma_f32 v66, v66, v174, v176
    v_fma_f32 v67, v67, v174, v176
    v_fma_f32 v68, v68, v174, v176
    v_fma_f32 v69, v69, v174, v176
    v_fma_f32 v70, v70, v174, v176
    v_fma_f32 v71, v71, v174, v176
    v_lshlrev_b32 v72, 16, v24
    v_and_b32 v73, 0xffff0000, v24
    v_lshlrev_b32 v74, 16, v25
    v_and_b32 v75, 0xffff0000, v25
    v_lshlrev_b32 v76, 16, v26
    v_and_b32 v77, 0xffff0000, v26
    v_lshlrev_b32 v78, 16, v27
    v_and_b32 v79, 0xffff0000, v27
    v_lshlrev_b32 v80, 16, v28
    v_and_b32 v81, 0xffff0000, v28
    v_lshlrev_b32 v82, 16, v29
    v_and_b32 v83, 0xffff0000, v29
    v_lshlrev_b32 v84, 16, v30
    v_and_b32 v85, 0xffff0000, v30
    v_lshlrev_b32 v86, 16, v31
    v_and_b32 v87, 0xffff0000, v31
    v_lshlrev_b32 v88, 16, v32
    v_and_b32 v89, 0xffff0000, v32
    v_lshlrev_b32 v90, 16, v33
    v_and_b32 v91, 0xffff0000, v33
    v_lshlrev_b32 v92, 16, v34
    v_and_b32 v93, 0xffff0000, v34
    v_lshlrev_b32 v94, 16, v35
    v_and_b32 v95, 0xffff0000, v35
    v_lshlrev_b32 v96, 16, v36
    v_and_b32 v97, 0xffff0000, v36
    v_lshlrev_b32 v98, 16, v37
    v_and_b32 v99, 0xffff0000, v37
    v_lshlrev_b32 v100, 16, v38
    v_and_b32 v101, 0xffff0000, v38
    v_lshlrev_b32 v102, 16, v39
    v_and_b32 v103, 0xffff0000, v39
    v_fma_f32 v72, v72, v175, v177
    v_fma_f32 v73, v73, v175, v177
    v_fma_f32 v74, v74, v175, v177
    v_fma_f32 v75, v75, v175, v177
    v_fma_f32 v76, v76, v175, v177
    v_fma_f32 v77, v77, v175, v177
    v_fma_f32 v78, v78, v175, v177
    v_fma_f32 v79, v79, v175, v177
    v_fma_f32 v80, v80, v175, v177
    v_fma_f32 v81, v81, v175, v177
    v_fma_f32 v82, v82, v175, v177
    v_fma_f32 v83, v83, v175, v177
    v_fma_f32 v84, v84, v175, v177
    v_fma_f32 v85, v85, v175, v177
    v_fma_f32 v86, v86, v175, v177
    v_fma_f32 v87, v87, v175, v177
    v_fma_f32 v88, v88, v175, v177
    v_fma_f32 v89, v89, v175, v177
    v_fma_f32 v90, v90, v175, v177
    v_fma_f32 v91, v91, v175, v177
    v_fma_f32 v92, v92, v175, v177
    v_fma_f32 v93, v93, v175, v177
    v_fma_f32 v94, v94, v175, v177
    v_fma_f32 v95, v95, v175, v177
    v_fma_f32 v96, v96, v175, v177
    v_fma_f32 v97, v97, v175, v177
    v_fma_f32 v98, v98, v175, v177
    v_fma_f32 v99, v99, v175, v177
    v_fma_f32 v100, v100, v175, v177
    v_fma_f32 v101, v101, v175, v177
    v_fma_f32 v102, v102, v175, v177
    v_fma_f32 v103, v103, v175, v177
    s_cmp_lg_u32 s3, 0
    s_cbranch_scc1 L_mw_24
    v_lshlrev_b32 v254, 8, v1
    v_add_u32 v254, 4, v254
    s_mov_b64 exec, 1
    s_mov_b32 s60, 0x200000
L_poll_25:
    global_load_dword v255, v254, s[38:39] sc1
    s_sub_u32 s60, s60, 1
    s_cbranch_scc1 L_poll_25_out
    s_waitcnt vmcnt(0)
    v_cmp_gt_u32 vcc, 1, v255
    s_cbranch_vccnz L_poll_25
L_poll_25_out:
    s_waitcnt vmcnt(0)
    s_mov_b64 exec, -1
    s_and_b32 s49, s2, 7
    s_lshl_b32 s49, s49, 8
    s_add_u32 s49, s49, 32768
    v_lshlrev_b32 v254, 8, v1
    v_add_u32 v254, s49, v254
    s_mov_b64 exec, 1
    s_mov_b32 s60, 0x200000
L_poll_26:
    global_load_dword v255, v254, s[40:41] sc1
    s_sub_u32 s60, s60, 1
    s_cbranch_scc1 L_poll_26_out
    s_waitcnt vmcnt(0)
    v_cmp_gt_u32 vcc, 64, v255
    s_cbranch_vccnz L_poll_26
L_poll_26_out:
    s_waitcnt vmcnt(0)
    s_mov_b64 exec, -1
L_mw_24:
    s_barrier
    s_add_u32 s12, s40, 81920
    s_addc_u32 s13, s41, 0
    s_mov_b32 s14, 16384
    s_mov_b32 s15, 0x20000
    v_lshlrev_b32 v5, 4, v1
    s_lshl_b32 s49, s3, 11
    s_add_u32 m0, s49, 139264
    s_nop 0
    buffer_load_dwordx4 v5, s[12:15], s49 offen sc1 lds
    buffer_load_dwordx4 v5, s[12:15], s49 offen offset:1024 sc1 lds
    s_cmp_ge_u32 s3, 4
    s_cbranch_scc1 L_mv_27
    s_lshr_b32 s62, s2, 3
    s_mul_i32 s62, s62, 24576
    s_add_u32 s62, s62, 786432
    v_lshlrev_b32 v252, 7, v0
    v_min_u32 v253, 24448, v252
    v_add_u32 v253, s62, v253
    global_load_dword v251, v253, s[18:19]
    s_waitcnt vmcnt(1)
L_mv_27:
    s_cmp_lt_u32 s3, 4
    s_cbranch_scc1 L_mv2_28
    s_add_u32 s49, s47, 393216
    s_add_u32 m0, s48, 49152
    s_nop 0
    buffer_load_dwordx4 v184, s[8:11], s49 offen lds
    s_add_u32 m0, s48, 50176
    s_nop 0
    buffer_load_dwordx4 v185, s[8:11], s49 offen lds
    s_add_u32 m0, s48, 51200
    s_nop 0
    buffer_load_dwordx4 v186, s[8:11], s49 offen lds
    s_add_u32 m0, s48, 52224
    s_nop 0
    buffer_load_dwordx4 v187, s[8:11], s49 offen lds
    s_add_u32 m0, s48, 53248
    s_nop 0
    buffer_load_dwordx4 v188, s[8:11], s49 offen lds
    s_add_u32 m0, s48, 54272
    s_nop 0
    buffer_load_dwordx4 v189, s[8:11], s49 offen lds
    s_waitcnt vmcnt(6)
L_mv2_28:
    s_barrier
    v_lshlrev_b32 v5, 3, v0
    v_add_u32 v5, 139264, v5
    ds_read_b64 v[160:161], v5 offset:0
    ds_read_b64 v[162:163], v5 offset:4096
    ds_read_b64 v[164:165], v5 offset:8192
    ds_read_b64 v[166:167], v5 offset:12288
    s_waitcnt lgkmcnt(0)
    v_add_f32 v160, v160, v162
    v_add_f32 v161, v161, v163
    v_add_f32 v160, v160, v164
    v_add_f32 v161, v161, v165
    v_add_f32 v160, v160, v166
    v_add_f32 v161, v161, v167
    v_cvt_pk_bf16_f32 v162, v160, v161
    v_lshlrev_b32 v160, 16, v162
    v_and_b32 v161, 0xffff0000, v162
    s_cmp_lt_u32 s3, 4
    s_cbranch_scc1 L_c1_29
    v_add_f32 v160, 1.0, v160
    v_add_f32 v161, 1.0, v161
    v_cvt_pk_bf16_f32 v162, v160, v161
    v_lshlrev_b32 v160, 16, v162
    v_and_b32 v161, 0xffff0000, v162
L_c1_29:
    ds_write_b64 v5, v[160:161] offset:16384
    s_waitcnt lgkmcnt(0)
    s_barrier
    v_and_b32 v5, 15, v1
    v_lshlrev_b32 v5, 5, v5
    v_add_u32 v5, 155648, v5
    ds_read_b128 v[104:107], v5 offset:2048
    ds_read_b128 v[108:111], v5 offset:2064
    ds_read_b128 v[136:139], v5 offset:0
    ds_read_b128 v[112:115], v5 offset:2560
    ds_read_b128 v[116:119], v5 offset:2576
    ds_read_b128 v[144:147], v5 offset:512
    ds_read_b128 v[120:123], v5 offset:3072
    ds_read_b128 v[124:127], v5 offset:3088
    ds_read_b128 v[152:155], v5 offset:1024
    ds_read_b128 v[128:131], v5 offset:3584
    ds_read_b128 v[132:135], v5 offset:3600
    ds_read_b128 v[160:163], v5 offset:1536
    s_waitcnt lgkmcnt(6)
    ds_read_b128 v[140:143], v5 offset:16
    ds_read_b128 v[148:151], v5 offset:528
    ds_read_b128 v[156:159], v5 offset:1040
    ds_read_b128 v[164:167], v5 offset:1552
    v_lshrrev_b32 v6, 4, v1
    s_lshl_b32 s49, s3, 3
    v_add_u32 v6, s49, v6
    v_add_u32 v7, 0, v6
    v_and_b32 v168, 15, v7
    v_and_b32 v169, 15, v1
    v_xor_b32 v168, v168, v169
    v_lshlrev_b32 v168, 4, v168
    v_lshl_add_u32 v178, v7, 10, v168
    v_add_u32 v7, 4, v6
    v_and_b32 v168, 15, v7
    v_and_b32 v169, 15, v1
    v_xor_b32 v168, v168, v169
    v_lshlrev_b32 v168, 4, v168
    v_lshl_add_u32 v179, v7, 10, v168
    s_waitcnt lgkmcnt(0)
    v_fma_f32 v40, v40, v104, v136
    v_fma_f32 v41, v41, v105, v137
    v_fma_f32 v42, v42, v106, v138
    v_fma_f32 v43, v43, v107, v139
    v_fma_f32 v44, v44, v108, v140
    v_fma_f32 v45, v45, v109, v141
    v_fma_f32 v46, v46, v110, v142
    v_fma_f32 v47, v47, v111, v143
    v_fma_f32 v48, v48, v112, v144
    v_fma_f32 v49, v49, v113, v145
    v_fma_f32 v50, v50, v114, v146
    v_fma_f32 v51, v51, v115, v147
    v_fma_f32 v52, v52, v116, v148
    v_fma_f32 v53, v53, v117, v149
    v_fma_f32 v54, v54, v118, v150
    v_fma_f32 v55, v55, v119, v151
    v_fma_f32 v56, v56, v120, v152
    v_fma_f32 v57, v57, v121, v153
    v_fma_f32 v58, v58, v122, v154
    v_fma_f32 v59, v59, v123, v155
    v_fma_f32 v60, v60, v124, v156
    v_fma_f32 v61, v61, v125, v157
    v_fma_f32 v62, v62, v126, v158
    v_fma_f32 v63, v63, v127, v159
    v_fma_f32 v64, v64, v128, v160
    v_fma_f32 v65, v65, v129, v161
    v_fma_f32 v66, v66, v130, v162
    v_fma_f32 v67, v67, v131, v163
    v_fma_f32 v68, v68, v132, v164
    v_fma_f32 v69, v69, v133, v165
    v_fma_f32 v70, v70, v134, v166
    v_fma_f32 v71, v71, v135, v167
    v_cvt_pk_bf16_f32 v8, v40, v41
    v_cvt_pk_bf16_f32 v9, v42, v43
    v_cvt_pk_bf16_f32 v10, v44, v45
    v_cvt_pk_bf16_f32 v11, v46, v47
    v_cvt_pk_bf16_f32 v12, v48, v49
    v_cvt_pk_bf16_f32 v13, v50, v51
    v_cvt_pk_bf16_f32 v14, v52, v53
    v_cvt_pk_bf16_f32 v15, v54, v55
    v_cvt_pk_bf16_f32 v16, v56, v57
    v_cvt_pk_bf16_f32 v17, v58, v59
    v_cvt_pk_bf16_f32 v18, v60, v61
    v_cvt_pk_bf16_f32 v19, v62, v63
    v_cvt_pk_bf16_f32 v20, v64, v65
    v_cvt_pk_bf16_f32 v21, v66, v67
    v_cvt_pk_bf16_f32 v22, v68, v69
    v_cvt_pk_bf16_f32 v23, v70, v71
    ds_write_b128 v178, v[8:11] offset:0
    ds_write_b128 v178, v[12:15] offset:256
    ds_write_b128 v178, v[16:19] offset:512
    ds_write_b128 v178, v[20:23] offset:768
    v_fma_f32 v72, v72, v104, v136
    v_fma_f32 v73, v73, v105, v137
    v_fma_f32 v74, v74, v106, v138
    v_fma_f32 v75, v75, v107, v139
    v_fma_f32 v76, v76, v108, v140
    v_fma_f32 v77, v77, v109, v141
    v_fma_f32 v78, v78, v110, v142
    v_fma_f32 v79, v79, v111, v143
    v_fma_f32 v80, v80, v112, v144
    v_fma_f32 v81, v81, v113, v145
    v_fma_f32 v82, v82, v114, v146
    v_fma_f32 v83, v83, v115, v147
    v_fma_f32 v84, v84, v116, v148
    v_fma_f32 v85, v85, v117, v149
    v_fma_f32 v86, v86, v118, v150
    v_fma_f32 v87, v87, v119, v151
    v_fma_f32 v88, v88, v120, v152
    v_fma_f32 v89, v89, v121, v153
    v_fma_f32 v90, v90, v122, v154
    v_fma_f32 v91, v91, v123, v155
    v_fma_f32 v92, v92, v124, v156
    v_fma_f32 v93, v93, v125, v157
    v_fma_f32 v94, v94, v126, v158
    v_fma_f32 v95, v95, v127, v159
    v_fma_f32 v96, v96, v128, v160
    v_fma_f32 v97, v97, v129, v161
    v_fma_f32 v98, v98, v130, v162
    v_fma_f32 v99, v99, v131, v163
    v_fma_f32 v100, v100, v132, v164
    v_fma_f32 v101, v101, v133, v165
    v_fma_f32 v102, v102, v134, v166
    v_fma_f32 v103, v103, v135, v167
    v_cvt_pk_bf16_f32 v24, v72, v73
    v_cvt_pk_bf16_f32 v25, v74, v75
    v_cvt_pk_bf16_f32 v26, v76, v77
    v_cvt_pk_bf16_f32 v27, v78, v79
    v_cvt_pk_bf16_f32 v28, v80, v81
    v_cvt_pk_bf16_f32 v29, v82, v83
    v_cvt_pk_bf16_f32 v30, v84, v85
    v_cvt_pk_bf16_f32 v31, v86, v87
    v_cvt_pk_bf16_f32 v32, v88, v89
    v_cvt_pk_bf16_f32 v33, v90, v91
    v_cvt_pk_bf16_f32 v34, v92, v93
    v_cvt_pk_bf16_f32 v35, v94, v95
    v_cvt_pk_bf16_f32 v36, v96, v97
    v_cvt_pk_bf16_f32 v37, v98, v99
    v_cvt_pk_bf16_f32 v38, v100, v101
    v_cvt_pk_bf16_f32 v39, v102, v103
    ds_write_b128 v179, v[24:27] offset:0
    ds_write_b128 v179, v[28:31] offset:256
    ds_write_b128 v179, v[32:35] offset:512
    ds_write_b128 v179, v[36:39] offset:768
    s_cmp_lt_u32 s3, 4
    s_cbranch_scc1 L_tw_30
    s_waitcnt vmcnt(12)
L_tw_30:
    s_waitcnt lgkmcnt(0)
    s_barrier
    s_cmp_ge_u32 s3, 4
    s_cbranch_scc1 L_p1load_31
    s_and_b32 s51, s3, 1
    s_lshr_b32 s52, s3, 1
    v_and_b32 v5, 15, v2
    v_xor_b32 v5, v5, v3
    v_lshlrev_b32 v5, 4, v5
    v_lshl_add_u32 v5, v2, 10, v5
    s_lshl_b32 s49, s51, 15
    v_add_u32 v72, s49, v5
    v_xor_b32 v73, 32, v72
    v_xor_b32 v74, 64, v72
    v_xor_b32 v75, 96, v72
    v_xor_b32 v76, 128, v72
    v_xor_b32 v77, 160, v72
    v_xor_b32 v78, 192, v72
    v_xor_b32 v79, 224, v72
    v_bfe_u32 v5, v1, 2, 2
    v_lshl_add_u32 v5, v3, 3, v5
    v_mul_u32_u24 v5, 384, v5
    v_bfe_u32 v6, v1, 3, 1
    v_xor_b32 v6, s52, v6
    v_lshl_add_u32 v5, v6, 6, v5
    v_bfe_u32 v6, v1, 4, 1
    v_lshl_add_u32 v5, v6, 5, v5
    v_and_b32 v6, 3, v1
    v_lshl_add_u32 v5, v6, 3, v5
    v_add_u32 v80, 65536, v5
    v_add_u32 v81, 49152, v80
    v_mov_b32 v192, 0
    v_mov_b32 v193, 0
    v_mov_b32 v194, 0
    v_mov_b32 v195, 0
    v_mov_b32 v196, 0
    v_mov_b32 v197, 0
    v_mov_b32 v198, 0
    v_mov_b32 v199, 0
    v_mov_b32 v200, 0
    v_mov_b32 v201, 0
    v_mov_b32 v202, 0
    v_mov_b32 v203, 0
    v_mov_b32 v204, 0
    v_mov_b32 v205, 0
    v_mov_b32 v206, 0
    v_mov_b32 v207, 0
    v_mov_b32 v208, 0
    v_mov_b32 v209, 0
    v_mov_b32 v210, 0
    v_mov_b32 v211, 0
    v_mov_b32 v212, 0
    v_mov_b32 v213, 0
    v_mov_b32 v214, 0
    v_mov_b32 v215, 0
    v_mov_b32 v216, 0
    v_mov_b32 v217, 0
    v_mov_b32 v218, 0
    v_mov_b32 v219, 0
    v_mov_b32 v220, 0
    v_mov_b32 v221, 0
    v_mov_b32 v222, 0
    v_mov_b32 v223, 0
    v_mov_b32 v224, 0
    v_mov_b32 v225, 0
    v_mov_b32 v226, 0
    v_mov_b32 v227, 0
    v_mov_b32 v228, 0
    v_mov_b32 v229, 0
    v_mov_b32 v230, 0
    v_mov_b32 v231, 0
    v_mov_b32 v232, 0
    v_mov_b32 v233, 0
    v_mov_b32 v234, 0
    v_mov_b32 v235, 0
    v_mov_b32 v236, 0
    v_mov_b32 v237, 0
    v_mov_b32 v238, 0
    v_mov_b32 v239, 0
    ds_read_b128 v[8:11], v72 offset:0
    ds_read_b64_tr_b16 v[12:13], v80 offset:0
    ds_read_b64_tr_b16 v[14:15], v80 offset:1536
    ds_read_b64_tr_b16 v[16:17], v80 offset:128
    ds_read_b64_tr_b16 v[18:19], v80 offset:1664
    ds_read_b64_tr_b16 v[20:21], v80 offset:256
    ds_read_b64_tr_b16 v[22:23], v80 offset:1792
    ds_read_b128 v[24:27], v73 offset:0
    ds_read_b64_tr_b16 v[28:29], v80 offset:6144
    ds_read_b64_tr_b16 v[30:31], v80 offset:7680
    ds_read_b64_tr_b16 v[32:33], v80 offset:6272
    ds_read_b64_tr_b16 v[34:35], v80 offset:7808
    ds_read_b64_tr_b16 v[36:37], v80 offset:6400
    ds_read_b64_tr_b16 v[38:39], v80 offset:7936
    ds_read_b128 v[40:43], v74 offset:0
    ds_read_b64_tr_b16 v[44:45], v80 offset:12288
    ds_read_b64_tr_b16 v[46:47], v80 offset:13824
    ds_read_b64_tr_b16 v[48:49], v80 offset:12416
    ds_read_b64_tr_b16 v[50:51], v80 offset:13952
    ds_read_b64_tr_b16 v[52:53], v80 offset:12544
    ds_read_b64_tr_b16 v[54:55], v80 offset:14080
    s_waitcnt lgkmcnt(14)
    v_mfma_f32_32x32x16_bf16 v[192:207], v[12:15], v[8:11], v[192:207]
    ds_read_b128 v[56:59], v75 offset:0
    ds_read_b64_tr_b16 v[60:61], v80 offset:18432
    ds_read_b64_tr_b16 v[62:63], v80 offset:19968
    v_mfma_f32_32x32x16_bf16 v[208:223], v[16:19], v[8:11], v[208:223]
    ds_read_b64_tr_b16 v[64:65], v80 offset:18560
    ds_read_b64_tr_b16 v[66:67], v80 offset:20096
    v_mfma_f32_32x32x16_bf16 v[224:239], v[8:11], v[20:23], v[224:239]
    ds_read_b64_tr_b16 v[68:69], v80 offset:18688
    ds_read_b64_tr_b16 v[70:71], v80 offset:20224
    s_waitcnt lgkmcnt(14)
    s_barrier
    v_mfma_f32_32x32x16_bf16 v[192:207], v[28:31], v[24:27], v[192:207]
    ds_read_b128 v[8:11], v76 offset:0
    ds_read_b64_tr_b16 v[12:13], v80 offset:24576
    ds_read_b64_tr_b16 v[14:15], v80 offset:26112
    v_mfma_f32_32x32x16_bf16 v[208:223], v[32:35], v[24:27], v[208:223]
    ds_read_b64_tr_b16 v[16:17], v80 offset:24704
    ds_read_b64_tr_b16 v[18:19], v80 offset:26240
    v_mfma_f32_32x32x16_bf16 v[224:239], v[24:27], v[36:39], v[224:239]
    ds_read_b64_tr_b16 v[20:21], v80 offset:24832
    ds_read_b64_tr_b16 v[22:23], v80 offset:26368
    s_waitcnt lgkmcnt(14)
    v_mfma_f32_32x32x16_bf16 v[192:207], v[44:47], v[40:43], v[192:207]
    ds_read_b128 v[24:27], v77 offset:0
    ds_read_b64_tr_b16 v[28:29], v80 offset:30720
    ds_read_b64_tr_b16 v[30:31], v80 offset:32256
    v_mfma_f32_32x32x16_bf16 v[208:223], v[48:51], v[40:43], v[208:223]
    ds_read_b64_tr_b16 v[32:33], v80 offset:30848
    ds_read_b64_tr_b16 v[34:35], v80 offset:32384
    v_mfma_f32_32x32x16_bf16 v[224:239], v[40:43], v[52:55], v[224:239]
    ds_read_b64_tr_b16 v[36:37], v80 offset:30976
    ds_read_b64_tr_b16 v[38:39], v80 offset:32512
    s_waitcnt lgkmcnt(14)
    v_mfma_f32_32x32x16_bf16 v[192:207], v[60:63], v[56:59], v[192:207]
    ds_read_b128 v[40:43], v78 offset:0
    ds_read_b64_tr_b16 v[44:45], v80 offset:36864
    ds_read_b64_tr_b16 v[46:47], v80 offset:38400
    v_mfma_f32_32x32x16_bf16 v[208:223], v[64:67], v[56:59], v[208:223]
    ds_read_b64_tr_b16 v[48:49], v80 offset:36992
    ds_read_b64_tr_b16 v[50:51], v80 offset:38528
    v_mfma_f32_32x32x16_bf16 v[224:239], v[56:59], v[68:71], v[224:239]
    ds_read_b64_tr_b16 v[52:53], v80 offset:37120
    ds_read_b64_tr_b16 v[54:55], v80 offset:38656
    s_waitcnt lgkmcnt(14)
    v_mfma_f32_32x32x16_bf16 v[192:207], v[12:15], v[8:11], v[192:207]
    ds_read_b128 v[56:59], v79 offset:0
    ds_read_b64_tr_b16 v[60:61], v80 offset:43008
    ds_read_b64_tr_b16 v[62:63], v80 offset:44544
    v_mfma_f32_32x32x16_bf16 v[208:223], v[16:19], v[8:11], v[208:223]
    ds_read_b64_tr_b16 v[64:65], v80 offset:43136
    ds_read_b64_tr_b16 v[66:67], v80 offset:44672
    v_mfma_f32_32x32x16_bf16 v[224:239], v[8:11], v[20:23], v[224:239]
    ds_read_b64_tr_b16 v[68:69], v80 offset:43264
    ds_read_b64_tr_b16 v[70:71], v80 offset:44800
    s_waitcnt lgkmcnt(14)
    s_barrier
    v_mfma_f32_32x32x16_bf16 v[192:207], v[28:31], v[24:27], v[192:207]
    ds_read_b128 v[8:11], v72 offset:256
    ds_read_b64_tr_b16 v[12:13], v81 offset:0
    ds_read_b64_tr_b16 v[14:15], v81 offset:1536
    v_mfma_f32_32x32x16_bf16 v[208:223], v[32:35], v[24:27], v[208:223]
    ds_read_b64_tr_b16 v[16:17], v81 offset:128
    ds_read_b64_tr_b16 v[18:19], v81 offset:1664
    v_mfma_f32_32x32x16_bf16 v[224:239], v[24:27], v[36:39], v[224:239]
    ds_read_b64_tr_b16 v[20:21], v81 offset:256
    ds_read_b64_tr_b16 v[22:23], v81 offset:1792
    s_waitcnt lgkmcnt(14)
    v_mfma_f32_32x32x16_bf16 v[192:207], v[44:47], v[40:43], v[192:207]
    ds_read_b128 v[24:27], v73 offset:256
    ds_read_b64_tr_b16 v[28:29], v81 offset:6144
    ds_read_b64_tr_b16 v[30:31], v81 offset:7680
    v_mfma_f32_32x32x16_bf16 v[208:223], v[48:51], v[40:43], v[208:223]
    ds_read_b64_tr_b16 v[32:33], v81 offset:6272
    ds_read_b64_tr_b16 v[34:35], v81 offset:7808
    v_mfma_f32_32x32x16_bf16 v[224:239], v[40:43], v[52:55], v[224:239]
    ds_read_b64_tr_b16 v[36:37], v81 offset:6400
    ds_read_b64_tr_b16 v[38:39], v81 offset:7936
    s_waitcnt lgkmcnt(14)
    v_mfma_f32_32x32x16_bf16 v[192:207], v[60:63], v[56:59], v[192:207]
    ds_read_b128 v[40:43], v74 offset:256
    ds_read_b64_tr_b16 v[44:45], v81 offset:12288
    ds_read_b64_tr_b16 v[46:47], v81 offset:13824
    v_mfma_f32_32x32x16_bf16 v[208:223], v[64:67], v[56:59], v[208:223]
    ds_read_b64_tr_b16 v[48:49], v81 offset:12416
    ds_read_b64_tr_b16 v[50:51], v81 offset:13952
    v_mfma_f32_32x32x16_bf16 v[224:239], v[56:59], v[68:71], v[224:239]
    ds_read_b64_tr_b16 v[52:53], v81 offset:12544
    ds_read_b64_tr_b16 v[54:55], v81 offset:14080
    s_waitcnt lgkmcnt(14)
    v_mfma_f32_32x32x16_bf16 v[192:207], v[12:15], v[8:11], v[192:207]
    ds_read_b128 v[56:59], v75 offset:256
    ds_read_b64_tr_b16 v[60:61], v81 offset:18432
    ds_read_b64_tr_b16 v[62:63], v81 offset:19968
    v_mfma_f32_32x32x16_bf16 v[208:223], v[16:19], v[8:11], v[208:223]
    ds_read_b64_tr_b16 v[64:65], v81 offset:18560
    ds_read_b64_tr_b16 v[66:67], v81 offset:20096
    v_mfma_f32_32x32x16_bf16 v[224:239], v[8:11], v[20:23], v[224:239]
    ds_read_b64_tr_b16 v[68:69], v81 offset:18688
    ds_read_b64_tr_b16 v[70:71], v81 offset:20224
    s_waitcnt lgkmcnt(14)
    s_barrier
    v_mfma_f32_32x32x16_bf16 v[192:207], v[28:31], v[24:27], v[192:207]
    ds_read_b128 v[8:11], v76 offset:256
    ds_read_b64_tr_b16 v[12:13], v81 offset:24576
    ds_read_b64_tr_b16 v[14:15], v81 offset:26112
    v_mfma_f32_32x32x16_bf16 v[208:223], v[32:35], v[24:27], v[208:223]
    ds_read_b64_tr_b16 v[16:17], v81 offset:24704
    ds_read_b64_tr_b16 v[18:19], v81 offset:26240
    v_mfma_f32_32x32x16_bf16 v[224:239], v[24:27], v[36:39], v[224:239]
    ds_read_b64_tr_b16 v[20:21], v81 offset:24832
    ds_read_b64_tr_b16 v[22:23], v81 offset:26368
    s_waitcnt lgkmcnt(14)
    v_mfma_f32_32x32x16_bf16 v[192:207], v[44:47], v[40:43], v[192:207]
    ds_read_b128 v[24:27], v77 offset:256
    ds_read_b64_tr_b16 v[28:29], v81 offset:30720
    ds_read_b64_tr_b16 v[30:31], v81 offset:32256
    v_mfma_f32_32x32x16_bf16 v[208:223], v[48:51], v[40:43], v[208:223]
    ds_read_b64_tr_b16 v[32:33], v81 offset:30848
    ds_read_b64_tr_b16 v[34:35], v81 offset:32384
    v_mfma_f32_32x32x16_bf16 v[224:239], v[40:43], v[52:55], v[224:239]
    ds_read_b64_tr_b16 v[36:37], v81 offset:30976
    ds_read_b64_tr_b16 v[38:39], v81 offset:32512
    s_waitcnt lgkmcnt(14)
    v_mfma_f32_32x32x16_bf16 v[192:207], v[60:63], v[56:59], v[192:207]
    ds_read_b128 v[40:43], v78 offset:256
    ds_read_b64_tr_b16 v[44:45], v81 offset:36864
    ds_read_b64_tr_b16 v[46:47], v81 offset:38400
    v_mfma_f32_32x32x16_bf16 v[208:223], v[64:67], v[56:59], v[208:223]
    ds_read_b64_tr_b16 v[48:49], v81 offset:36992
    ds_read_b64_tr_b16 v[50:51], v81 offset:38528
    v_mfma_f32_32x32x16_bf16 v[224:239], v[56:59], v[68:71], v[224:239]
    ds_read_b64_tr_b16 v[52:53], v81 offset:37120
    ds_read_b64_tr_b16 v[54:55], v81 offset:38656
    s_waitcnt lgkmcnt(14)
    v_mfma_f32_32x32x16_bf16 v[192:207], v[12:15], v[8:11], v[192:207]
    ds_read_b128 v[56:59], v79 offset:256
    ds_read_b64_tr_b16 v[60:61], v81 offset:43008
    ds_read_b64_tr_b16 v[62:63], v81 offset:44544
    v_mfma_f32_32x32x16_bf16 v[208:223], v[16:19], v[8:11], v[208:223]
    ds_read_b64_tr_b16 v[64:65], v81 offset:43136
    ds_read_b64_tr_b16 v[66:67], v81 offset:44672
    v_mfma_f32_32x32x16_bf16 v[224:239], v[8:11], v[20:23], v[224:239]
    ds_read_b64_tr_b16 v[68:69], v81 offset:43264
    ds_read_b64_tr_b16 v[70:71], v81 offset:44800
    s_waitcnt lgkmcnt(14)
    s_barrier
    v_mfma_f32_32x32x16_bf16 v[192:207], v[28:31], v[24:27], v[192:207]
    ds_read_b128 v[8:11], v72 offset:512
    ds_read_b64_tr_b16 v[12:13], v80 offset:0
    ds_read_b64_tr_b16 v[14:15], v80 offset:1536
    v_mfma_f32_32x32x16_bf16 v[208:223], v[32:35], v[24:27], v[208:223]
    ds_read_b64_tr_b16 v[16:17], v80 offset:128
    ds_read_b64_tr_b16 v[18:19], v80 offset:1664
    v_mfma_f32_32x32x16_bf16 v[224:239], v[24:27], v[36:39], v[224:239]
    ds_read_b64_tr_b16 v[20:21], v80 offset:256
    ds_read_b64_tr_b16 v[22:23], v80 offset:1792
    s_waitcnt lgkmcnt(14)
    v_mfma_f32_32x32x16_bf16 v[192:207], v[44:47], v[40:43], v[192:207]
    ds_read_b128 v[24:27], v73 offset:512
    ds_read_b64_tr_b16 v[28:29], v80 offset:6144
    ds_read_b64_tr_b16 v[30:31], v80 offset:7680
    v_mfma_f32_32x32x16_bf16 v[208:223], v[48:51], v[40:43], v[208:223]
    ds_read_b64_tr_b16 v[32:33], v80 offset:6272
    ds_read_b64_tr_b16 v[34:35], v80 offset:7808
    v_mfma_f32_32x32x16_bf16 v[224:239], v[40:43], v[52:55], v[224:239]
    ds_read_b64_tr_b16 v[36:37], v80 offset:6400
    ds_read_b64_tr_b16 v[38:39], v80 offset:7936
    s_waitcnt lgkmcnt(14)
    v_mfma_f32_32x32x16_bf16 v[192:207], v[60:63], v[56:59], v[192:207]
    ds_read_b128 v[40:43], v74 offset:512
    ds_read_b64_tr_b16 v[44:45], v80 offset:12288
    ds_read_b64_tr_b16 v[46:47], v80 offset:13824
    v_mfma_f32_32x32x16_bf16 v[208:223], v[64:67], v[56:59], v[208:223]
    ds_read_b64_tr_b16 v[48:49], v80 offset:12416
    ds_read_b64_tr_b16 v[50:51], v80 offset:13952
    v_mfma_f32_32x32x16_bf16 v[224:239], v[56:59], v[68:71], v[224:239]
    ds_read_b64_tr_b16 v[52:53], v80 offset:12544
    ds_read_b64_tr_b16 v[54:55], v80 offset:14080
    s_waitcnt lgkmcnt(14)
    v_mfma_f32_32x32x16_bf16 v[192:207], v[12:15], v[8:11], v[192:207]
    ds_read_b128 v[56:59], v75 offset:512
    ds_read_b64_tr_b16 v[60:61], v80 offset:18432
    ds_read_b64_tr_b16 v[62:63], v80 offset:19968
    v_mfma_f32_32x32x16_bf16 v[208:223], v[16:19], v[8:11], v[208:223]
    ds_read_b64_tr_b16 v[64:65], v80 offset:18560
    ds_read_b64_tr_b16 v[66:67], v80 offset:20096
    v_mfma_f32_32x32x16_bf16 v[224:239], v[8:11], v[20:23], v[224:239]
    ds_read_b64_tr_b16 v[68:69], v80 offset:18688
    ds_read_b64_tr_b16 v[70:71], v80 offset:20224
    s_waitcnt lgkmcnt(14)
    s_barrier
    v_mfma_f32_32x32x16_bf16 v[192:207], v[28:31], v[24:27], v[192:207]
    ds_read_b128 v[8:11], v76 offset:512
    ds_read_b64_tr_b16 v[12:13], v80 offset:24576
    ds_read_b64_tr_b16 v[14:15], v80 offset:26112
    v_mfma_f32_32x32x16_bf16 v[208:223], v[32:35], v[24:27], v[208:223]
    ds_read_b64_tr_b16 v[16:17], v80 offset:24704
    ds_read_b64_tr_b16 v[18:19], v80 offset:26240
    v_mfma_f32_32x32x16_bf16 v[224:239], v[24:27], v[36:39], v[224:239]
    ds_read_b64_tr_b16 v[20:21], v80 offset:24832
    ds_read_b64_tr_b16 v[22:23], v80 offset:26368
    s_waitcnt lgkmcnt(14)
    v_mfma_f32_32x32x16_bf16 v[192:207], v[44:47], v[40:43], v[192:207]
    ds_read_b128 v[24:27], v77 offset:512
    ds_read_b64_tr_b16 v[28:29], v80 offset:30720
    ds_read_b64_tr_b16 v[30:31], v80 offset:32256
    v_mfma_f32_32x32x16_bf16 v[208:223], v[48:51], v[40:43], v[208:223]
    ds_read_b64_tr_b16 v[32:33], v80 offset:30848
    ds_read_b64_tr_b16 v[34:35], v80 offset:32384
    v_mfma_f32_32x32x16_bf16 v[224:239], v[40:43], v[52:55], v[224:239]
    ds_read_b64_tr_b16 v[36:37], v80 offset:30976
    ds_read_b64_tr_b16 v[38:39], v80 offset:32512
    s_waitcnt lgkmcnt(14)
    v_mfma_f32_32x32x16_bf16 v[192:207], v[60:63], v[56:59], v[192:207]
    ds_read_b128 v[40:43], v78 offset:512
    ds_read_b64_tr_b16 v[44:45], v80 offset:36864
    ds_read_b64_tr_b16 v[46:47], v80 offset:38400
    v_mfma_f32_32x32x16_bf16 v[208:223], v[64:67], v[56:59], v[208:223]
    ds_read_b64_tr_b16 v[48:49], v80 offset:36992
    ds_read_b64_tr_b16 v[50:51], v80 offset:38528
    v_mfma_f32_32x32x16_bf16 v[224:239], v[56:59], v[68:71], v[224:239]
    ds_read_b64_tr_b16 v[52:53], v80 offset:37120
    ds_read_b64_tr_b16 v[54:55], v80 offset:38656
    s_waitcnt lgkmcnt(14)
    v_mfma_f32_32x32x16_bf16 v[192:207], v[12:15], v[8:11], v[192:207]
    ds_read_b128 v[56:59], v79 offset:512
    ds_read_b64_tr_b16 v[60:61], v80 offset:43008
    ds_read_b64_tr_b16 v[62:63], v80 offset:44544
    v_mfma_f32_32x32x16_bf16 v[208:223], v[16:19], v[8:11], v[208:223]
    ds_read_b64_tr_b16 v[64:65], v80 offset:43136
    ds_read_b64_tr_b16 v[66:67], v80 offset:44672
    v_mfma_f32_32x32x16_bf16 v[224:239], v[8:11], v[20:23], v[224:239]
    ds_read_b64_tr_b16 v[68:69], v80 offset:43264
    ds_read_b64_tr_b16 v[70:71], v80 offset:44800
    s_cmp_lg_u32 s57, 2
    s_cbranch_scc1 L_restl_33
    v_lshrrev_b32 v5, 2, v0
    v_and_b32 v6, 3, v0
    v_lshlrev_b32 v7, 3, v5
    global_load_dwordx2 v[136:137], v7, s[32:33]
    v_mul_u32_u24 v5, 24576, v5
    v_lshl_add_u32 v5, v6, 4, v5
    s_mov_b32 s12, s34
    s_mov_b32 s13, s35
    s_mov_b32 s14, 3145728
    s_mov_b32 s15, 0x20000
    s_lshl_b32 s49, s59, 6
    buffer_load_dwordx4 v[104:107], v5, s[12:15], s49 offen
    s_add_u32 s49, s49, 6144
    buffer_load_dwordx4 v[108:111], v5, s[12:15], s49 offen
    s_add_u32 s49, s49, 6144
    buffer_load_dwordx4 v[112:115], v5, s[12:15], s49 offen
    s_add_u32 s49, s49, 6144
    buffer_load_dwordx4 v[116:119], v5, s[12:15], s49 offen
L_restl_33:
    s_waitcnt lgkmcnt(14)
    s_barrier
    v_mfma_f32_32x32x16_bf16 v[192:207], v[28:31], v[24:27], v[192:207]
    ds_read_b128 v[8:11], v72 offset:768
    ds_read_b64_tr_b16 v[12:13], v81 offset:0
    ds_read_b64_tr_b16 v[14:15], v81 offset:1536
    v_mfma_f32_32x32x16_bf16 v[208:223], v[32:35], v[24:27], v[208:223]
    ds_read_b64_tr_b16 v[16:17], v81 offset:128
    ds_read_b64_tr_b16 v[18:19], v81 offset:1664
    v_mfma_f32_32x32x16_bf16 v[224:239], v[24:27], v[36:39], v[224:239]
    ds_read_b64_tr_b16 v[20:21], v81 offset:256
    ds_read_b64_tr_b16 v[22:23], v81 offset:1792
    s_waitcnt lgkmcnt(14)
    v_mfma_f32_32x32x16_bf16 v[192:207], v[44:47], v[40:43], v[192:207]
    ds_read_b128 v[24:27], v73 offset:768
    ds_read_b64_tr_b16 v[28:29], v81 offset:6144
    ds_read_b64_tr_b16 v[30:31], v81 offset:7680
    v_mfma_f32_32x32x16_bf16 v[208:223], v[48:51], v[40:43], v[208:223]
    ds_read_b64_tr_b16 v[32:33], v81 offset:6272
    ds_read_b64_tr_b16 v[34:35], v81 offset:7808
    v_mfma_f32_32x32x16_bf16 v[224:239], v[40:43], v[52:55], v[224:239]
    ds_read_b64_tr_b16 v[36:37], v81 offset:6400
    ds_read_b64_tr_b16 v[38:39], v81 offset:7936
    s_waitcnt lgkmcnt(14)
    v_mfma_f32_32x32x16_bf16 v[192:207], v[60:63], v[56:59], v[192:207]
    ds_read_b128 v[40:43], v74 offset:768
    ds_read_b64_tr_b16 v[44:45], v81 offset:12288
    ds_read_b64_tr_b16 v[46:47], v81 offset:13824
    v_mfma_f32_32x32x16_bf16 v[208:223], v[64:67], v[56:59], v[208:223]
    ds_read_b64_tr_b16 v[48:49], v81 offset:12416
    ds_read_b64_tr_b16 v[50:51], v81 offset:13952
    v_mfma_f32_32x32x16_bf16 v[224:239], v[56:59], v[68:71], v[224:239]
    ds_read_b64_tr_b16 v[52:53], v81 offset:12544
    ds_read_b64_tr_b16 v[54:55], v81 offset:14080
    s_waitcnt lgkmcnt(14)
    v_mfma_f32_32x32x16_bf16 v[192:207], v[12:15], v[8:11], v[192:207]
    ds_read_b128 v[56:59], v75 offset:768
    ds_read_b64_tr_b16 v[60:61], v81 offset:18432
    ds_read_b64_tr_b16 v[62:63], v81 offset:19968
    v_mfma_f32_32x32x16_bf16 v[208:223], v[16:19], v[8:11], v[208:223]
    ds_read_b64_tr_b16 v[64:65], v81 offset:18560
    ds_read_b64_tr_b16 v[66:67], v81 offset:20096
    v_mfma_f32_32x32x16_bf16 v[224:239], v[8:11], v[20:23], v[224:239]
    ds_read_b64_tr_b16 v[68:69], v81 offset:18688
    ds_read_b64_tr_b16 v[70:71], v81 offset:20224
    s_waitcnt lgkmcnt(14)
    s_barrier
    v_mfma_f32_32x32x16_bf16 v[192:207], v[28:31], v[24:27], v[192:207]
    ds_read_b128 v[8:11], v76 offset:768
    ds_read_b64_tr_b16 v[12:13], v81 offset:24576
    ds_read_b64_tr_b16 v[14:15], v81 offset:26112
    v_mfma_f32_32x32x16_bf16 v[208:223], v[32:35], v[24:27], v[208:223]
    ds_read_b64_tr_b16 v[16:17], v81 offset:24704
    ds_read_b64_tr_b16 v[18:19], v81 offset:26240
    v_mfma_f32_32x32x16_bf16 v[224:239], v[24:27], v[36:39], v[224:239]
    ds_read_b64_tr_b16 v[20:21], v81 offset:24832
    ds_read_b64_tr_b16 v[22:23], v81 offset:26368
    s_waitcnt lgkmcnt(14)
    v_mfma_f32_32x32x16_bf16 v[192:207], v[44:47], v[40:43], v[192:207]
    ds_read_b128 v[24:27], v77 offset:768
    ds_read_b64_tr_b16 v[28:29], v81 offset:30720
    ds_read_b64_tr_b16 v[30:31], v81 offset:32256
    v_mfma_f32_32x32x16_bf16 v[208:223], v[48:51], v[40:43], v[208:223]
    ds_read_b64_tr_b16 v[32:33], v81 offset:30848
    ds_read_b64_tr_b16 v[34:35], v81 offset:32384
    v_mfma_f32_32x32x16_bf16 v[224:239], v[40:43], v[52:55], v[224:239]
    ds_read_b64_tr_b16 v[36:37], v81 offset:30976
    ds_read_b64_tr_b16 v[38:39], v81 offset:32512
    s_waitcnt lgkmcnt(14)
    v_mfma_f32_32x32x16_bf16 v[192:207], v[60:63], v[56:59], v[192:207]
    ds_read_b128 v[40:43], v78 offset:768
    ds_read_b64_tr_b16 v[44:45], v81 offset:36864
    ds_read_b64_tr_b16 v[46:47], v81 offset:38400
    v_mfma_f32_32x32x16_bf16 v[208:223], v[64:67], v[56:59], v[208:223]
    ds_read_b64_tr_b16 v[48:49], v81 offset:36992
    ds_read_b64_tr_b16 v[50:51], v81 offset:38528
    v_mfma_f32_32x32x16_bf16 v[224:239], v[56:59], v[68:71], v[224:239]
    ds_read_b64_tr_b16 v[52:53], v81 offset:37120
    ds_read_b64_tr_b16 v[54:55], v81 offset:38656
    s_waitcnt lgkmcnt(14)
    v_mfma_f32_32x32x16_bf16 v[192:207], v[12:15], v[8:11], v[192:207]
    ds_read_b128 v[56:59], v79 offset:768
    ds_read_b64_tr_b16 v[60:61], v81 offset:43008
    ds_read_b64_tr_b16 v[62:63], v81 offset:44544
    v_mfma_f32_32x32x16_bf16 v[208:223], v[16:19], v[8:11], v[208:223]
    ds_read_b64_tr_b16 v[64:65], v81 offset:43136
    ds_read_b64_tr_b16 v[66:67], v81 offset:44672
    v_mfma_f32_32x32x16_bf16 v[224:239], v[8:11], v[20:23], v[224:239]
    ds_read_b64_tr_b16 v[68:69], v81 offset:43264
    ds_read_b64_tr_b16 v[70:71], v81 offset:44800
    s_waitcnt lgkmcnt(14)
    v_mfma_f32_32x32x16_bf16 v[192:207], v[28:31], v[24:27], v[192:207]
    v_mfma_f32_32x32x16_bf16 v[208:223], v[32:35], v[24:27], v[208:223]
    v_mfma_f32_32x32x16_bf16 v[224:239], v[24:27], v[36:39], v[224:239]
    s_waitcnt lgkmcnt(7)
    v_mfma_f32_32x32x16_bf16 v[192:207], v[44:47], v[40:43], v[192:207]
    v_mfma_f32_32x32x16_bf16 v[208:223], v[48:51], v[40:43], v[208:223]
    v_mfma_f32_32x32x16_bf16 v[224:239], v[40:43], v[52:55], v[224:239]
    s_waitcnt lgkmcnt(0)
    v_mfma_f32_32x32x16_bf16 v[192:207], v[60:63], v[56:59], v[192:207]
    v_mfma_f32_32x32x16_bf16 v[208:223], v[64:67], v[56:59], v[208:223]
    v_mfma_f32_32x32x16_bf16 v[224:239], v[56:59], v[68:71], v[224:239]
    s_lshl_b32 s53, s43, 2
    s_lshl_b32 s54, s52, 1
    s_add_u32 s53, s53, s54
    s_lshl_b32 s54, s42, 1
    s_add_u32 s54, s54, s51
    s_lshl_b32 s55, s53, 6
    s_add_u32 s55, s55, s54
    v_lshlrev_b32 v5, 4, v1
    s_lshl_b32 s56, s55, 11
    s_add_u32 s56, s56, 3145728
    v_add_u32 v6, s56, v5
    v_add_u32 v7, 0x20000, v6
    v_bfe_u32 v32, v1, 4, 1
    v_lshlrev_b32 v32, 17, v32
    v_and_b32 v33, 15, v1
    v_lshl_add_u32 v33, v3, 4, v33
    v_lshl_add_u32 v32, v33, 4, v32
    s_add_u32 s56, s56, 1024
    v_add_u32 v32, s56, v32
    s_lshl_b32 s56, s55, 10
    s_add_u32 s56, s56, 1048576
    v_add_u32 v33, s56, v5
    v_add_u32 v34, 0x10000, v33
    s_mov_b32 s49, 0x3eb8aa3b
    v_cvt_pk_bf16_f32 v16, v208, v209
    v_cvt_pk_bf16_f32 v17, v210, v211
    v_cvt_pk_bf16_f32 v18, v212, v213
    v_cvt_pk_bf16_f32 v19, v214, v215
    v_cvt_pk_bf16_f32 v20, v216, v217
    v_cvt_pk_bf16_f32 v21, v218, v219
    v_cvt_pk_bf16_f32 v22, v220, v221
    v_cvt_pk_bf16_f32 v23, v222, v223
    global_store_dwordx4 v6, v[16:19], s[40:41] sc1
    global_store_dwordx4 v7, v[20:23], s[40:41] sc1
    v_cvt_pk_bf16_f32 v24, v224, v225
    v_cvt_pk_bf16_f32 v25, v226, v227
    v_cvt_pk_bf16_f32 v26, v228, v229
    v_cvt_pk_bf16_f32 v27, v230, v231
    v_cvt_pk_bf16_f32 v28, v232, v233
    v_cvt_pk_bf16_f32 v29, v234, v235
    v_cvt_pk_bf16_f32 v30, v236, v237
    v_cvt_pk_bf16_f32 v31, v238, v239
    global_store_dwordx4 v32, v[24:27], s[40:41] sc1
    global_store_dwordx4 v32, v[28:31], s[40:41] offset:512 sc1
    v_mul_f32 v192, s49, v192
    v_mul_f32 v193, s49, v193
    v_mul_f32 v194, s49, v194
    v_mul_f32 v195, s49, v195
    v_mul_f32 v196, s49, v196
    v_mul_f32 v197, s49, v197
    v_mul_f32 v198, s49, v198
    v_mul_f32 v199, s49, v199
    v_mul_f32 v200, s49, v200
    v_mul_f32 v201, s49, v201
    v_mul_f32 v202, s49, v202
    v_mul_f32 v203, s49, v203
    v_mul_f32 v204, s49, v204
    v_mul_f32 v205, s49, v205
    v_mul_f32 v206, s49, v206
    v_mul_f32 v207, s49, v207
    v_cvt_pk_bf16_f32 v8, v192, v193
    v_cvt_pk_bf16_f32 v9, v194, v195
    v_cvt_pk_bf16_f32 v10, v196, v197
    v_cvt_pk_bf16_f32 v11, v198, v199
    v_cvt_pk_bf16_f32 v12, v200, v201
    v_cvt_pk_bf16_f32 v13, v202, v203
    v_cvt_pk_bf16_f32 v14, v204, v205
    v_cvt_pk_bf16_f32 v15, v206, v207
    global_store_dwordx4 v33, v[8:11], s[40:41] sc1
    global_store_dwordx4 v34, v[12:15], s[40:41] sc1
    s_waitcnt vmcnt(0)
    s_branch L_p1done_32
L_p1load_31:
    s_add_u32 s49, s47, 589824
    s_add_u32 m0, s48, 73728
    s_nop 0
    buffer_load_dwordx4 v184, s[8:11], s49 offen lds
    s_add_u32 m0, s48, 74752
    s_nop 0
    buffer_load_dwordx4 v185, s[8:11], s49 offen lds
    s_add_u32 m0, s48, 75776
    s_nop 0
    buffer_load_dwordx4 v186, s[8:11], s49 offen lds
    s_add_u32 m0, s48, 76800
    s_nop 0
    buffer_load_dwordx4 v187, s[8:11], s49 offen lds
    s_add_u32 m0, s48, 77824
    s_nop 0
    buffer_load_dwordx4 v188, s[8:11], s49 offen lds
    s_add_u32 m0, s48, 78848
    s_nop 0
    buffer_load_dwordx4 v189, s[8:11], s49 offen lds
    s_waitcnt vmcnt(12)
    s_barrier
    s_waitcnt vmcnt(6)
    s_barrier
    s_add_u32 s49, s47, 786432
    s_add_u32 m0, s48, 0
    s_nop 0
    buffer_load_dwordx4 v184, s[8:11], s49 offen lds
    s_add_u32 m0, s48, 1024
    s_nop 0
    buffer_load_dwordx4 v185, s[8:11], s49 offen lds
    s_add_u32 m0, s48, 2048
    s_nop 0
    buffer_load_dwordx4 v186, s[8:11], s49 offen lds
    s_add_u32 m0, s48, 3072
    s_nop 0
    buffer_load_dwordx4 v187, s[8:11], s49 offen lds
    s_add_u32 m0, s48, 4096
    s_nop 0
    buffer_load_dwordx4 v188, s[8:11], s49 offen lds
    s_add_u32 m0, s48, 5120
    s_nop 0
    buffer_load_dwordx4 v189, s[8:11], s49 offen lds
    s_waitcnt vmcnt(6)
    s_barrier
    s_add_u32 s49, s47, 983040
    s_add_u32 m0, s48, 24576
    s_nop 0
    buffer_load_dwordx4 v184, s[8:11], s49 offen lds
    s_add_u32 m0, s48, 25600
    s_nop 0
    buffer_load_dwordx4 v185, s[8:11], s49 offen lds
    s_add_u32 m0, s48, 26624
    s_nop 0
    buffer_load_dwordx4 v186, s[8:11], s49 offen lds
    s_add_u32 m0, s48, 27648
    s_nop 0
    buffer_load_dwordx4 v187, s[8:11], s49 offen lds
    s_add_u32 m0, s48, 28672
    s_nop 0
    buffer_load_dwordx4 v188, s[8:11], s49 offen lds
    s_add_u32 m0, s48, 29696
    s_nop 0
    buffer_load_dwordx4 v189, s[8:11], s49 offen lds
    s_waitcnt vmcnt(6)
    s_barrier
    s_add_u32 s49, s47, 1179648
    s_add_u32 m0, s48, 49152
    s_nop 0
    buffer_load_dwordx4 v184, s[8:11], s49 offen lds
    s_add_u32 m0, s48, 50176
    s_nop 0
    buffer_load_dwordx4 v185, s[8:11], s49 offen lds
    s_add_u32 m0, s48, 51200
    s_nop 0
    buffer_load_dwordx4 v186, s[8:11], s49 offen lds
    s_add_u32 m0, s48, 52224
    s_nop 0
    buffer_load_dwordx4 v187, s[8:11], s49 offen lds
    s_add_u32 m0, s48, 53248
    s_nop 0
    buffer_load_dwordx4 v188, s[8:11], s49 offen lds
    s_add_u32 m0, s48, 54272
    s_nop 0
    buffer_load_dwordx4 v189, s[8:11], s49 offen lds
    s_waitcnt vmcnt(6)
    s_barrier
    s_add_u32 s49, s47, 1376256
    s_add_u32 m0, s48, 73728
    s_nop 0
    buffer_load_dwordx4 v184, s[8:11], s49 offen lds
    s_add_u32 m0, s48, 74752
    s_nop 0
    buffer_load_dwordx4 v185, s[8:11], s49 offen lds
    s_add_u32 m0, s48, 75776
    s_nop 0
    buffer_load_dwordx4 v186, s[8:11], s49 offen lds
    s_add_u32 m0, s48, 76800
    s_nop 0
    buffer_load_dwordx4 v187, s[8:11], s49 offen lds
    s_add_u32 m0, s48, 77824
    s_nop 0
    buffer_load_dwordx4 v188, s[8:11], s49 offen lds
    s_add_u32 m0, s48, 78848
    s_nop 0
    buffer_load_dwordx4 v189, s[8:11], s49 offen lds
    s_waitcnt vmcnt(6)
    s_barrier
    s_waitcnt vmcnt(0)
    s_barrier
    s_cmp_lg_u32 s57, 2
    s_cbranch_scc1 L_restl_34
    v_lshrrev_b32 v5, 2, v0
    v_and_b32 v6, 3, v0
    v_lshlrev_b32 v7, 3, v5
    global_load_dwordx2 v[136:137], v7, s[32:33]
    v_mul_u32_u24 v5, 24576, v5
    v_lshl_add_u32 v5, v6, 4, v5
    s_mov_b32 s12, s34
    s_mov_b32 s13, s35
    s_mov_b32 s14, 3145728
    s_mov_b32 s15, 0x20000
    s_lshl_b32 s49, s59, 6
    buffer_load_dwordx4 v[104:107], v5, s[12:15], s49 offen
    s_add_u32 s49, s49, 6144
    buffer_load_dwordx4 v[108:111], v5, s[12:15], s49 offen
    s_add_u32 s49, s49, 6144
    buffer_load_dwordx4 v[112:115], v5, s[12:15], s49 offen
    s_add_u32 s49, s49, 6144
    buffer_load_dwordx4 v[116:119], v5, s[12:15], s49 offen
L_restl_34:
    s_getpc_b64 s[62:63]
L_pc_35:
    s_add_u32 s62, s62, (L_P2 - L_pc_35)
    s_addc_u32 s63, s63, 0
    v_lshlrev_b32 v252, 7, v1
    v_min_u32 v253, (L_P3 - L_P2 - 4), v252
    global_load_dword v251, v253, s[62:63]
    v_add_u32 v252, 0x2000, v252
    v_min_u32 v253, (L_P3 - L_P2 - 4), v252
    global_load_dword v251, v253, s[62:63]
L_p1done_32:
    s_lshl_b32 s58, s43, 8
    s_add_u32 s58, s58, 0
    s_barrier
    s_cmp_lg_u32 s3, 0
    s_cbranch_scc1 L_sig_36
    v_mov_b32 v254, s58
    v_mov_b32 v255, 1
    s_mov_b64 exec, 1
    global_atomic_add v254, v255, s[40:41] sc1
    s_mov_b64 exec, -1
L_sig_36:
    s_cmp_lg_u32 s57, 2
    s_cbranch_scc1 L_restx_37
    s_waitcnt vmcnt(0)
    v_lshlrev_b32 v150, 16, v136
    v_and_b32 v151, 0xffff0000, v136
    v_lshlrev_b32 v152, 16, v137
    v_and_b32 v153, 0xffff0000, v137
    v_mul_f32 v160, 0xbfb8aa3b, v150
    v_mul_f32 v161, 0xbfb8aa3b, v151
    v_mul_f32 v162, 0xbfb8aa3b, v152
    v_mul_f32 v163, 0xbfb8aa3b, v153
    v_exp_f32 v160, v160
    v_exp_f32 v161, v161
    v_exp_f32 v162, v162
    v_exp_f32 v163, v163
    s_nop 0
    v_add_f32 v160, 1.0, v160
    v_add_f32 v161, 1.0, v161
    v_add_f32 v162, 1.0, v162
    v_add_f32 v163, 1.0, v163
    v_rcp_f32 v160, v160
    v_rcp_f32 v161, v161
    v_rcp_f32 v162, v162
    v_rcp_f32 v163, v163
    s_nop 0
    v_mul_f32 v150, v150, v160
    v_mul_f32 v151, v151, v161
    v_mul_f32 v152, v152, v162
    v_mul_f32 v153, v153, v163
    v_cvt_pk_bf16_f32 v160, v150, v151
    v_cvt_pk_bf16_f32 v161, v152, v153
    v_lshlrev_b32 v150, 16, v160
    v_and_b32 v151, 0xffff0000, v160
    v_lshlrev_b32 v152, 16, v161
    v_and_b32 v153, 0xffff0000, v161
    v_mov_b32 v140, 0
    v_mov_b32 v141, 0
    v_mov_b32 v142, 0
    v_mov_b32 v143, 0
    v_mov_b32 v144, 0
    v_mov_b32 v145, 0
    v_mov_b32 v146, 0
    v_mov_b32 v147, 0
    s_waitcnt vmcnt(0)
    v_lshlrev_b32 v160, 16, v104
    v_and_b32 v161, 0xffff0000, v104
    v_fmac_f32 v140, v150, v160
    v_fmac_f32 v141, v150, v161
    v_lshlrev_b32 v160, 16, v105
    v_and_b32 v161, 0xffff0000, v105
    v_fmac_f32 v142, v150, v160
    v_fmac_f32 v143, v150, v161
    v_lshlrev_b32 v160, 16, v106
    v_and_b32 v161, 0xffff0000, v106
    v_fmac_f32 v144, v150, v160
    v_fmac_f32 v145, v150, v161
    v_lshlrev_b32 v160, 16, v107
    v_and_b32 v161, 0xffff0000, v107
    v_fmac_f32 v146, v150, v160
    v_fmac_f32 v147, v150, v161
    v_lshlrev_b32 v160, 16, v108
    v_and_b32 v161, 0xffff0000, v108
    v_fmac_f32 v140, v151, v160
    v_fmac_f32 v141, v151, v161
    v_lshlrev_b32 v160, 16, v109
    v_and_b32 v161, 0xffff0000, v109
    v_fmac_f32 v142, v151, v160
    v_fmac_f32 v143, v151, v161
    v_lshlrev_b32 v160, 16, v110
    v_and_b32 v161, 0xffff0000, v110
    v_fmac_f32 v144, v151, v160
    v_fmac_f32 v145, v151, v161
    v_lshlrev_b32 v160, 16, v111
    v_and_b32 v161, 0xffff0000, v111
    v_fmac_f32 v146, v151, v160
    v_fmac_f32 v147, v151, v161
    v_lshlrev_b32 v160, 16, v112
    v_and_b32 v161, 0xffff0000, v112
    v_fmac_f32 v140, v152, v160
    v_fmac_f32 v141, v152, v161
    v_lshlrev_b32 v160, 16, v113
    v_and_b32 v161, 0xffff0000, v113
    v_fmac_f32 v142, v152, v160
    v_fmac_f32 v143, v152, v161
    v_lshlrev_b32 v160, 16, v114
    v_and_b32 v161, 0xffff0000, v114
    v_fmac_f32 v144, v152, v160
    v_fmac_f32 v145, v152, v161
    v_lshlrev_b32 v160, 16, v115
    v_and_b32 v161, 0xffff0000, v115
    v_fmac_f32 v146, v152, v160
    v_fmac_f32 v147, v152, v161
    v_lshlrev_b32 v160, 16, v116
    v_and_b32 v161, 0xffff0000, v116
    v_fmac_f32 v140, v153, v160
    v_fmac_f32 v141, v153, v161
    v_lshlrev_b32 v160, 16, v117
    v_and_b32 v161, 0xffff0000, v117
    v_fmac_f32 v142, v153, v160
    v_fmac_f32 v143, v153, v161
    v_lshlrev_b32 v160, 16, v118
    v_and_b32 v161, 0xffff0000, v118
    v_fmac_f32 v144, v153, v160
    v_fmac_f32 v145, v153, v161
    v_lshlrev_b32 v160, 16, v119
    v_and_b32 v161, 0xffff0000, v119
    v_fmac_f32 v146, v153, v160
    v_fmac_f32 v147, v153, v161
    v_lshrrev_b32 v5, 2, v0
    v_lshlrev_b32 v5, 7, v5
    v_and_b32 v6, 3, v0
    v_lshl_add_u32 v5, v6, 5, v5
    ds_write_b128 v5, v[140:143]
    ds_write_b128 v5, v[144:147] offset:16
    s_waitcnt lgkmcnt(0)
    s_barrier
    v_lshrrev_b32 v6, 5, v0
    v_lshlrev_b32 v5, 2, v2
    v_lshl_add_u32 v6, v6, 10, v5
    ds_read_b32 v160, v6 offset:0
    ds_read_b32 v161, v6 offset:128
    ds_read_b32 v162, v6 offset:256
    ds_read_b32 v163, v6 offset:384
    ds_read_b32 v164, v6 offset:512
    ds_read_b32 v165, v6 offset:640
    ds_read_b32 v166, v6 offset:768
    ds_read_b32 v167, v6 offset:896
    s_waitcnt lgkmcnt(0)
    v_add_f32 v160, v160, v161
    v_add_f32 v160, v160, v162
    v_add_f32 v160, v160, v163
    v_add_f32 v160, v160, v164
    v_add_f32 v160, v160, v165
    v_add_f32 v160, v160, v166
    v_add_f32 v160, v160, v167
    v_lshlrev_b32 v6, 2, v0
    ds_write_b32 v6, v160 offset:16384
    s_waitcnt lgkmcnt(0)
    s_barrier
    s_cmp_lg_u32 s3, 0
    s_cbranch_scc1 L_restx_37
    v_lshl_add_u32 v6, v3, 10, v5
    ds_read_b32 v160, v6 offset:16384
    ds_read_b32 v161, v6 offset:16512
    ds_read_b32 v162, v6 offset:16640
    ds_read_b32 v163, v6 offset:16768
    ds_read_b32 v164, v6 offset:16896
    ds_read_b32 v165, v6 offset:17024
    ds_read_b32 v166, v6 offset:17152
    ds_read_b32 v167, v6 offset:17280
    s_waitcnt lgkmcnt(0)
    v_add_f32 v160, v160, v161
    v_add_f32 v160, v160, v162
    v_add_f32 v160, v160, v163
    v_add_f32 v160, v160, v164
    v_add_f32 v160, v160, v165
    v_add_f32 v160, v160, v166
    v_add_f32 v160, v160, v167
    v_mov_b32 v161, v160
    s_nop 1
    v_permlane32_swap_b32 v160, v161
    s_nop 1
    v_add_f32 v160, v160, v161
    v_cvt_pk_bf16_f32 v160, v160, v160
    v_and_b32 v160, 0xffff0000, v160
    s_lshr_b32 s49, s59, 4
    s_cmp_lg_u32 s49, 4
    s_cbranch_scc1 L_mod4_38
    v_add_f32 v160, 1.0, v160
    v_cvt_pk_bf16_f32 v160, v160, v160
    v_and_b32 v160, 0xffff0000, v160
L_mod4_38:
    s_lshl_b32 s49, s59, 7
    s_add_u32 s49, s49, 65536
    v_add_u32 v5, s49, v5
    s_mov_b64 exec, 0xffffffff
    global_store_dword v5, v160, s[40:41] sc1
    s_mov_b64 exec, -1
    v_lshlrev_b32 v5, 8, v1
    v_add_u32 v5, 34816, v5
    v_mov_b32 v6, 1
    s_waitcnt vmcnt(0)
    s_mov_b64 exec, 0xff
    global_atomic_add v5, v6, s[40:41] sc1
    s_mov_b64 exec, -1
L_restx_37:
L_P2:
    s_and_b32 s42, s2, 31
    s_lshr_b32 s43, s2, 5
    v_lshlrev_b32 v10, 4, v1
    s_cmp_lt_u32 s3, 4
    s_cbranch_scc1 L_p2pre_41
    v_lshlrev_b32 v252, 7, v1
    s_lshr_b32 s62, s2, 3
    s_and_b32 s63, s3, 3
    s_lshl_b32 s61, s63, 13
    s_mul_i32 s46, s62, 57344
    s_add_u32 s46, s46, s61
    s_add_u32 s52, s24, s46
    s_addc_u32 s53, s25, 0
    s_add_u32 s46, s46, 32768
    s_lshl_b32 s47, s62, 14
    s_cmp_eq_u32 s63, 3
    s_cselect_b32 s46, s47, s46
    s_cselect_b32 s54, s20, s24
    s_cselect_b32 s55, s21, s25
    s_add_u32 s54, s54, s46
    s_addc_u32 s55, s55, 0
    s_mul_i32 s46, s62, 28672
    s_add_u32 s46, s46, s61
    s_sub_u32 s46, s46, 8192
    s_add_u32 s47, s47, 8192
    s_cmp_eq_u32 s63, 0
    s_cselect_b32 s46, s47, s46
    s_cselect_b32 s56, s20, s30
    s_cselect_b32 s57, s21, s31
    s_add_u32 s56, s56, s46
    s_addc_u32 s57, s57, 0
    s_mul_i32 s46, s62, 28672
    s_add_u32 s46, s46, 24576
    s_add_u32 s50, s30, s46
    s_addc_u32 s51, s31, 0
    s_bfe_u32 s46, s2, 0x20001
    s_lshl_b32 s46, s46, 21
    s_lshl_b32 s47, s62, 16
    s_add_u32 s46, s46, s47
    s_add_u32 s46, s46, s61
    s_add_u32 s44, s26, s46
    s_addc_u32 s45, s27, 0
    s_add_u32 s48, s44, 32768
    s_addc_u32 s49, s45, 0
    s_movk_i32 s59, 8064
    s_movk_i32 s58, 3968
    s_lshl_b32 s46, s42, 17
    s_add_u32 s46, s46, 3145728
    s_add_u32 s4, s40, s46
    s_addc_u32 s5, s41, 0
    s_mov_b32 s6, 131072
    s_mov_b32 s7, 0x20000
    s_and_b32 s47, s3, 3
    s_lshl_b32 s47, s47, 10
    v_lshlrev_b32 v5, 9, v1
    v_add_u32 v5, 133120, v5
    v_mov_b32 v12, 0x3f803f80
    v_mov_b32 v13, 0x3f803f80
    v_mov_b32 v14, 0x3f803f80
    v_mov_b32 v15, 0x3f803f80
    s_mov_b32 s62, -1
    s_mov_b32 s63, 3
    s_mov_b64 exec, s[62:63]
    ds_write_b128 v5, v[12:15]
    s_mov_b64 exec, -1
    s_waitcnt lgkmcnt(0)
    s_branch L_p2pre2_42
L_p2pre_41:
    s_lshl_b32 s48, s42, 6
    s_lshl_b32 s49, s43, 3
    s_add_u32 s48, s48, s49
    s_lshl_b32 s49, s3, 1
    s_add_u32 s48, s48, s49
    s_lshl_b32 s48, s48, 10
    s_add_u32 s48, s48, 1048576
    v_add_u32 v14, s48, v10
    v_and_b32 v187, 15, v1
    v_lshl_add_u32 v187, v3, 4, v187
    v_lshlrev_b32 v187, 4, v187
    v_add_u32 v187, 1024, v187
    v_bfe_u32 v188, v1, 4, 1
    v_cmp_eq_u32 vcc, 1, v188
    v_mov_b32 v189, 133120
    v_mov_b32 v188, 1
    s_nop 0
    v_cndmask_b32 v187, v187, v189, vcc
    v_mov_b32 v189, 0
    v_cndmask_b32 v188, v188, v189, vcc
    v_mov_b32 v112, 0
    v_mov_b32 v113, 0
    v_mov_b32 v114, 0
    v_mov_b32 v115, 0
    v_mov_b32 v116, 0
    v_mov_b32 v117, 0
    v_mov_b32 v118, 0
    v_mov_b32 v119, 0
    v_mov_b32 v120, 0
    v_mov_b32 v121, 0
    v_mov_b32 v122, 0
    v_mov_b32 v123, 0
    v_mov_b32 v124, 0
    v_mov_b32 v125, 0
    v_mov_b32 v126, 0
    v_mov_b32 v127, 0
    v_mov_b32 v148, 0
    v_mov_b32 v149, 0
    v_mov_b32 v150, 0
    v_mov_b32 v151, 0
    v_mov_b32 v128, 0
    v_mov_b32 v129, 0
    v_mov_b32 v130, 0
    v_mov_b32 v131, 0
    v_mov_b32 v132, 0
    v_mov_b32 v133, 0
    v_mov_b32 v134, 0
    v_mov_b32 v135, 0
    v_mov_b32 v136, 0
    v_mov_b32 v137, 0
    v_mov_b32 v138, 0
    v_mov_b32 v139, 0
    v_mov_b32 v140, 0
    v_mov_b32 v141, 0
    v_mov_b32 v142, 0
    v_mov_b32 v143, 0
    v_mov_b32 v156, 0
    v_mov_b32 v157, 0
    v_mov_b32 v158, 0
    v_mov_b32 v159, 0
    v_mov_b32 v180, 0x3f803f80
    v_mov_b32 v181, 0x3f803f80
    v_mov_b32 v182, 0x3f803f80
    v_mov_b32 v183, 0x3f803f80
L_p2pre2_42:
    s_lshr_b32 s46, s42, 2
    s_lshl_b32 s46, s46, 8
    s_add_u32 s46, s46, 0
    s_cmp_lg_u32 s3, 0
    s_cbranch_scc1 L_wait_43
    v_lshlrev_b32 v254, 8, v1
    v_add_u32 v254, s46, v254
    s_mov_b64 exec, 1
    s_mov_b32 s60, 0x200000
L_poll_44:
    global_load_dword v255, v254, s[40:41] sc1
    s_sub_u32 s60, s60, 1
    s_cbranch_scc1 L_poll_44_out
    s_waitcnt vmcnt(0)
    v_cmp_gt_u32 vcc, 32, v255
    s_cbranch_vccnz L_poll_44
L_poll_44_out:
    s_waitcnt vmcnt(0)
    s_mov_b64 exec, -1
L_wait_43:
    s_barrier
    s_cmp_ge_u32 s3, 4
    s_cbranch_scc1 L_p2load_39
    global_load_dwordx4 v[4:7], v14, s[40:41] sc1
    global_load_dwordx4 v[8:11], v14, s[40:41] offset:1024 sc1
    v_lshlrev_b32 v12, 4, v1
    s_waitcnt vmcnt(0)
    s_barrier
    v_mov_b32 v13, v187
    ds_read_b128 v[160:163], v12
    ds_read_b128 v[164:167], v12 offset:2048
    ds_read_b128 v[168:171], v13
    ds_read_b128 v[172:175], v13 offset:512
    s_waitcnt lgkmcnt(3)
    v_mfma_f32_32x32x16_bf16 v[48:63], v[160:163], v[4:7], 0
    v_mfma_f32_32x32x16_bf16 v[80:95], v[160:163], v[8:11], 0
    s_nop 15
    v_max3_f32 v14, v48, v49, v50
    v_max3_f32 v14, v51, v52, v14
    v_max3_f32 v14, v53, v54, v14
    v_max3_f32 v14, v55, v56, v14
    v_max3_f32 v14, v57, v58, v14
    v_max3_f32 v14, v59, v60, v14
    v_max3_f32 v14, v61, v62, v14
    v_max_f32 v14, v63, v14
    v_mov_b32 v15, v14
    s_nop 1
    v_permlane32_swap_b32 v14, v15
    s_nop 1
    v_max_f32 v14, v14, v15
    v_sub_f32 v14, 0, v14
    v_mov_b32 v16, v14
    v_mov_b32 v17, v14
    v_mov_b32 v18, v14
    v_mov_b32 v19, v14
    v_mov_b32 v20, v14
    v_mov_b32 v21, v14
    v_mov_b32 v22, v14
    v_mov_b32 v23, v14
    v_mov_b32 v24, v14
    v_mov_b32 v25, v14
    v_mov_b32 v26, v14
    v_mov_b32 v27, v14
    v_mov_b32 v28, v14
    v_mov_b32 v29, v14
    v_mov_b32 v30, v14
    v_mov_b32 v31, v14
    v_max3_f32 v14, v80, v81, v82
    v_max3_f32 v14, v83, v84, v14
    v_max3_f32 v14, v85, v86, v14
    v_max3_f32 v14, v87, v88, v14
    v_max3_f32 v14, v89, v90, v14
    v_max3_f32 v14, v91, v92, v14
    v_max3_f32 v14, v93, v94, v14
    v_max_f32 v14, v95, v14
    v_mov_b32 v15, v14
    s_nop 1
    v_permlane32_swap_b32 v14, v15
    s_nop 1
    v_max_f32 v14, v14, v15
    v_sub_f32 v14, 0, v14
    v_mov_b32 v32, v14
    v_mov_b32 v33, v14
    v_mov_b32 v34, v14
    v_mov_b32 v35, v14
    v_mov_b32 v36, v14
    v_mov_b32 v37, v14
    v_mov_b32 v38, v14
    v_mov_b32 v39, v14
    v_mov_b32 v40, v14
    v_mov_b32 v41, v14
    v_mov_b32 v42, v14
    v_mov_b32 v43, v14
    v_mov_b32 v44, v14
    v_mov_b32 v45, v14
    v_mov_b32 v46, v14
    v_mov_b32 v47, v14
    s_mov_b32 s50, 16384
    s_waitcnt lgkmcnt(0)
    v_mfma_f32_32x32x16_bf16 v[48:63], v[160:163], v[4:7], v[16:31]
    v_mfma_f32_32x32x16_bf16 v[80:95], v[160:163], v[8:11], v[32:47]
    s_nop 13
.p2align 3
    v_exp_f32 v48, v48
    v_exp_f32 v49, v49
    v_mfma_f32_32x32x16_bf16 v[112:127], v[180:183], v[148:151], v[112:127]
    v_exp_f32 v50, v50
    v_exp_f32 v51, v51
    v_exp_f32 v52, v52
    s_waitcnt lgkmcnt(0)
    v_mfma_f32_32x32x16_bf16 v[64:79], v[164:167], v[4:7], v[16:31]
    v_exp_f32 v53, v53
    v_exp_f32 v54, v54
    v_exp_f32 v55, v55
    v_exp_f32 v56, v56
    v_cvt_pk_bf16_f32 v144, v48, v49
    v_cvt_pk_bf16_f32 v145, v50, v51
    v_cvt_pk_bf16_f32 v146, v52, v53
    v_cvt_pk_bf16_f32 v147, v54, v55
    v_exp_f32 v57, v57
    v_exp_f32 v58, v58
    v_mfma_f32_32x32x16_bf16 v[112:127], v[168:171], v[144:147], v[112:127]
    v_exp_f32 v59, v59
    v_exp_f32 v60, v60
    v_exp_f32 v61, v61
    v_exp_f32 v62, v62
    v_exp_f32_e64 v63, v63
    v_cvt_pk_bf16_f32 v148, v56, v57
    v_cvt_pk_bf16_f32 v149, v58, v59
    v_cvt_pk_bf16_f32 v150, v60, v61
    v_cvt_pk_bf16_f32 v151, v62, v63
    v_exp_f32 v80, v80
    v_exp_f32 v81, v81
    v_mfma_f32_32x32x16_bf16 v[128:143], v[180:183], v[156:159], v[128:143]
    ds_read_b128 v[176:179], v13 offset:2048
    v_exp_f32 v82, v82
    v_exp_f32 v83, v83
    ds_read_b128 v[180:183], v13 offset:2560
    v_exp_f32 v84, v84
    v_exp_f32 v85, v85
    ds_read_b128 v[160:163], v12 offset:4096
    v_mfma_f32_32x32x16_bf16 v[96:111], v[164:167], v[8:11], v[32:47]
    v_exp_f32 v86, v86
    v_exp_f32 v87, v87
    v_exp_f32_e64 v88, v88
    v_cvt_pk_bf16_f32 v152, v80, v81
    v_cvt_pk_bf16_f32 v153, v82, v83
    v_cvt_pk_bf16_f32 v154, v84, v85
    v_cvt_pk_bf16_f32 v155, v86, v87
    v_exp_f32 v89, v89
    v_exp_f32 v90, v90
    v_mfma_f32_32x32x16_bf16 v[128:143], v[168:171], v[152:155], v[128:143]
    v_exp_f32 v91, v91
    v_exp_f32 v92, v92
    v_exp_f32 v93, v93
    v_exp_f32 v94, v94
    v_exp_f32_e64 v95, v95
    v_cvt_pk_bf16_f32 v156, v88, v89
    v_cvt_pk_bf16_f32 v157, v90, v91
    v_cvt_pk_bf16_f32 v158, v92, v93
    v_cvt_pk_bf16_f32 v159, v94, v95
    v_exp_f32 v64, v64
    v_exp_f32 v65, v65
    v_mfma_f32_32x32x16_bf16 v[112:127], v[172:175], v[148:151], v[112:127]
    v_exp_f32 v66, v66
    v_exp_f32 v67, v67
    v_exp_f32 v68, v68
    s_waitcnt lgkmcnt(0)
    v_mfma_f32_32x32x16_bf16 v[48:63], v[160:163], v[4:7], v[16:31]
    v_exp_f32 v69, v69
    v_exp_f32 v70, v70
    v_exp_f32 v71, v71
    v_exp_f32 v72, v72
    v_cvt_pk_bf16_f32 v144, v64, v65
    v_cvt_pk_bf16_f32 v145, v66, v67
    v_cvt_pk_bf16_f32 v146, v68, v69
    v_cvt_pk_bf16_f32 v147, v70, v71
    v_exp_f32 v73, v73
    v_exp_f32 v74, v74
    v_mfma_f32_32x32x16_bf16 v[112:127], v[176:179], v[144:147], v[112:127]
    v_exp_f32 v75, v75
    v_exp_f32 v76, v76
    v_exp_f32 v77, v77
    v_exp_f32 v78, v78
    v_exp_f32_e64 v79, v79
    v_cvt_pk_bf16_f32 v148, v72, v73
    v_cvt_pk_bf16_f32 v149, v74, v75
    v_cvt_pk_bf16_f32 v150, v76, v77
    v_cvt_pk_bf16_f32 v151, v78, v79
    v_exp_f32 v96, v96
    v_exp_f32 v97, v97
    v_mfma_f32_32x32x16_bf16 v[128:143], v[172:175], v[156:159], v[128:143]
    ds_read_b128 v[168:171], v13 offset:4096
    v_exp_f32 v98, v98
    v_exp_f32 v99, v99
    ds_read_b128 v[172:175], v13 offset:4608
    v_exp_f32 v100, v100
    v_exp_f32 v101, v101
    ds_read_b128 v[164:167], v12 offset:6144
    v_mfma_f32_32x32x16_bf16 v[80:95], v[160:163], v[8:11], v[32:47]
    v_exp_f32 v102, v102
    v_exp_f32 v103, v103
    v_exp_f32_e64 v104, v104
    v_cvt_pk_bf16_f32 v152, v96, v97
    v_cvt_pk_bf16_f32 v153, v98, v99
    v_cvt_pk_bf16_f32 v154, v100, v101
    v_cvt_pk_bf16_f32 v155, v102, v103
    v_exp_f32 v105, v105
    v_exp_f32 v106, v106
    v_mfma_f32_32x32x16_bf16 v[128:143], v[176:179], v[152:155], v[128:143]
    v_exp_f32 v107, v107
    v_exp_f32 v108, v108
    v_exp_f32 v109, v109
    v_exp_f32 v110, v110
    v_exp_f32_e64 v111, v111
    v_cvt_pk_bf16_f32 v156, v104, v105
    v_cvt_pk_bf16_f32 v157, v106, v107
    v_cvt_pk_bf16_f32 v158, v108, v109
    v_cvt_pk_bf16_f32 v159, v110, v111
    v_exp_f32 v48, v48
    v_exp_f32 v49, v49
    v_mfma_f32_32x32x16_bf16 v[112:127], v[180:183], v[148:151], v[112:127]
    v_exp_f32 v50, v50
    v_exp_f32 v51, v51
    v_exp_f32 v52, v52
    s_waitcnt lgkmcnt(0)
    v_mfma_f32_32x32x16_bf16 v[64:79], v[164:167], v[4:7], v[16:31]
    v_exp_f32 v53, v53
    v_exp_f32 v54, v54
    v_exp_f32 v55, v55
    v_exp_f32 v56, v56
    v_cvt_pk_bf16_f32 v144, v48, v49
    v_cvt_pk_bf16_f32 v145, v50, v51
    v_cvt_pk_bf16_f32 v146, v52, v53
    v_cvt_pk_bf16_f32 v147, v54, v55
    v_exp_f32 v57, v57
    v_exp_f32 v58, v58
    v_mfma_f32_32x32x16_bf16 v[112:127], v[168:171], v[144:147], v[112:127]
    v_exp_f32 v59, v59
    v_exp_f32 v60, v60
    v_exp_f32 v61, v61
    v_exp_f32 v62, v62
    v_exp_f32_e64 v63, v63
    v_cvt_pk_bf16_f32 v148, v56, v57
    v_cvt_pk_bf16_f32 v149, v58, v59
    v_cvt_pk_bf16_f32 v150, v60, v61
    v_cvt_pk_bf16_f32 v151, v62, v63
    v_exp_f32 v80, v80
    v_exp_f32 v81, v81
    v_mfma_f32_32x32x16_bf16 v[128:143], v[180:183], v[156:159], v[128:143]
    ds_read_b128 v[176:179], v13 offset:6144
    v_exp_f32 v82, v82
    v_exp_f32 v83, v83
    ds_read_b128 v[180:183], v13 offset:6656
    v_exp_f32 v84, v84
    v_exp_f32 v85, v85
    ds_read_b128 v[160:163], v12 offset:8192
    v_mfma_f32_32x32x16_bf16 v[96:111], v[164:167], v[8:11], v[32:47]
    v_exp_f32 v86, v86
    v_exp_f32 v87, v87
    v_exp_f32_e64 v88, v88
    v_cvt_pk_bf16_f32 v152, v80, v81
    v_cvt_pk_bf16_f32 v153, v82, v83
    v_cvt_pk_bf16_f32 v154, v84, v85
    v_cvt_pk_bf16_f32 v155, v86, v87
    v_exp_f32 v89, v89
    v_exp_f32 v90, v90
    v_mfma_f32_32x32x16_bf16 v[128:143], v[168:171], v[152:155], v[128:143]
    v_exp_f32 v91, v91
    v_exp_f32 v92, v92
    v_exp_f32 v93, v93
    v_exp_f32 v94, v94
    v_exp_f32_e64 v95, v95
    v_cvt_pk_bf16_f32 v156, v88, v89
    v_cvt_pk_bf16_f32 v157, v90, v91
    v_cvt_pk_bf16_f32 v158, v92, v93
    v_cvt_pk_bf16_f32 v159, v94, v95
    v_exp_f32 v64, v64
    v_exp_f32 v65, v65
    v_mfma_f32_32x32x16_bf16 v[112:127], v[172:175], v[148:151], v[112:127]
    v_exp_f32 v66, v66
    v_exp_f32 v67, v67
    v_exp_f32 v68, v68
    s_waitcnt lgkmcnt(0)
    v_mfma_f32_32x32x16_bf16 v[48:63], v[160:163], v[4:7], v[16:31]
    v_exp_f32 v69, v69
    v_exp_f32 v70, v70
    v_exp_f32 v71, v71
    v_exp_f32 v72, v72
    v_cvt_pk_bf16_f32 v144, v64, v65
    v_cvt_pk_bf16_f32 v145, v66, v67
    v_cvt_pk_bf16_f32 v146, v68, v69
    v_cvt_pk_bf16_f32 v147, v70, v71
    v_exp_f32 v73, v73
    v_exp_f32 v74, v74
    v_mfma_f32_32x32x16_bf16 v[112:127], v[176:179], v[144:147], v[112:127]
    v_exp_f32 v75, v75
    v_exp_f32 v76, v76
    v_exp_f32 v77, v77
    v_exp_f32 v78, v78
    v_exp_f32_e64 v79, v79
    v_cvt_pk_bf16_f32 v148, v72, v73
    v_cvt_pk_bf16_f32 v149, v74, v75
    v_cvt_pk_bf16_f32 v150, v76, v77
    v_cvt_pk_bf16_f32 v151, v78, v79
    v_exp_f32 v96, v96
    v_exp_f32 v97, v97
    v_mfma_f32_32x32x16_bf16 v[128:143], v[172:175], v[156:159], v[128:143]
    ds_read_b128 v[168:171], v13 offset:8192
    v_exp_f32 v98, v98
    v_exp_f32 v99, v99
    ds_read_b128 v[172:175], v13 offset:8704
    v_exp_f32 v100, v100
    v_exp_f32 v101, v101
    ds_read_b128 v[164:167], v12 offset:10240
    v_mfma_f32_32x32x16_bf16 v[80:95], v[160:163], v[8:11], v[32:47]
    v_exp_f32 v102, v102
    v_exp_f32 v103, v103
    v_exp_f32_e64 v104, v104
    v_cvt_pk_bf16_f32 v152, v96, v97
    v_cvt_pk_bf16_f32 v153, v98, v99
    v_cvt_pk_bf16_f32 v154, v100, v101
    v_cvt_pk_bf16_f32 v155, v102, v103
    v_exp_f32 v105, v105
    v_exp_f32 v106, v106
    v_mfma_f32_32x32x16_bf16 v[128:143], v[176:179], v[152:155], v[128:143]
    v_exp_f32 v107, v107
    v_exp_f32 v108, v108
    v_exp_f32 v109, v109
    v_exp_f32 v110, v110
    v_exp_f32_e64 v111, v111
    v_cvt_pk_bf16_f32 v156, v104, v105
    v_cvt_pk_bf16_f32 v157, v106, v107
    v_cvt_pk_bf16_f32 v158, v108, v109
    v_cvt_pk_bf16_f32 v159, v110, v111
    v_exp_f32 v48, v48
    v_exp_f32 v49, v49
    v_mfma_f32_32x32x16_bf16 v[112:127], v[180:183], v[148:151], v[112:127]
    v_exp_f32 v50, v50
    v_exp_f32 v51, v51
    v_exp_f32 v52, v52
    s_waitcnt lgkmcnt(0)
    v_mfma_f32_32x32x16_bf16 v[64:79], v[164:167], v[4:7], v[16:31]
    v_exp_f32 v53, v53
    v_exp_f32 v54, v54
    v_exp_f32 v55, v55
    v_exp_f32 v56, v56
    v_cvt_pk_bf16_f32 v144, v48, v49
    v_cvt_pk_bf16_f32 v145, v50, v51
    v_cvt_pk_bf16_f32 v146, v52, v53
    v_cvt_pk_bf16_f32 v147, v54, v55
    v_exp_f32 v57, v57
    v_exp_f32 v58, v58
    v_mfma_f32_32x32x16_bf16 v[112:127], v[168:171], v[144:147], v[112:127]
    v_exp_f32 v59, v59
    v_exp_f32 v60, v60
    v_exp_f32 v61, v61
    v_exp_f32 v62, v62
    v_exp_f32_e64 v63, v63
    v_cvt_pk_bf16_f32 v148, v56, v57
    v_cvt_pk_bf16_f32 v149, v58, v59
    v_cvt_pk_bf16_f32 v150, v60, v61
    v_cvt_pk_bf16_f32 v151, v62, v63
    v_exp_f32 v80, v80
    v_exp_f32 v81, v81
    v_mfma_f32_32x32x16_bf16 v[128:143], v[180:183], v[156:159], v[128:143]
    ds_read_b128 v[176:179], v13 offset:10240
    v_exp_f32 v82, v82
    v_exp_f32 v83, v83
    ds_read_b128 v[180:183], v13 offset:10752
    v_exp_f32 v84, v84
    v_exp_f32 v85, v85
    ds_read_b128 v[160:163], v12 offset:12288
    v_mfma_f32_32x32x16_bf16 v[96:111], v[164:167], v[8:11], v[32:47]
    v_exp_f32 v86, v86
    v_exp_f32 v87, v87
    v_exp_f32_e64 v88, v88
    v_cvt_pk_bf16_f32 v152, v80, v81
    v_cvt_pk_bf16_f32 v153, v82, v83
    v_cvt_pk_bf16_f32 v154, v84, v85
    v_cvt_pk_bf16_f32 v155, v86, v87
    v_exp_f32 v89, v89
    v_exp_f32 v90, v90
    v_mfma_f32_32x32x16_bf16 v[128:143], v[168:171], v[152:155], v[128:143]
    v_exp_f32 v91, v91
    v_exp_f32 v92, v92
    v_exp_f32 v93, v93
    v_exp_f32 v94, v94
    v_exp_f32_e64 v95, v95
    v_cvt_pk_bf16_f32 v156, v88, v89
    v_cvt_pk_bf16_f32 v157, v90, v91
    v_cvt_pk_bf16_f32 v158, v92, v93
    v_cvt_pk_bf16_f32 v159, v94, v95
    v_exp_f32 v64, v64
    v_exp_f32 v65, v65
    v_mfma_f32_32x32x16_bf16 v[112:127], v[172:175], v[148:151], v[112:127]
    v_exp_f32 v66, v66
    v_exp_f32 v67, v67
    v_exp_f32 v68, v68
    s_waitcnt lgkmcnt(0)
    v_mfma_f32_32x32x16_bf16 v[48:63], v[160:163], v[4:7], v[16:31]
    v_exp_f32 v69, v69
    v_exp_f32 v70, v70
    v_exp_f32 v71, v71
    v_exp_f32 v72, v72
    v_cvt_pk_bf16_f32 v144, v64, v65
    v_cvt_pk_bf16_f32 v145, v66, v67
    v_cvt_pk_bf16_f32 v146, v68, v69
    v_cvt_pk_bf16_f32 v147, v70, v71
    v_exp_f32 v73, v73
    v_exp_f32 v74, v74
    v_mfma_f32_32x32x16_bf16 v[112:127], v[176:179], v[144:147], v[112:127]
    v_exp_f32 v75, v75
    v_exp_f32 v76, v76
    v_exp_f32 v77, v77
    v_exp_f32 v78, v78
    v_exp_f32_e64 v79, v79
    v_cvt_pk_bf16_f32 v148, v72, v73
    v_cvt_pk_bf16_f32 v149, v74, v75
    v_cvt_pk_bf16_f32 v150, v76, v77
    v_cvt_pk_bf16_f32 v151, v78, v79
    v_exp_f32 v96, v96
    v_exp_f32 v97, v97
    v_mfma_f32_32x32x16_bf16 v[128:143], v[172:175], v[156:159], v[128:143]
    ds_read_b128 v[168:171], v13 offset:12288
    v_exp_f32 v98, v98
    v_exp_f32 v99, v99
    ds_read_b128 v[172:175], v13 offset:12800
    v_exp_f32 v100, v100
    v_exp_f32 v101, v101
    ds_read_b128 v[164:167], v12 offset:14336
    v_mfma_f32_32x32x16_bf16 v[80:95], v[160:163], v[8:11], v[32:47]
    v_exp_f32 v102, v102
    v_exp_f32 v103, v103
    v_exp_f32_e64 v104, v104
    v_cvt_pk_bf16_f32 v152, v96, v97
    v_cvt_pk_bf16_f32 v153, v98, v99
    v_cvt_pk_bf16_f32 v154, v100, v101
    v_cvt_pk_bf16_f32 v155, v102, v103
    v_exp_f32 v105, v105
    v_exp_f32 v106, v106
    v_mfma_f32_32x32x16_bf16 v[128:143], v[176:179], v[152:155], v[128:143]
    v_exp_f32 v107, v107
    v_exp_f32 v108, v108
    v_exp_f32 v109, v109
    v_exp_f32 v110, v110
    v_exp_f32_e64 v111, v111
    v_cvt_pk_bf16_f32 v156, v104, v105
    v_cvt_pk_bf16_f32 v157, v106, v107
    v_cvt_pk_bf16_f32 v158, v108, v109
    v_cvt_pk_bf16_f32 v159, v110, v111
    v_exp_f32 v48, v48
    v_exp_f32 v49, v49
    v_mfma_f32_32x32x16_bf16 v[112:127], v[180:183], v[148:151], v[112:127]
    v_exp_f32 v50, v50
    v_exp_f32 v51, v51
    v_exp_f32 v52, v52
    s_waitcnt lgkmcnt(0)
    v_mfma_f32_32x32x16_bf16 v[64:79], v[164:167], v[4:7], v[16:31]
    v_exp_f32 v53, v53
    v_exp_f32 v54, v54
    v_exp_f32 v55, v55
    v_exp_f32 v56, v56
    v_cvt_pk_bf16_f32 v144, v48, v49
    v_cvt_pk_bf16_f32 v145, v50, v51
    v_cvt_pk_bf16_f32 v146, v52, v53
    v_cvt_pk_bf16_f32 v147, v54, v55
    v_exp_f32 v57, v57
    v_exp_f32 v58, v58
    v_mfma_f32_32x32x16_bf16 v[112:127], v[168:171], v[144:147], v[112:127]
    v_exp_f32 v59, v59
    v_exp_f32 v60, v60
    v_exp_f32 v61, v61
    v_exp_f32 v62, v62
    v_exp_f32_e64 v63, v63
    v_cvt_pk_bf16_f32 v148, v56, v57
    v_cvt_pk_bf16_f32 v149, v58, v59
    v_cvt_pk_bf16_f32 v150, v60, v61
    v_cvt_pk_bf16_f32 v151, v62, v63
    v_exp_f32 v80, v80
    v_exp_f32 v81, v81
    v_mfma_f32_32x32x16_bf16 v[128:143], v[180:183], v[156:159], v[128:143]
    ds_read_b128 v[176:179], v13 offset:14336
    v_exp_f32 v82, v82
    v_exp_f32 v83, v83
    ds_read_b128 v[180:183], v13 offset:14848
    v_exp_f32 v84, v84
    v_exp_f32 v85, v85
    ds_read_b128 v[160:163], v12 offset:16384
    v_mfma_f32_32x32x16_bf16 v[96:111], v[164:167], v[8:11], v[32:47]
    v_exp_f32 v86, v86
    v_exp_f32 v87, v87
    v_exp_f32_e64 v88, v88
    v_cvt_pk_bf16_f32 v152, v80, v81
    v_cvt_pk_bf16_f32 v153, v82, v83
    v_cvt_pk_bf16_f32 v154, v84, v85
    v_cvt_pk_bf16_f32 v155, v86, v87
    v_exp_f32 v89, v89
    v_exp_f32 v90, v90
    v_mfma_f32_32x32x16_bf16 v[128:143], v[168:171], v[152:155], v[128:143]
    v_exp_f32 v91, v91
    v_exp_f32 v92, v92
    v_exp_f32 v93, v93
    v_exp_f32 v94, v94
    v_exp_f32_e64 v95, v95
    v_cvt_pk_bf16_f32 v156, v88, v89
    v_cvt_pk_bf16_f32 v157, v90, v91
    v_cvt_pk_bf16_f32 v158, v92, v93
    v_cvt_pk_bf16_f32 v159, v94, v95
    v_exp_f32 v64, v64
    v_exp_f32 v65, v65
    v_mfma_f32_32x32x16_bf16 v[112:127], v[172:175], v[148:151], v[112:127]
    v_exp_f32 v66, v66
    v_exp_f32 v67, v67
    v_exp_f32 v68, v68
    s_waitcnt lgkmcnt(0)
    v_mfma_f32_32x32x16_bf16 v[48:63], v[160:163], v[4:7], v[16:31]
    v_exp_f32 v69, v69
    v_exp_f32 v70, v70
    v_exp_f32 v71, v71
    v_exp_f32 v72, v72
    v_cvt_pk_bf16_f32 v144, v64, v65
    v_cvt_pk_bf16_f32 v145, v66, v67
    v_cvt_pk_bf16_f32 v146, v68, v69
    v_cvt_pk_bf16_f32 v147, v70, v71
    v_exp_f32 v73, v73
    v_exp_f32 v74, v74
    v_mfma_f32_32x32x16_bf16 v[112:127], v[176:179], v[144:147], v[112:127]
    v_exp_f32 v75, v75
    v_exp_f32 v76, v76
    v_exp_f32 v77, v77
    v_exp_f32 v78, v78
    v_exp_f32_e64 v79, v79
    v_cvt_pk_bf16_f32 v148, v72, v73
    v_cvt_pk_bf16_f32 v149, v74, v75
    v_cvt_pk_bf16_f32 v150, v76, v77
    v_cvt_pk_bf16_f32 v151, v78, v79
    v_exp_f32 v96, v96
    v_exp_f32 v97, v97
    v_mfma_f32_32x32x16_bf16 v[128:143], v[172:175], v[156:159], v[128:143]
    ds_read_b128 v[168:171], v13 offset:16384
    v_exp_f32 v98, v98
    v_exp_f32 v99, v99
    ds_read_b128 v[172:175], v13 offset:16896
    v_exp_f32 v100, v100
    v_exp_f32 v101, v101
    ds_read_b128 v[164:167], v12 offset:18432
    v_mfma_f32_32x32x16_bf16 v[80:95], v[160:163], v[8:11], v[32:47]
    v_exp_f32 v102, v102
    v_exp_f32 v103, v103
    v_exp_f32_e64 v104, v104
    v_cvt_pk_bf16_f32 v152, v96, v97
    v_cvt_pk_bf16_f32 v153, v98, v99
    v_cvt_pk_bf16_f32 v154, v100, v101
    v_cvt_pk_bf16_f32 v155, v102, v103
    v_exp_f32 v105, v105
    v_exp_f32 v106, v106
    v_mfma_f32_32x32x16_bf16 v[128:143], v[176:179], v[152:155], v[128:143]
    v_exp_f32 v107, v107
    v_exp_f32 v108, v108
    v_exp_f32 v109, v109
    v_exp_f32 v110, v110
    v_exp_f32_e64 v111, v111
    v_cvt_pk_bf16_f32 v156, v104, v105
    v_cvt_pk_bf16_f32 v157, v106, v107
    v_cvt_pk_bf16_f32 v158, v108, v109
    v_cvt_pk_bf16_f32 v159, v110, v111
    v_add_u32 v12, 16384, v12
    v_mad_u32_u24 v13, v188, s50, v13
    s_barrier
    s_mov_b32 s44, 1
.p2align 6
L_att_main_45:
    v_exp_f32 v48, v48
    v_exp_f32 v49, v49
    v_mfma_f32_32x32x16_bf16 v[112:127], v[180:183], v[148:151], v[112:127]
    v_exp_f32 v50, v50
    v_exp_f32 v51, v51
    v_exp_f32 v52, v52
    s_waitcnt lgkmcnt(0)
    v_mfma_f32_32x32x16_bf16 v[64:79], v[164:167], v[4:7], v[16:31]
    v_exp_f32 v53, v53
    v_exp_f32 v54, v54
    v_exp_f32 v55, v55
    v_exp_f32 v56, v56
    v_cvt_pk_bf16_f32 v144, v48, v49
    v_cvt_pk_bf16_f32 v145, v50, v51
    v_cvt_pk_bf16_f32 v146, v52, v53
    v_cvt_pk_bf16_f32 v147, v54, v55
    v_exp_f32 v57, v57
    v_exp_f32 v58, v58
    v_mfma_f32_32x32x16_bf16 v[112:127], v[168:171], v[144:147], v[112:127]
    v_exp_f32 v59, v59
    v_exp_f32 v60, v60
    v_exp_f32 v61, v61
    v_exp_f32 v62, v62
    v_exp_f32_e64 v63, v63
    v_cvt_pk_bf16_f32 v148, v56, v57
    v_cvt_pk_bf16_f32 v149, v58, v59
    v_cvt_pk_bf16_f32 v150, v60, v61
    v_cvt_pk_bf16_f32 v151, v62, v63
    v_exp_f32 v80, v80
    v_exp_f32 v81, v81
    v_mfma_f32_32x32x16_bf16 v[128:143], v[180:183], v[156:159], v[128:143]
    ds_read_b128 v[176:179], v13 offset:2048
    v_exp_f32 v82, v82
    v_exp_f32 v83, v83
    ds_read_b128 v[180:183], v13 offset:2560
    v_exp_f32 v84, v84
    v_exp_f32 v85, v85
    ds_read_b128 v[160:163], v12 offset:4096
    v_mfma_f32_32x32x16_bf16 v[96:111], v[164:167], v[8:11], v[32:47]
    v_exp_f32 v86, v86
    v_exp_f32 v87, v87
    v_exp_f32_e64 v88, v88
    v_cvt_pk_bf16_f32 v152, v80, v81
    v_cvt_pk_bf16_f32 v153, v82, v83
    v_cvt_pk_bf16_f32 v154, v84, v85
    v_cvt_pk_bf16_f32 v155, v86, v87
    v_exp_f32 v89, v89
    v_exp_f32 v90, v90
    v_mfma_f32_32x32x16_bf16 v[128:143], v[168:171], v[152:155], v[128:143]
    v_exp_f32 v91, v91
    v_exp_f32 v92, v92
    v_exp_f32 v93, v93
    v_exp_f32 v94, v94
    v_exp_f32_e64 v95, v95
    v_cvt_pk_bf16_f32 v156, v88, v89
    v_cvt_pk_bf16_f32 v157, v90, v91
    v_cvt_pk_bf16_f32 v158, v92, v93
    v_cvt_pk_bf16_f32 v159, v94, v95
    v_exp_f32 v64, v64
    v_exp_f32 v65, v65
    v_mfma_f32_32x32x16_bf16 v[112:127], v[172:175], v[148:151], v[112:127]
    v_exp_f32 v66, v66
    v_exp_f32 v67, v67
    v_exp_f32 v68, v68
    s_waitcnt lgkmcnt(0)
    v_mfma_f32_32x32x16_bf16 v[48:63], v[160:163], v[4:7], v[16:31]
    v_exp_f32 v69, v69
    v_exp_f32 v70, v70
    v_exp_f32 v71, v71
    v_exp_f32 v72, v72
    v_cvt_pk_bf16_f32 v144, v64, v65
    v_cvt_pk_bf16_f32 v145, v66, v67
    v_cvt_pk_bf16_f32 v146, v68, v69
    v_cvt_pk_bf16_f32 v147, v70, v71
    v_exp_f32 v73, v73
    v_exp_f32 v74, v74
    v_mfma_f32_32x32x16_bf16 v[112:127], v[176:179], v[144:147], v[112:127]
    v_exp_f32 v75, v75
    v_exp_f32 v76, v76
    v_exp_f32 v77, v77
    v_exp_f32 v78, v78
    v_exp_f32_e64 v79, v79
    v_cvt_pk_bf16_f32 v148, v72, v73
    v_cvt_pk_bf16_f32 v149, v74, v75
    v_cvt_pk_bf16_f32 v150, v76, v77
    v_cvt_pk_bf16_f32 v151, v78, v79
    v_exp_f32 v96, v96
    v_exp_f32 v97, v97
    v_mfma_f32_32x32x16_bf16 v[128:143], v[172:175], v[156:159], v[128:143]
    ds_read_b128 v[168:171], v13 offset:4096
    v_exp_f32 v98, v98
    v_exp_f32 v99, v99
    ds_read_b128 v[172:175], v13 offset:4608
    v_exp_f32 v100, v100
    v_exp_f32 v101, v101
    ds_read_b128 v[164:167], v12 offset:6144
    v_mfma_f32_32x32x16_bf16 v[80:95], v[160:163], v[8:11], v[32:47]
    v_exp_f32 v102, v102
    v_exp_f32 v103, v103
    v_exp_f32_e64 v104, v104
    v_cvt_pk_bf16_f32 v152, v96, v97
    v_cvt_pk_bf16_f32 v153, v98, v99
    v_cvt_pk_bf16_f32 v154, v100, v101
    v_cvt_pk_bf16_f32 v155, v102, v103
    v_exp_f32 v105, v105
    v_exp_f32 v106, v106
    v_mfma_f32_32x32x16_bf16 v[128:143], v[176:179], v[152:155], v[128:143]
    v_exp_f32 v107, v107
    v_exp_f32 v108, v108
    v_exp_f32 v109, v109
    v_exp_f32 v110, v110
    v_exp_f32_e64 v111, v111
    v_cvt_pk_bf16_f32 v156, v104, v105
    v_cvt_pk_bf16_f32 v157, v106, v107
    v_cvt_pk_bf16_f32 v158, v108, v109
    v_cvt_pk_bf16_f32 v159, v110, v111
    v_exp_f32 v48, v48
    v_exp_f32 v49, v49
    v_mfma_f32_32x32x16_bf16 v[112:127], v[180:183], v[148:151], v[112:127]
    v_exp_f32 v50, v50
    v_exp_f32 v51, v51
    v_exp_f32 v52, v52
    s_waitcnt lgkmcnt(0)
    v_mfma_f32_32x32x16_bf16 v[64:79], v[164:167], v[4:7], v[16:31]
    v_exp_f32 v53, v53
    v_exp_f32 v54, v54
    v_exp_f32 v55, v55
    v_exp_f32 v56, v56
    v_cvt_pk_bf16_f32 v144, v48, v49
    v_cvt_pk_bf16_f32 v145, v50, v51
    v_cvt_pk_bf16_f32 v146, v52, v53
    v_cvt_pk_bf16_f32 v147, v54, v55
    v_exp_f32 v57, v57
    v_exp_f32 v58, v58
    v_mfma_f32_32x32x16_bf16 v[112:127], v[168:171], v[144:147], v[112:127]
    v_exp_f32 v59, v59
    v_exp_f32 v60, v60
    v_exp_f32 v61, v61
    v_exp_f32 v62, v62
    v_exp_f32_e64 v63, v63
    v_cvt_pk_bf16_f32 v148, v56, v57
    v_cvt_pk_bf16_f32 v149, v58, v59
    v_cvt_pk_bf16_f32 v150, v60, v61
    v_cvt_pk_bf16_f32 v151, v62, v63
    v_exp_f32 v80, v80
    v_exp_f32 v81, v81
    v_mfma_f32_32x32x16_bf16 v[128:143], v[180:183], v[156:159], v[128:143]
    ds_read_b128 v[176:179], v13 offset:6144
    v_exp_f32 v82, v82
    v_exp_f32 v83, v83
    ds_read_b128 v[180:183], v13 offset:6656
    v_exp_f32 v84, v84
    v_exp_f32 v85, v85
    ds_read_b128 v[160:163], v12 offset:8192
    v_mfma_f32_32x32x16_bf16 v[96:111], v[164:167], v[8:11], v[32:47]
    v_exp_f32 v86, v86
    v_exp_f32 v87, v87
    v_exp_f32_e64 v88, v88
    v_cvt_pk_bf16_f32 v152, v80, v81
    v_cvt_pk_bf16_f32 v153, v82, v83
    v_cvt_pk_bf16_f32 v154, v84, v85
    v_cvt_pk_bf16_f32 v155, v86, v87
    v_exp_f32 v89, v89
    v_exp_f32 v90, v90
    v_mfma_f32_32x32x16_bf16 v[128:143], v[168:171], v[152:155], v[128:143]
    v_exp_f32 v91, v91
    v_exp_f32 v92, v92
    v_exp_f32 v93, v93
    v_exp_f32 v94, v94
    v_exp_f32_e64 v95, v95
    v_cvt_pk_bf16_f32 v156, v88, v89
    v_cvt_pk_bf16_f32 v157, v90, v91
    v_cvt_pk_bf16_f32 v158, v92, v93
    v_cvt_pk_bf16_f32 v159, v94, v95
    v_exp_f32 v64, v64
    v_exp_f32 v65, v65
    v_mfma_f32_32x32x16_bf16 v[112:127], v[172:175], v[148:151], v[112:127]
    v_exp_f32 v66, v66
    v_exp_f32 v67, v67
    v_exp_f32 v68, v68
    s_waitcnt lgkmcnt(0)
    v_mfma_f32_32x32x16_bf16 v[48:63], v[160:163], v[4:7], v[16:31]
    v_exp_f32 v69, v69
    v_exp_f32 v70, v70
    v_exp_f32 v71, v71
    v_exp_f32 v72, v72
    v_cvt_pk_bf16_f32 v144, v64, v65
    v_cvt_pk_bf16_f32 v145, v66, v67
    v_cvt_pk_bf16_f32 v146, v68, v69
    v_cvt_pk_bf16_f32 v147, v70, v71
    v_exp_f32 v73, v73
    v_exp_f32 v74, v74
    v_mfma_f32_32x32x16_bf16 v[112:127], v[176:179], v[144:147], v[112:127]
    v_exp_f32 v75, v75
    v_exp_f32 v76, v76
    v_exp_f32 v77, v77
    v_exp_f32 v78, v78
    v_exp_f32_e64 v79, v79
    v_cvt_pk_bf16_f32 v148, v72, v73
    v_cvt_pk_bf16_f32 v149, v74, v75
    v_cvt_pk_bf16_f32 v150, v76, v77
    v_cvt_pk_bf16_f32 v151, v78, v79
    v_exp_f32 v96, v96
    v_exp_f32 v97, v97
    v_mfma_f32_32x32x16_bf16 v[128:143], v[172:175], v[156:159], v[128:143]
    ds_read_b128 v[168:171], v13 offset:8192
    v_exp_f32 v98, v98
    v_exp_f32 v99, v99
    ds_read_b128 v[172:175], v13 offset:8704
    v_exp_f32 v100, v100
    v_exp_f32 v101, v101
    ds_read_b128 v[164:167], v12 offset:10240
    v_mfma_f32_32x32x16_bf16 v[80:95], v[160:163], v[8:11], v[32:47]
    v_exp_f32 v102, v102
    v_exp_f32 v103, v103
    v_exp_f32_e64 v104, v104
    v_cvt_pk_bf16_f32 v152, v96, v97
    v_cvt_pk_bf16_f32 v153, v98, v99
    v_cvt_pk_bf16_f32 v154, v100, v101
    v_cvt_pk_bf16_f32 v155, v102, v103
    v_exp_f32 v105, v105
    v_exp_f32 v106, v106
    v_mfma_f32_32x32x16_bf16 v[128:143], v[176:179], v[152:155], v[128:143]
    v_exp_f32 v107, v107
    v_exp_f32 v108, v108
    v_exp_f32 v109, v109
    v_exp_f32 v110, v110
    v_exp_f32_e64 v111, v111
    v_cvt_pk_bf16_f32 v156, v104, v105
    v_cvt_pk_bf16_f32 v157, v106, v107
    v_cvt_pk_bf16_f32 v158, v108, v109
    v_cvt_pk_bf16_f32 v159, v110, v111
    v_exp_f32 v48, v48
    v_exp_f32 v49, v49
    v_mfma_f32_32x32x16_bf16 v[112:127], v[180:183], v[148:151], v[112:127]
    v_exp_f32 v50, v50
    v_exp_f32 v51, v51
    v_exp_f32 v52, v52
    s_waitcnt lgkmcnt(0)
    v_mfma_f32_32x32x16_bf16 v[64:79], v[164:167], v[4:7], v[16:31]
    v_exp_f32 v53, v53
    v_exp_f32 v54, v54
    v_exp_f32 v55, v55
    v_exp_f32 v56, v56
    v_cvt_pk_bf16_f32 v144, v48, v49
    v_cvt_pk_bf16_f32 v145, v50, v51
    v_cvt_pk_bf16_f32 v146, v52, v53
    v_cvt_pk_bf16_f32 v147, v54, v55
    v_exp_f32 v57, v57
    v_exp_f32 v58, v58
    v_mfma_f32_32x32x16_bf16 v[112:127], v[168:171], v[144:147], v[112:127]
    v_exp_f32 v59, v59
    v_exp_f32 v60, v60
    v_exp_f32 v61, v61
    v_exp_f32 v62, v62
    v_exp_f32_e64 v63, v63
    v_cvt_pk_bf16_f32 v148, v56, v57
    v_cvt_pk_bf16_f32 v149, v58, v59
    v_cvt_pk_bf16_f32 v150, v60, v61
    v_cvt_pk_bf16_f32 v151, v62, v63
    v_exp_f32 v80, v80
    v_exp_f32 v81, v81
    v_mfma_f32_32x32x16_bf16 v[128:143], v[180:183], v[156:159], v[128:143]
    ds_read_b128 v[176:179], v13 offset:10240
    v_exp_f32 v82, v82
    v_exp_f32 v83, v83
    ds_read_b128 v[180:183], v13 offset:10752
    v_exp_f32 v84, v84
    v_exp_f32 v85, v85
    ds_read_b128 v[160:163], v12 offset:12288
    v_mfma_f32_32x32x16_bf16 v[96:111], v[164:167], v[8:11], v[32:47]
    v_exp_f32 v86, v86
    v_exp_f32 v87, v87
    v_exp_f32_e64 v88, v88
    v_cvt_pk_bf16_f32 v152, v80, v81
    v_cvt_pk_bf16_f32 v153, v82, v83
    v_cvt_pk_bf16_f32 v154, v84, v85
    v_cvt_pk_bf16_f32 v155, v86, v87
    v_exp_f32 v89, v89
    v_exp_f32 v90, v90
    v_mfma_f32_32x32x16_bf16 v[128:143], v[168:171], v[152:155], v[128:143]
    v_exp_f32 v91, v91
    v_exp_f32 v92, v92
    v_exp_f32 v93, v93
    v_exp_f32 v94, v94
    v_exp_f32_e64 v95, v95
    v_cvt_pk_bf16_f32 v156, v88, v89
    v_cvt_pk_bf16_f32 v157, v90, v91
    v_cvt_pk_bf16_f32 v158, v92, v93
    v_cvt_pk_bf16_f32 v159, v94, v95
    v_exp_f32 v64, v64
    v_exp_f32 v65, v65
    v_mfma_f32_32x32x16_bf16 v[112:127], v[172:175], v[148:151], v[112:127]
    v_exp_f32 v66, v66
    v_exp_f32 v67, v67
    v_exp_f32 v68, v68
    s_waitcnt lgkmcnt(0)
    v_mfma_f32_32x32x16_bf16 v[48:63], v[160:163], v[4:7], v[16:31]
    v_exp_f32 v69, v69
    v_exp_f32 v70, v70
    v_exp_f32 v71, v71
    v_exp_f32 v72, v72
    v_cvt_pk_bf16_f32 v144, v64, v65
    v_cvt_pk_bf16_f32 v145, v66, v67
    v_cvt_pk_bf16_f32 v146, v68, v69
    v_cvt_pk_bf16_f32 v147, v70, v71
    v_exp_f32 v73, v73
    v_exp_f32 v74, v74
    v_mfma_f32_32x32x16_bf16 v[112:127], v[176:179], v[144:147], v[112:127]
    v_exp_f32 v75, v75
    v_exp_f32 v76, v76
    v_exp_f32 v77, v77
    v_exp_f32 v78, v78
    v_exp_f32_e64 v79, v79
    v_cvt_pk_bf16_f32 v148, v72, v73
    v_cvt_pk_bf16_f32 v149, v74, v75
    v_cvt_pk_bf16_f32 v150, v76, v77
    v_cvt_pk_bf16_f32 v151, v78, v79
    v_exp_f32 v96, v96
    v_exp_f32 v97, v97
    v_mfma_f32_32x32x16_bf16 v[128:143], v[172:175], v[156:159], v[128:143]
    ds_read_b128 v[168:171], v13 offset:12288
    v_exp_f32 v98, v98
    v_exp_f32 v99, v99
    ds_read_b128 v[172:175], v13 offset:12800
    v_exp_f32 v100, v100
    v_exp_f32 v101, v101
    ds_read_b128 v[164:167], v12 offset:14336
    v_mfma_f32_32x32x16_bf16 v[80:95], v[160:163], v[8:11], v[32:47]
    v_exp_f32 v102, v102
    v_exp_f32 v103, v103
    v_exp_f32_e64 v104, v104
    v_cvt_pk_bf16_f32 v152, v96, v97
    v_cvt_pk_bf16_f32 v153, v98, v99
    v_cvt_pk_bf16_f32 v154, v100, v101
    v_cvt_pk_bf16_f32 v155, v102, v103
    v_exp_f32 v105, v105
    v_exp_f32 v106, v106
    v_mfma_f32_32x32x16_bf16 v[128:143], v[176:179], v[152:155], v[128:143]
    v_exp_f32 v107, v107
    v_exp_f32 v108, v108
    v_exp_f32 v109, v109
    v_exp_f32 v110, v110
    v_exp_f32_e64 v111, v111
    v_cvt_pk_bf16_f32 v156, v104, v105
    v_cvt_pk_bf16_f32 v157, v106, v107
    v_cvt_pk_bf16_f32 v158, v108, v109
    v_cvt_pk_bf16_f32 v159, v110, v111
    v_exp_f32 v48, v48
    v_exp_f32 v49, v49
    v_mfma_f32_32x32x16_bf16 v[112:127], v[180:183], v[148:151], v[112:127]
    v_exp_f32 v50, v50
    v_exp_f32 v51, v51
    v_exp_f32 v52, v52
    s_waitcnt lgkmcnt(0)
    v_mfma_f32_32x32x16_bf16 v[64:79], v[164:167], v[4:7], v[16:31]
    v_exp_f32 v53, v53
    v_exp_f32 v54, v54
    v_exp_f32 v55, v55
    v_exp_f32 v56, v56
    v_cvt_pk_bf16_f32 v144, v48, v49
    v_cvt_pk_bf16_f32 v145, v50, v51
    v_cvt_pk_bf16_f32 v146, v52, v53
    v_cvt_pk_bf16_f32 v147, v54, v55
    v_exp_f32 v57, v57
    v_exp_f32 v58, v58
    v_mfma_f32_32x32x16_bf16 v[112:127], v[168:171], v[144:147], v[112:127]
    v_exp_f32 v59, v59
    v_exp_f32 v60, v60
    v_exp_f32 v61, v61
    v_exp_f32 v62, v62
    v_exp_f32_e64 v63, v63
    v_cvt_pk_bf16_f32 v148, v56, v57
    v_cvt_pk_bf16_f32 v149, v58, v59
    v_cvt_pk_bf16_f32 v150, v60, v61
    v_cvt_pk_bf16_f32 v151, v62, v63
    v_exp_f32 v80, v80
    v_exp_f32 v81, v81
    v_mfma_f32_32x32x16_bf16 v[128:143], v[180:183], v[156:159], v[128:143]
    ds_read_b128 v[176:179], v13 offset:14336
    v_exp_f32 v82, v82
    v_exp_f32 v83, v83
    ds_read_b128 v[180:183], v13 offset:14848
    v_exp_f32 v84, v84
    v_exp_f32 v85, v85
    ds_read_b128 v[160:163], v12 offset:16384
    v_mfma_f32_32x32x16_bf16 v[96:111], v[164:167], v[8:11], v[32:47]
    v_exp_f32 v86, v86
    v_exp_f32 v87, v87
    v_exp_f32_e64 v88, v88
    v_cvt_pk_bf16_f32 v152, v80, v81
    v_cvt_pk_bf16_f32 v153, v82, v83
    v_cvt_pk_bf16_f32 v154, v84, v85
    v_cvt_pk_bf16_f32 v155, v86, v87
    v_exp_f32 v89, v89
    v_exp_f32 v90, v90
    v_mfma_f32_32x32x16_bf16 v[128:143], v[168:171], v[152:155], v[128:143]
    v_exp_f32 v91, v91
    v_exp_f32 v92, v92
    v_exp_f32 v93, v93
    v_exp_f32 v94, v94
    v_exp_f32_e64 v95, v95
    v_cvt_pk_bf16_f32 v156, v88, v89
    v_cvt_pk_bf16_f32 v157, v90, v91
    v_cvt_pk_bf16_f32 v158, v92, v93
    v_cvt_pk_bf16_f32 v159, v94, v95
    v_exp_f32 v64, v64
    v_exp_f32 v65, v65
    v_mfma_f32_32x32x16_bf16 v[112:127], v[172:175], v[148:151], v[112:127]
    v_exp_f32 v66, v66
    v_exp_f32 v67, v67
    v_exp_f32 v68, v68
    s_waitcnt lgkmcnt(0)
    v_mfma_f32_32x32x16_bf16 v[48:63], v[160:163], v[4:7], v[16:31]
    v_exp_f32 v69, v69
    v_exp_f32 v70, v70
    v_exp_f32 v71, v71
    v_exp_f32 v72, v72
    v_cvt_pk_bf16_f32 v144, v64, v65
    v_cvt_pk_bf16_f32 v145, v66, v67
    v_cvt_pk_bf16_f32 v146, v68, v69
    v_cvt_pk_bf16_f32 v147, v70, v71
    v_exp_f32 v73, v73
    v_exp_f32 v74, v74
    v_mfma_f32_32x32x16_bf16 v[112:127], v[176:179], v[144:147], v[112:127]
    v_exp_f32 v75, v75
    v_exp_f32 v76, v76
    v_exp_f32 v77, v77
    v_exp_f32 v78, v78
    v_exp_f32_e64 v79, v79
    v_cvt_pk_bf16_f32 v148, v72, v73
    v_cvt_pk_bf16_f32 v149, v74, v75
    v_cvt_pk_bf16_f32 v150, v76, v77
    v_cvt_pk_bf16_f32 v151, v78, v79
    v_exp_f32 v96, v96
    v_exp_f32 v97, v97
    v_mfma_f32_32x32x16_bf16 v[128:143], v[172:175], v[156:159], v[128:143]
    ds_read_b128 v[168:171], v13 offset:16384
    v_exp_f32 v98, v98
    v_exp_f32 v99, v99
    ds_read_b128 v[172:175], v13 offset:16896
    v_exp_f32 v100, v100
    v_exp_f32 v101, v101
    ds_read_b128 v[164:167], v12 offset:18432
    v_mfma_f32_32x32x16_bf16 v[80:95], v[160:163], v[8:11], v[32:47]
    v_exp_f32 v102, v102
    v_exp_f32 v103, v103
    v_exp_f32_e64 v104, v104
    v_cvt_pk_bf16_f32 v152, v96, v97
    v_cvt_pk_bf16_f32 v153, v98, v99
    v_cvt_pk_bf16_f32 v154, v100, v101
    v_cvt_pk_bf16_f32 v155, v102, v103
    v_exp_f32 v105, v105
    v_exp_f32 v106, v106
    v_mfma_f32_32x32x16_bf16 v[128:143], v[176:179], v[152:155], v[128:143]
    v_exp_f32 v107, v107
    v_exp_f32 v108, v108
    v_exp_f32 v109, v109
    v_exp_f32 v110, v110
    v_exp_f32_e64 v111, v111
    v_cvt_pk_bf16_f32 v156, v104, v105
    v_cvt_pk_bf16_f32 v157, v106, v107
    v_cvt_pk_bf16_f32 v158, v108, v109
    v_cvt_pk_bf16_f32 v159, v110, v111
    v_add_u32 v12, 16384, v12
    v_mad_u32_u24 v13, v188, s50, v13
    s_add_u32 s44, s44, 1
    s_cmp_lt_u32 s44, 8
    s_cbranch_scc1 L_att_main_45
    s_nop 1
    v_mfma_f32_32x32x16_bf16 v[112:127], v[180:183], v[148:151], v[112:127]
    v_mfma_f32_32x32x16_bf16 v[128:143], v[180:183], v[156:159], v[128:143]
    s_waitcnt lgkmcnt(0)
    s_nop 15
    v_mov_b32 v14, 0x5f800000
    v_cmp_nlt_f32 vcc, v120, v14
    v_cmp_nlt_f32 s[46:47], v136, v14
    s_nop 1
    s_or_b64 vcc, vcc, s[46:47]
    s_cbranch_vccz L_att_done_46
    v_lshlrev_b32 v12, 4, v1
    v_mov_b32 v184, 0xff800000
    v_mov_b32 v185, 0xff800000
    s_mov_b32 s44, 0
L_att_fb_47:
    ds_read_b128 v[160:163], v12
    v_add_u32 v12, 2048, v12
    s_waitcnt lgkmcnt(0)
    v_mfma_f32_32x32x16_bf16 v[48:63], v[160:163], v[4:7], 0
    v_mfma_f32_32x32x16_bf16 v[80:95], v[160:163], v[8:11], 0
    s_nop 15
    v_max3_f32 v184, v48, v49, v184
    v_max3_f32 v184, v50, v51, v184
    v_max3_f32 v184, v52, v53, v184
    v_max3_f32 v184, v54, v55, v184
    v_max3_f32 v184, v56, v57, v184
    v_max3_f32 v184, v58, v59, v184
    v_max3_f32 v184, v60, v61, v184
    v_max3_f32 v184, v62, v63, v184
    v_max3_f32 v185, v80, v81, v185
    v_max3_f32 v185, v82, v83, v185
    v_max3_f32 v185, v84, v85, v185
    v_max3_f32 v185, v86, v87, v185
    v_max3_f32 v185, v88, v89, v185
    v_max3_f32 v185, v90, v91, v185
    v_max3_f32 v185, v92, v93, v185
    v_max3_f32 v185, v94, v95, v185
    s_add_u32 s44, s44, 1
    s_cmp_lt_u32 s44, 64
    s_cbranch_scc1 L_att_fb_47
    v_mov_b32 v14, v184
    v_mov_b32 v15, v14
    s_nop 1
    v_permlane32_swap_b32 v14, v15
    s_nop 1
    v_max_f32 v14, v14, v15
    v_sub_f32 v14, 0, v14
    v_mov_b32 v16, v14
    v_mov_b32 v17, v14
    v_mov_b32 v18, v14
    v_mov_b32 v19, v14
    v_mov_b32 v20, v14
    v_mov_b32 v21, v14
    v_mov_b32 v22, v14
    v_mov_b32 v23, v14
    v_mov_b32 v24, v14
    v_mov_b32 v25, v14
    v_mov_b32 v26, v14
    v_mov_b32 v27, v14
    v_mov_b32 v28, v14
    v_mov_b32 v29, v14
    v_mov_b32 v30, v14
    v_mov_b32 v31, v14
    v_mov_b32 v14, v185
    v_mov_b32 v15, v14
    s_nop 1
    v_permlane32_swap_b32 v14, v15
    s_nop 1
    v_max_f32 v14, v14, v15
    v_sub_f32 v14, 0, v14
    v_mov_b32 v32, v14
    v_mov_b32 v33, v14
    v_mov_b32 v34, v14
    v_mov_b32 v35, v14
    v_mov_b32 v36, v14
    v_mov_b32 v37, v14
    v_mov_b32 v38, v14
    v_mov_b32 v39, v14
    v_mov_b32 v40, v14
    v_mov_b32 v41, v14
    v_mov_b32 v42, v14
    v_mov_b32 v43, v14
    v_mov_b32 v44, v14
    v_mov_b32 v45, v14
    v_mov_b32 v46, v14
    v_mov_b32 v47, v14
    s_mov_b32 s50, 4096
    v_mov_b32 v112, 0
    v_mov_b32 v113, 0
    v_mov_b32 v114, 0
    v_mov_b32 v115, 0
    v_mov_b32 v116, 0
    v_mov_b32 v117, 0
    v_mov_b32 v118, 0
    v_mov_b32 v119, 0
    v_mov_b32 v120, 0
    v_mov_b32 v121, 0
    v_mov_b32 v122, 0
    v_mov_b32 v123, 0
    v_mov_b32 v124, 0
    v_mov_b32 v125, 0
    v_mov_b32 v126, 0
    v_mov_b32 v127, 0
    v_mov_b32 v128, 0
    v_mov_b32 v129, 0
    v_mov_b32 v130, 0
    v_mov_b32 v131, 0
    v_mov_b32 v132, 0
    v_mov_b32 v133, 0
    v_mov_b32 v134, 0
    v_mov_b32 v135, 0
    v_mov_b32 v136, 0
    v_mov_b32 v137, 0
    v_mov_b32 v138, 0
    v_mov_b32 v139, 0
    v_mov_b32 v140, 0
    v_mov_b32 v141, 0
    v_mov_b32 v142, 0
    v_mov_b32 v143, 0
    v_lshlrev_b32 v12, 4, v1
    v_mov_b32 v13, v187
    ds_read_b128 v[160:163], v12
    ds_read_b128 v[164:167], v12 offset:2048
    ds_read_b128 v[168:171], v13
    ds_read_b128 v[172:175], v13 offset:512
    s_waitcnt lgkmcnt(0)
    v_mfma_f32_32x32x16_bf16 v[48:63], v[160:163], v[4:7], v[16:31]
    v_mfma_f32_32x32x16_bf16 v[80:95], v[160:163], v[8:11], v[32:47]
    v_mov_b32 v148, 0
    v_mov_b32 v149, 0
    v_mov_b32 v150, 0
    v_mov_b32 v151, 0
    v_mov_b32 v156, 0
    v_mov_b32 v157, 0
    v_mov_b32 v158, 0
    v_mov_b32 v159, 0
    v_mov_b32 v180, 0x3f803f80
    v_mov_b32 v181, 0x3f803f80
    v_mov_b32 v182, 0x3f803f80
    v_mov_b32 v183, 0x3f803f80
    s_nop 13
    s_mov_b32 s44, 0
L_att_loop_48:
    v_exp_f32 v48, v48
    v_exp_f32 v49, v49
    v_mfma_f32_32x32x16_bf16 v[112:127], v[180:183], v[148:151], v[112:127]
    v_exp_f32 v50, v50
    v_exp_f32 v51, v51
    v_exp_f32 v52, v52
    s_waitcnt lgkmcnt(0)
    v_mfma_f32_32x32x16_bf16 v[64:79], v[164:167], v[4:7], v[16:31]
    v_exp_f32 v53, v53
    v_exp_f32 v54, v54
    v_exp_f32 v55, v55
    v_exp_f32 v56, v56
    v_cvt_pk_bf16_f32 v144, v48, v49
    v_cvt_pk_bf16_f32 v145, v50, v51
    v_cvt_pk_bf16_f32 v146, v52, v53
    v_cvt_pk_bf16_f32 v147, v54, v55
    v_exp_f32 v57, v57
    v_exp_f32 v58, v58
    v_mfma_f32_32x32x16_bf16 v[112:127], v[168:171], v[144:147], v[112:127]
    v_exp_f32 v59, v59
    v_exp_f32 v60, v60
    v_exp_f32 v61, v61
    v_exp_f32 v62, v62
    v_exp_f32_e64 v63, v63
    v_cvt_pk_bf16_f32 v148, v56, v57
    v_cvt_pk_bf16_f32 v149, v58, v59
    v_cvt_pk_bf16_f32 v150, v60, v61
    v_cvt_pk_bf16_f32 v151, v62, v63
    v_exp_f32 v80, v80
    v_exp_f32 v81, v81
    v_mfma_f32_32x32x16_bf16 v[128:143], v[180:183], v[156:159], v[128:143]
    ds_read_b128 v[176:179], v13 offset:2048
    v_exp_f32 v82, v82
    v_exp_f32 v83, v83
    ds_read_b128 v[180:183], v13 offset:2560
    v_exp_f32 v84, v84
    v_exp_f32 v85, v85
    ds_read_b128 v[160:163], v12 offset:4096
    v_mfma_f32_32x32x16_bf16 v[96:111], v[164:167], v[8:11], v[32:47]
    v_exp_f32 v86, v86
    v_exp_f32 v87, v87
    v_exp_f32_e64 v88, v88
    v_cvt_pk_bf16_f32 v152, v80, v81
    v_cvt_pk_bf16_f32 v153, v82, v83
    v_cvt_pk_bf16_f32 v154, v84, v85
    v_cvt_pk_bf16_f32 v155, v86, v87
    v_exp_f32 v89, v89
    v_exp_f32 v90, v90
    v_mfma_f32_32x32x16_bf16 v[128:143], v[168:171], v[152:155], v[128:143]
    v_exp_f32 v91, v91
    v_exp_f32 v92, v92
    v_exp_f32 v93, v93
    v_exp_f32 v94, v94
    v_exp_f32_e64 v95, v95
    v_cvt_pk_bf16_f32 v156, v88, v89
    v_cvt_pk_bf16_f32 v157, v90, v91
    v_cvt_pk_bf16_f32 v158, v92, v93
    v_cvt_pk_bf16_f32 v159, v94, v95
    v_exp_f32 v64, v64
    v_exp_f32 v65, v65
    v_mfma_f32_32x32x16_bf16 v[112:127], v[172:175], v[148:151], v[112:127]
    v_exp_f32 v66, v66
    v_exp_f32 v67, v67
    v_exp_f32 v68, v68
    s_waitcnt lgkmcnt(0)
    v_mfma_f32_32x32x16_bf16 v[48:63], v[160:163], v[4:7], v[16:31]
    v_exp_f32 v69, v69
    v_exp_f32 v70, v70
    v_exp_f32 v71, v71
    v_exp_f32 v72, v72
    v_cvt_pk_bf16_f32 v144, v64, v65
    v_cvt_pk_bf16_f32 v145, v66, v67
    v_cvt_pk_bf16_f32 v146, v68, v69
    v_cvt_pk_bf16_f32 v147, v70, v71
    v_exp_f32 v73, v73
    v_exp_f32 v74, v74
    v_mfma_f32_32x32x16_bf16 v[112:127], v[176:179], v[144:147], v[112:127]
    v_exp_f32 v75, v75
    v_exp_f32 v76, v76
    v_exp_f32 v77, v77
    v_exp_f32 v78, v78
    v_exp_f32_e64 v79, v79
    v_cvt_pk_bf16_f32 v148, v72, v73
    v_cvt_pk_bf16_f32 v149, v74, v75
    v_cvt_pk_bf16_f32 v150, v76, v77
    v_cvt_pk_bf16_f32 v151, v78, v79
    v_exp_f32 v96, v96
    v_exp_f32 v97, v97
    v_mfma_f32_32x32x16_bf16 v[128:143], v[172:175], v[156:159], v[128:143]
    ds_read_b128 v[168:171], v13 offset:4096
    v_exp_f32 v98, v98
    v_exp_f32 v99, v99
    ds_read_b128 v[172:175], v13 offset:4608
    v_exp_f32 v100, v100
    v_exp_f32 v101, v101
    ds_read_b128 v[164:167], v12 offset:6144
    v_mfma_f32_32x32x16_bf16 v[80:95], v[160:163], v[8:11], v[32:47]
    v_exp_f32 v102, v102
    v_exp_f32 v103, v103
    v_exp_f32_e64 v104, v104
    v_cvt_pk_bf16_f32 v152, v96, v97
    v_cvt_pk_bf16_f32 v153, v98, v99
    v_cvt_pk_bf16_f32 v154, v100, v101
    v_cvt_pk_bf16_f32 v155, v102, v103
    v_exp_f32 v105, v105
    v_exp_f32 v106, v106
    v_mfma_f32_32x32x16_bf16 v[128:143], v[176:179], v[152:155], v[128:143]
    v_exp_f32 v107, v107
    v_exp_f32 v108, v108
    v_exp_f32 v109, v109
    v_exp_f32 v110, v110
    v_exp_f32_e64 v111, v111
    v_cvt_pk_bf16_f32 v156, v104, v105
    v_cvt_pk_bf16_f32 v157, v106, v107
    v_cvt_pk_bf16_f32 v158, v108, v109
    v_cvt_pk_bf16_f32 v159, v110, v111
    v_add_u32 v12, 4096, v12
    v_mad_u32_u24 v13, v188, s50, v13
    s_add_u32 s44, s44, 1
    s_cmp_lt_u32 s44, 32
    s_cbranch_scc1 L_att_loop_48
    s_nop 1
    v_mfma_f32_32x32x16_bf16 v[112:127], v[180:183], v[148:151], v[112:127]
    v_mfma_f32_32x32x16_bf16 v[128:143], v[180:183], v[156:159], v[128:143]
    s_waitcnt lgkmcnt(0)
    s_nop 15
L_att_done_46:
    v_rcp_f32 v14, v120
    v_rcp_f32 v15, v136
    s_lshl_b32 s46, s43, 3
    s_lshl_b32 s47, s3, 1
    s_add_u32 s46, s46, s47
    s_lshl_b32 s46, s46, 5
    s_add_u32 s46, s46, s42
    s_lshl_b32 s46, s46, 10
    s_add_u32 s46, s46, 7340032
    v_mul_f32 v112, v112, v14
    v_mul_f32 v113, v113, v14
    v_mul_f32 v114, v114, v14
    v_mul_f32 v115, v115, v14
    v_mul_f32 v116, v116, v14
    v_mul_f32 v117, v117, v14
    v_mul_f32 v118, v118, v14
    v_mul_f32 v119, v119, v14
    v_cvt_pk_bf16_f32 v144, v112, v113
    v_cvt_pk_bf16_f32 v145, v114, v115
    v_cvt_pk_bf16_f32 v146, v116, v117
    v_cvt_pk_bf16_f32 v147, v118, v119
    v_mul_f32 v128, v128, v15
    v_mul_f32 v129, v129, v15
    v_mul_f32 v130, v130, v15
    v_mul_f32 v131, v131, v15
    v_mul_f32 v132, v132, v15
    v_mul_f32 v133, v133, v15
    v_mul_f32 v134, v134, v15
    v_mul_f32 v135, v135, v15
    v_cvt_pk_bf16_f32 v152, v128, v129
    v_cvt_pk_bf16_f32 v153, v130, v131
    v_cvt_pk_bf16_f32 v154, v132, v133
    v_cvt_pk_bf16_f32 v155, v134, v135
    v_lshlrev_b32 v186, 4, v1
    v_add_u32 v186, s46, v186
    global_store_dwordx4 v186, v[144:147], s[40:41] sc1
    v_add_u32 v186, 0x8000, v186
    global_store_dwordx4 v186, v[152:155], s[40:41] sc1
    s_waitcnt vmcnt(0)
    s_branch L_p2done_40
L_p2load_39:
    s_mov_b32 m0, s47
    s_nop 0
    buffer_load_dwordx4 v10, s[4:7], s47 offen sc1 lds
    s_add_u32 s47, s47, 4096
    s_mov_b32 m0, s47
    s_nop 0
    buffer_load_dwordx4 v10, s[4:7], s47 offen sc1 lds
    s_add_u32 s47, s47, 4096
    s_mov_b32 m0, s47
    s_nop 0
    buffer_load_dwordx4 v10, s[4:7], s47 offen sc1 lds
    s_add_u32 s47, s47, 4096
    s_mov_b32 m0, s47
    s_nop 0
    buffer_load_dwordx4 v10, s[4:7], s47 offen sc1 lds
    s_add_u32 s47, s47, 4096
    s_mov_b32 m0, s47
    s_nop 0
    buffer_load_dwordx4 v10, s[4:7], s47 offen sc1 lds
    s_add_u32 s47, s47, 4096
    s_mov_b32 m0, s47
    s_nop 0
    buffer_load_dwordx4 v10, s[4:7], s47 offen sc1 lds
    s_add_u32 s47, s47, 4096
    s_mov_b32 m0, s47
    s_nop 0
    buffer_load_dwordx4 v10, s[4:7], s47 offen sc1 lds
    s_add_u32 s47, s47, 4096
    s_mov_b32 m0, s47
    s_nop 0
    buffer_load_dwordx4 v10, s[4:7], s47 offen sc1 lds
    s_add_u32 s47, s47, 4096
    s_mov_b32 m0, s47
    s_nop 0
    buffer_load_dwordx4 v10, s[4:7], s47 offen sc1 lds
    s_add_u32 s47, s47, 4096
    s_mov_b32 m0, s47
    s_nop 0
    buffer_load_dwordx4 v10, s[4:7], s47 offen sc1 lds
    s_add_u32 s47, s47, 4096
    s_mov_b32 m0, s47
    s_nop 0
    buffer_load_dwordx4 v10, s[4:7], s47 offen sc1 lds
    s_add_u32 s47, s47, 4096
    s_mov_b32 m0, s47
    s_nop 0
    buffer_load_dwordx4 v10, s[4:7], s47 offen sc1 lds
    s_add_u32 s47, s47, 4096
    s_waitcnt vmcnt(4)
    s_barrier
    s_mov_b32 m0, s47
    s_nop 0
    buffer_load_dwordx4 v10, s[4:7], s47 offen sc1 lds
    s_add_u32 s47, s47, 4096
    s_mov_b32 m0, s47
    s_nop 0
    buffer_load_dwordx4 v10, s[4:7], s47 offen sc1 lds
    s_add_u32 s47, s47, 4096
    s_mov_b32 m0, s47
    s_nop 0
    buffer_load_dwordx4 v10, s[4:7], s47 offen sc1 lds
    s_add_u32 s47, s47, 4096
    s_mov_b32 m0, s47
    s_nop 0
    buffer_load_dwordx4 v10, s[4:7], s47 offen sc1 lds
    s_add_u32 s47, s47, 4096
    s_mov_b32 m0, s47
    s_nop 0
    buffer_load_dwordx4 v10, s[4:7], s47 offen sc1 lds
    s_add_u32 s47, s47, 4096
    s_mov_b32 m0, s47
    s_nop 0
    buffer_load_dwordx4 v10, s[4:7], s47 offen sc1 lds
    s_add_u32 s47, s47, 4096
    s_mov_b32 m0, s47
    s_nop 0
    buffer_load_dwordx4 v10, s[4:7], s47 offen sc1 lds
    s_add_u32 s47, s47, 4096
    s_mov_b32 m0, s47
    s_nop 0
    buffer_load_dwordx4 v10, s[4:7], s47 offen sc1 lds
    s_add_u32 s47, s47, 4096
    s_mov_b32 m0, s47
    s_nop 0
    buffer_load_dwordx4 v10, s[4:7], s47 offen sc1 lds
    s_add_u32 s47, s47, 4096
    s_mov_b32 m0, s47
    s_nop 0
    buffer_load_dwordx4 v10, s[4:7], s47 offen sc1 lds
    s_add_u32 s47, s47, 4096
    s_mov_b32 m0, s47
    s_nop 0
    buffer_load_dwordx4 v10, s[4:7], s47 offen sc1 lds
    s_add_u32 s47, s47, 4096
    s_mov_b32 m0, s47
    s_nop 0
    buffer_load_dwordx4 v10, s[4:7], s47 offen sc1 lds
    s_add_u32 s47, s47, 4096
    s_mov_b32 m0, s47
    s_nop 0
    buffer_load_dwordx4 v10, s[4:7], s47 offen sc1 lds
    s_add_u32 s47, s47, 4096
    s_mov_b32 m0, s47
    s_nop 0
    buffer_load_dwordx4 v10, s[4:7], s47 offen sc1 lds
    s_add_u32 s47, s47, 4096
    s_mov_b32 m0, s47
    s_nop 0
    buffer_load_dwordx4 v10, s[4:7], s47 offen sc1 lds
    s_add_u32 s47, s47, 4096
    s_mov_b32 m0, s47
    s_nop 0
    buffer_load_dwordx4 v10, s[4:7], s47 offen sc1 lds
    s_add_u32 s47, s47, 4096
    s_mov_b32 m0, s47
    s_nop 0
    buffer_load_dwordx4 v10, s[4:7], s47 offen sc1 lds
    s_add_u32 s47, s47, 4096
    s_mov_b32 m0, s47
    s_nop 0
    buffer_load_dwordx4 v10, s[4:7], s47 offen sc1 lds
    s_add_u32 s47, s47, 4096
    s_mov_b32 m0, s47
    s_nop 0
    buffer_load_dwordx4 v10, s[4:7], s47 offen sc1 lds
    s_add_u32 s47, s47, 4096
    s_mov_b32 m0, s47
    s_nop 0
    buffer_load_dwordx4 v10, s[4:7], s47 offen sc1 lds
    s_waitcnt vmcnt(0)
    s_barrier
    v_min_u32 v253, s59, v252
    global_load_dword v251, v253, s[52:53]
    v_min_u32 v253, s59, v252
    global_load_dword v251, v253, s[54:55]
    v_min_u32 v253, s59, v252
    global_load_dword v251, v253, s[56:57]
    v_min_u32 v253, s58, v252
    global_load_dword v251, v253, s[50:51]
    v_min_u32 v253, s59, v252
    global_load_dword v251, v253, s[44:45]
    v_min_u32 v253, s59, v252
    global_load_dword v251, v253, s[48:49]
    s_getpc_b64 s[62:63]
L_pc_49:
    s_add_u32 s62, s62, (L_P3 - L_pc_49)
    s_addc_u32 s63, s63, 0
    v_lshlrev_b32 v252, 7, v1
    v_min_u32 v253, (L_P4 - L_P3 - 4), v252
    global_load_dword v251, v253, s[62:63]
    s_lshr_b32 s59, s2, 3
    s_bfe_u32 s46, s2, 0x20001
    s_lshl_b32 s44, s46, 3
    s_and_b32 s46, s2, 1
    s_cmp_ge_u32 s59, 24
    s_cbranch_scc1 L_p5i_50
    s_mul_i32 s47, s59, 86
    s_lshr_b32 s47, s47, 8
    s_add_u32 s44, s44, s47
    s_mul_i32 s47, s47, 3
    s_sub_u32 s45, s59, s47
    s_lshl_b32 s46, s46, 2
    s_add_u32 s45, s45, s46
    s_branch L_p5j_51
L_p5i_50:
    s_lshl_b32 s46, s46, 2
    s_add_u32 s44, s44, s46
    s_sub_u32 s47, s59, 24
    s_and_b32 s47, s47, 3
    s_add_u32 s44, s44, s47
    s_mov_b32 s45, 3
L_p5j_51:
    s_and_b32 s49, s3, 3
    v_lshrrev_b32 v5, 3, v1
    s_lshl_b32 s46, s49, 4
    s_add_u32 s46, s46, 0
    v_add_u32 v5, s46, v5
    v_bfe_u32 v6, v5, 1, 3
    v_and_b32 v7, 7, v1
    v_xor_b32 v6, v6, v7
    v_lshlrev_b32 v5, 12, v5
    v_lshl_add_u32 v200, v6, 4, v5
    v_lshrrev_b32 v5, 3, v1
    s_lshl_b32 s46, s49, 4
    s_add_u32 s46, s46, 8
    v_add_u32 v5, s46, v5
    v_bfe_u32 v6, v5, 1, 3
    v_and_b32 v7, 7, v1
    v_xor_b32 v6, v6, v7
    v_lshlrev_b32 v5, 12, v5
    v_lshl_add_u32 v201, v6, 4, v5
    s_lshl_b32 s46, s44, 18
    s_add_u32 s8, s26, s46
    s_addc_u32 s9, s27, 0
    s_mov_b32 s10, 262144
    s_mov_b32 s11, 0x20000
    buffer_load_dwordx4 v[8:11], v200, s[8:11], 0 offen offset:768
    buffer_load_dwordx4 v[12:15], v201, s[8:11], 0 offen offset:768
    buffer_load_dwordx4 v[16:19], v200, s[8:11], 0 offen offset:896
    buffer_load_dwordx4 v[20:23], v201, s[8:11], 0 offen offset:896
    buffer_load_dwordx4 v[24:27], v200, s[8:11], 0 offen offset:1024
    buffer_load_dwordx4 v[28:31], v201, s[8:11], 0 offen offset:1024
    buffer_load_dwordx4 v[32:35], v200, s[8:11], 0 offen offset:1152
    buffer_load_dwordx4 v[36:39], v201, s[8:11], 0 offen offset:1152
    buffer_load_dwordx4 v[40:43], v200, s[8:11], 0 offen offset:1280
    buffer_load_dwordx4 v[44:47], v201, s[8:11], 0 offen offset:1280
    buffer_load_dwordx4 v[48:51], v200, s[8:11], 0 offen offset:1408
    buffer_load_dwordx4 v[52:55], v201, s[8:11], 0 offen offset:1408
    buffer_load_dwordx4 v[56:59], v200, s[8:11], 0 offen offset:1536
    buffer_load_dwordx4 v[60:63], v201, s[8:11], 0 offen offset:1536
    buffer_load_dwordx4 v[64:67], v200, s[8:11], 0 offen offset:1664
    buffer_load_dwordx4 v[68:71], v201, s[8:11], 0 offen offset:1664
    buffer_load_dwordx4 v[72:75], v200, s[8:11], 0 offen offset:1792
    buffer_load_dwordx4 v[76:79], v201, s[8:11], 0 offen offset:1792
    buffer_load_dwordx4 v[80:83], v200, s[8:11], 0 offen offset:1920
    buffer_load_dwordx4 v[84:87], v201, s[8:11], 0 offen offset:1920
    buffer_load_dwordx4 v[88:91], v200, s[8:11], 0 offen offset:2048
    buffer_load_dwordx4 v[92:95], v201, s[8:11], 0 offen offset:2048
    buffer_load_dwordx4 v[96:99], v200, s[8:11], 0 offen offset:2176
    buffer_load_dwordx4 v[100:103], v201, s[8:11], 0 offen offset:2176
    buffer_load_dwordx4 v[104:107], v200, s[8:11], 0 offen offset:2304
    buffer_load_dwordx4 v[108:111], v201, s[8:11], 0 offen offset:2304
    buffer_load_dwordx4 v[112:115], v200, s[8:11], 0 offen offset:2432
    buffer_load_dwordx4 v[116:119], v201, s[8:11], 0 offen offset:2432
    buffer_load_dwordx4 v[120:123], v200, s[8:11], 0 offen offset:2560
    buffer_load_dwordx4 v[124:127], v201, s[8:11], 0 offen offset:2560
    buffer_load_dwordx4 v[128:131], v200, s[8:11], 0 offen offset:2688
    buffer_load_dwordx4 v[132:135], v201, s[8:11], 0 offen offset:2688
    buffer_load_dwordx4 v[136:139], v200, s[8:11], 0 offen offset:2816
    buffer_load_dwordx4 v[140:143], v201, s[8:11], 0 offen offset:2816
    buffer_load_dwordx4 v[144:147], v200, s[8:11], 0 offen offset:2944
    buffer_load_dwordx4 v[148:151], v201, s[8:11], 0 offen offset:2944
    buffer_load_dwordx4 v[152:155], v200, s[8:11], 0 offen offset:3072
    buffer_load_dwordx4 v[156:159], v201, s[8:11], 0 offen offset:3072
    buffer_load_dwordx4 v[160:163], v200, s[8:11], 0 offen offset:3200
    buffer_load_dwordx4 v[164:167], v201, s[8:11], 0 offen offset:3200
    buffer_load_dwordx4 v[168:171], v200, s[8:11], 0 offen offset:3328
    buffer_load_dwordx4 v[172:175], v201, s[8:11], 0 offen offset:3328
    buffer_load_dwordx4 v[176:179], v200, s[8:11], 0 offen offset:3456
    buffer_load_dwordx4 v[180:183], v201, s[8:11], 0 offen offset:3456
L_p2done_40:
    s_lshl_b32 s58, s43, 8
    s_add_u32 s58, s58, 2048
    s_barrier
    s_cmp_lg_u32 s3, 0
    s_cbranch_scc1 L_sig_52
    v_mov_b32 v254, s58
    v_mov_b32 v255, 1
    s_mov_b64 exec, 1
    global_atomic_add v254, v255, s[40:41] sc1
    s_mov_b64 exec, -1
L_sig_52:
L_P3:
    s_and_b32 s42, s2, 7
    s_lshl_b32 s42, s42, 2
    s_lshr_b32 s43, s2, 6
    s_add_u32 s42, s42, s43
    s_bfe_u32 s43, s2, 0x30003
    s_and_b32 s51, s3, 1
    s_bfe_u32 s52, s3, 0x10001
    s_lshl_b32 s53, s43, 6
    s_lshl_b32 s46, s52, 5
    s_add_u32 s53, s53, s46
    s_cmp_lt_u32 s3, 4
    s_cbranch_scc1 L_p3c_53
    v_lshrrev_b32 v204, 3, v1
    v_lshlrev_b32 v204, 10, v204
    v_bfe_u32 v205, v1, 4, 1
    v_lshlrev_b32 v205, 2, v205
    v_and_b32 v206, 7, v1
    v_xor_b32 v205, v205, v206
    v_lshl_add_u32 v204, v205, 4, v204
    s_lshl_b32 s46, s43, 7
    s_add_u32 s8, s20, s46
    s_addc_u32 s9, s21, 0
    s_sub_u32 s10, 524288, s46
    s_mov_b32 s11, 0x20000
    s_and_b32 s49, s3, 3
    s_mul_i32 s47, s49, 131072
    s_mul_i32 s48, s49, 16384
    s_add_u32 m0, s48, 0
    s_nop 0
    buffer_load_dwordx4 v204, s[8:11], s47 offen lds
    s_add_u32 m0, s48, 1024
    s_add_u32 s47, s47, 8192
    buffer_load_dwordx4 v204, s[8:11], s47 offen lds
    s_add_u32 m0, s48, 2048
    s_add_u32 s47, s47, 8192
    buffer_load_dwordx4 v204, s[8:11], s47 offen lds
    s_add_u32 m0, s48, 3072
    s_add_u32 s47, s47, 8192
    buffer_load_dwordx4 v204, s[8:11], s47 offen lds
    s_add_u32 m0, s48, 4096
    s_add_u32 s47, s47, 8192
    buffer_load_dwordx4 v204, s[8:11], s47 offen lds
    s_add_u32 m0, s48, 5120
    s_add_u32 s47, s47, 8192
    buffer_load_dwordx4 v204, s[8:11], s47 offen lds
    s_add_u32 m0, s48, 6144
    s_add_u32 s47, s47, 8192
    buffer_load_dwordx4 v204, s[8:11], s47 offen lds
    s_add_u32 m0, s48, 7168
    s_add_u32 s47, s47, 8192
    buffer_load_dwordx4 v204, s[8:11], s47 offen lds
    s_add_u32 m0, s48, 8192
    s_add_u32 s47, s47, 8192
    buffer_load_dwordx4 v204, s[8:11], s47 offen lds
    s_add_u32 m0, s48, 9216
    s_add_u32 s47, s47, 8192
    buffer_load_dwordx4 v204, s[8:11], s47 offen lds
    s_add_u32 m0, s48, 10240
    s_add_u32 s47, s47, 8192
    buffer_load_dwordx4 v204, s[8:11], s47 offen lds
    s_add_u32 m0, s48, 11264
    s_add_u32 s47, s47, 8192
    buffer_load_dwordx4 v204, s[8:11], s47 offen lds
    s_add_u32 m0, s48, 12288
    s_add_u32 s47, s47, 8192
    buffer_load_dwordx4 v204, s[8:11], s47 offen lds
    s_add_u32 m0, s48, 13312
    s_add_u32 s47, s47, 8192
    buffer_load_dwordx4 v204, s[8:11], s47 offen lds
    s_add_u32 m0, s48, 14336
    s_add_u32 s47, s47, 8192
    buffer_load_dwordx4 v204, s[8:11], s47 offen lds
    s_add_u32 m0, s48, 15360
    s_add_u32 s47, s47, 8192
    buffer_load_dwordx4 v204, s[8:11], s47 offen lds
    s_branch L_p3w_54
L_p3c_53:
    s_lshl_b32 s46, s42, 16
    s_lshl_b32 s47, s51, 15
    s_add_u32 s46, s46, s47
    s_lshl_b32 s47, s53, 1
    s_add_u32 s46, s46, s47
    v_lshlrev_b32 v12, 10, v2
    v_lshl_add_u32 v12, v3, 3, v12
    v_add_u32 v12, s46, v12
    global_load_dwordx2 v[208:209], v12, s[16:17] offset:0
    global_load_dwordx2 v[210:211], v12, s[16:17] offset:16
    global_load_dwordx2 v[212:213], v12, s[16:17] offset:32
    global_load_dwordx2 v[214:215], v12, s[16:17] offset:48
    v_bfe_u32 v11, v1, 2, 2
    v_lshl_add_u32 v11, v3, 2, v11
    v_lshlrev_b32 v11, 7, v11
    v_bfe_u32 v12, v1, 3, 1
    v_xor_b32 v12, s52, v12
    v_lshl_add_u32 v11, v12, 6, v11
    v_bfe_u32 v12, v1, 4, 1
    v_lshl_add_u32 v11, v12, 5, v11
    v_and_b32 v12, 3, v1
    v_lshl_add_u32 v112, v12, 3, v11
    v_add_u32 v113, 65536, v112
    s_lshl_b32 s46, s51, 15
    s_add_u32 s46, s46, 65536
    v_lshlrev_b32 v114, 4, v1
    v_add_u32 v114, s46, v114
    v_mov_b32 v192, 0
    v_mov_b32 v193, 0
    v_mov_b32 v194, 0
    v_mov_b32 v195, 0
    v_mov_b32 v196, 0
    v_mov_b32 v197, 0
    v_mov_b32 v198, 0
    v_mov_b32 v199, 0
    v_mov_b32 v200, 0
    v_mov_b32 v201, 0
    v_mov_b32 v202, 0
    v_mov_b32 v203, 0
    v_mov_b32 v204, 0
    v_mov_b32 v205, 0
    v_mov_b32 v206, 0
    v_mov_b32 v207, 0
L_p3w_54:
    s_lshl_b32 s46, s42, 16
    s_add_u32 s46, s46, 7340032
    s_add_u32 s4, s40, s46
    s_addc_u32 s5, s41, 0
    s_mov_b32 s6, 65536
    s_mov_b32 s7, 0x20000
    v_lshlrev_b32 v232, 4, v1
    s_lshl_b32 s54, s3, 10
    s_lshr_b32 s46, s42, 2
    s_lshl_b32 s46, s46, 8
    s_add_u32 s46, s46, 2048
    s_and_b32 s47, s2, 7
    s_lshl_b32 s47, s47, 8
    s_add_u32 s47, s47, 34816
    s_cmp_lg_u32 s3, 0
    s_cbranch_scc1 L_w2_55
    v_mov_b32 v254, s47
    v_mov_b32 v253, 64
    s_mov_b64 exec, 1
    v_mov_b32 v254, s46
    v_mov_b32 v253, 32
    s_mov_b64 exec, 3
    s_mov_b32 s60, 0x200000
L_poll2_56:
    global_load_dword v255, v254, s[40:41] sc1
    s_sub_u32 s60, s60, 1
    s_cbranch_scc1 L_poll2_56_out
    s_waitcnt vmcnt(0)
    v_cmp_gt_u32 vcc, v253, v255
    s_cbranch_vccnz L_poll2_56
L_poll2_56_out:
    s_waitcnt vmcnt(0)
    s_mov_b64 exec, -1
L_w2_55:
    s_barrier
    s_cmp_ge_u32 s3, 4
    s_cbranch_scc1 L_p3g_57
    s_lshl_b32 s47, s53, 2
    s_add_u32 s47, s47, 69632
    v_lshlrev_b32 v12, 4, v3
    v_add_u32 v12, s47, v12
    global_load_dwordx4 v[216:219], v12, s[40:41] offset:0 sc1
    global_load_dwordx4 v[220:223], v12, s[40:41] offset:32 sc1
    global_load_dwordx4 v[224:227], v12, s[40:41] offset:64 sc1
    global_load_dwordx4 v[228:231], v12, s[40:41] offset:96 sc1
L_p3g_57:
    s_add_u32 s55, s54, 0
    s_add_u32 m0, s55, 65536
    s_nop 0
    buffer_load_dwordx4 v232, s[4:7], s55 offen sc1 lds
    s_add_u32 s55, s54, 8192
    s_add_u32 m0, s55, 65536
    s_nop 0
    buffer_load_dwordx4 v232, s[4:7], s55 offen sc1 lds
    s_add_u32 s55, s54, 32768
    s_add_u32 m0, s55, 65536
    s_nop 0
    buffer_load_dwordx4 v232, s[4:7], s55 offen sc1 lds
    s_add_u32 s55, s54, 40960
    s_add_u32 m0, s55, 65536
    s_nop 0
    buffer_load_dwordx4 v232, s[4:7], s55 offen sc1 lds
    s_add_u32 s55, s54, 16384
    s_add_u32 m0, s55, 65536
    s_nop 0
    buffer_load_dwordx4 v232, s[4:7], s55 offen sc1 lds
    s_add_u32 s55, s54, 24576
    s_add_u32 m0, s55, 65536
    s_nop 0
    buffer_load_dwordx4 v232, s[4:7], s55 offen sc1 lds
    s_add_u32 s55, s54, 49152
    s_add_u32 m0, s55, 65536
    s_nop 0
    buffer_load_dwordx4 v232, s[4:7], s55 offen sc1 lds
    s_add_u32 s55, s54, 57344
    s_add_u32 m0, s55, 65536
    s_nop 0
    buffer_load_dwordx4 v232, s[4:7], s55 offen sc1 lds
    s_waitcnt vmcnt(4)
    s_barrier
    s_cmp_ge_u32 s3, 4
    s_cbranch_scc1 L_p3load_58
    ds_read_b128 v[8:11], v114 offset:0
    ds_read_b64_tr_b16 v[12:13], v112 offset:0
    ds_read_b64_tr_b16 v[14:15], v112 offset:1024
    ds_read_b128 v[20:23], v114 offset:1024
    ds_read_b64_tr_b16 v[24:25], v112 offset:2048
    ds_read_b64_tr_b16 v[26:27], v112 offset:3072
    ds_read_b128 v[32:35], v114 offset:2048
    ds_read_b64_tr_b16 v[36:37], v112 offset:4096
    ds_read_b64_tr_b16 v[38:39], v112 offset:5120
    ds_read_b128 v[44:47], v114 offset:3072
    ds_read_b64_tr_b16 v[48:49], v112 offset:6144
    ds_read_b64_tr_b16 v[50:51], v112 offset:7168
    ds_read_b128 v[56:59], v114 offset:4096
    ds_read_b64_tr_b16 v[60:61], v112 offset:8192
    ds_read_b64_tr_b16 v[62:63], v112 offset:9216
    ds_read_b128 v[68:71], v114 offset:5120
    ds_read_b64_tr_b16 v[72:73], v112 offset:10240
    ds_read_b64_tr_b16 v[74:75], v112 offset:11264
    s_waitcnt lgkmcnt(12)
    v_mfma_f32_32x32x16_bf16 v[192:207], v[12:15], v[8:11], v[192:207]
    ds_read_b128 v[80:83], v114 offset:6144
    ds_read_b64_tr_b16 v[84:85], v112 offset:12288
    ds_read_b64_tr_b16 v[86:87], v112 offset:13312
    v_mfma_f32_32x32x16_bf16 v[192:207], v[24:27], v[20:23], v[192:207]
    ds_read_b128 v[92:95], v114 offset:7168
    ds_read_b64_tr_b16 v[96:97], v112 offset:14336
    ds_read_b64_tr_b16 v[98:99], v112 offset:15360
    s_waitcnt lgkmcnt(12)
    v_mfma_f32_32x32x16_bf16 v[192:207], v[36:39], v[32:35], v[192:207]
    ds_read_b128 v[8:11], v114 offset:8192
    ds_read_b64_tr_b16 v[12:13], v112 offset:16384
    ds_read_b64_tr_b16 v[14:15], v112 offset:17408
    v_mfma_f32_32x32x16_bf16 v[192:207], v[48:51], v[44:47], v[192:207]
    ds_read_b128 v[20:23], v114 offset:9216
    ds_read_b64_tr_b16 v[24:25], v112 offset:18432
    ds_read_b64_tr_b16 v[26:27], v112 offset:19456
    s_waitcnt lgkmcnt(12)
    v_mfma_f32_32x32x16_bf16 v[192:207], v[60:63], v[56:59], v[192:207]
    ds_read_b128 v[32:35], v114 offset:10240
    ds_read_b64_tr_b16 v[36:37], v112 offset:20480
    ds_read_b64_tr_b16 v[38:39], v112 offset:21504
    v_mfma_f32_32x32x16_bf16 v[192:207], v[72:75], v[68:71], v[192:207]
    ds_read_b128 v[44:47], v114 offset:11264
    ds_read_b64_tr_b16 v[48:49], v112 offset:22528
    ds_read_b64_tr_b16 v[50:51], v112 offset:23552
    s_waitcnt lgkmcnt(12)
    v_mfma_f32_32x32x16_bf16 v[192:207], v[84:87], v[80:83], v[192:207]
    ds_read_b128 v[56:59], v114 offset:12288
    ds_read_b64_tr_b16 v[60:61], v112 offset:24576
    ds_read_b64_tr_b16 v[62:63], v112 offset:25600
    v_mfma_f32_32x32x16_bf16 v[192:207], v[96:99], v[92:95], v[192:207]
    ds_read_b128 v[68:71], v114 offset:13312
    ds_read_b64_tr_b16 v[72:73], v112 offset:26624
    ds_read_b64_tr_b16 v[74:75], v112 offset:27648
    s_waitcnt lgkmcnt(12)
    v_mfma_f32_32x32x16_bf16 v[192:207], v[12:15], v[8:11], v[192:207]
    ds_read_b128 v[80:83], v114 offset:14336
    ds_read_b64_tr_b16 v[84:85], v112 offset:28672
    ds_read_b64_tr_b16 v[86:87], v112 offset:29696
    v_mfma_f32_32x32x16_bf16 v[192:207], v[24:27], v[20:23], v[192:207]
    ds_read_b128 v[92:95], v114 offset:15360
    ds_read_b64_tr_b16 v[96:97], v112 offset:30720
    ds_read_b64_tr_b16 v[98:99], v112 offset:31744
    s_waitcnt vmcnt(0)
    s_waitcnt lgkmcnt(12)
    s_barrier
    v_mfma_f32_32x32x16_bf16 v[192:207], v[36:39], v[32:35], v[192:207]
    ds_read_b128 v[8:11], v114 offset:16384
    ds_read_b64_tr_b16 v[12:13], v112 offset:32768
    ds_read_b64_tr_b16 v[14:15], v112 offset:33792
    v_mfma_f32_32x32x16_bf16 v[192:207], v[48:51], v[44:47], v[192:207]
    ds_read_b128 v[20:23], v114 offset:17408
    ds_read_b64_tr_b16 v[24:25], v112 offset:34816
    ds_read_b64_tr_b16 v[26:27], v112 offset:35840
    s_waitcnt lgkmcnt(12)
    v_mfma_f32_32x32x16_bf16 v[192:207], v[60:63], v[56:59], v[192:207]
    ds_read_b128 v[32:35], v114 offset:18432
    ds_read_b64_tr_b16 v[36:37], v112 offset:36864
    ds_read_b64_tr_b16 v[38:39], v112 offset:37888
    v_mfma_f32_32x32x16_bf16 v[192:207], v[72:75], v[68:71], v[192:207]
    ds_read_b128 v[44:47], v114 offset:19456
    ds_read_b64_tr_b16 v[48:49], v112 offset:38912
    ds_read_b64_tr_b16 v[50:51], v112 offset:39936
    s_waitcnt lgkmcnt(12)
    v_mfma_f32_32x32x16_bf16 v[192:207], v[84:87], v[80:83], v[192:207]
    ds_read_b128 v[56:59], v114 offset:20480
    ds_read_b64_tr_b16 v[60:61], v112 offset:40960
    ds_read_b64_tr_b16 v[62:63], v112 offset:41984
    v_mfma_f32_32x32x16_bf16 v[192:207], v[96:99], v[92:95], v[192:207]
    ds_read_b128 v[68:71], v114 offset:21504
    ds_read_b64_tr_b16 v[72:73], v112 offset:43008
    ds_read_b64_tr_b16 v[74:75], v112 offset:44032
    s_waitcnt lgkmcnt(12)
    v_mfma_f32_32x32x16_bf16 v[192:207], v[12:15], v[8:11], v[192:207]
    ds_read_b128 v[80:83], v114 offset:22528
    ds_read_b64_tr_b16 v[84:85], v112 offset:45056
    ds_read_b64_tr_b16 v[86:87], v112 offset:46080
    v_mfma_f32_32x32x16_bf16 v[192:207], v[24:27], v[20:23], v[192:207]
    ds_read_b128 v[92:95], v114 offset:23552
    ds_read_b64_tr_b16 v[96:97], v112 offset:47104
    ds_read_b64_tr_b16 v[98:99], v112 offset:48128
    s_waitcnt lgkmcnt(12)
    v_mfma_f32_32x32x16_bf16 v[192:207], v[36:39], v[32:35], v[192:207]
    ds_read_b128 v[8:11], v114 offset:24576
    ds_read_b64_tr_b16 v[12:13], v112 offset:49152
    ds_read_b64_tr_b16 v[14:15], v112 offset:50176
    v_mfma_f32_32x32x16_bf16 v[192:207], v[48:51], v[44:47], v[192:207]
    ds_read_b128 v[20:23], v114 offset:25600
    ds_read_b64_tr_b16 v[24:25], v112 offset:51200
    ds_read_b64_tr_b16 v[26:27], v112 offset:52224
    s_waitcnt lgkmcnt(12)
    v_mfma_f32_32x32x16_bf16 v[192:207], v[60:63], v[56:59], v[192:207]
    ds_read_b128 v[32:35], v114 offset:26624
    ds_read_b64_tr_b16 v[36:37], v112 offset:53248
    ds_read_b64_tr_b16 v[38:39], v112 offset:54272
    v_mfma_f32_32x32x16_bf16 v[192:207], v[72:75], v[68:71], v[192:207]
    ds_read_b128 v[44:47], v114 offset:27648
    ds_read_b64_tr_b16 v[48:49], v112 offset:55296
    ds_read_b64_tr_b16 v[50:51], v112 offset:56320
    s_waitcnt lgkmcnt(12)
    v_mfma_f32_32x32x16_bf16 v[192:207], v[84:87], v[80:83], v[192:207]
    ds_read_b128 v[56:59], v114 offset:28672
    ds_read_b64_tr_b16 v[60:61], v112 offset:57344
    ds_read_b64_tr_b16 v[62:63], v112 offset:58368
    v_mfma_f32_32x32x16_bf16 v[192:207], v[96:99], v[92:95], v[192:207]
    ds_read_b128 v[68:71], v114 offset:29696
    ds_read_b64_tr_b16 v[72:73], v112 offset:59392
    ds_read_b64_tr_b16 v[74:75], v112 offset:60416
    s_waitcnt lgkmcnt(12)
    v_mfma_f32_32x32x16_bf16 v[192:207], v[12:15], v[8:11], v[192:207]
    ds_read_b128 v[80:83], v114 offset:30720
    ds_read_b64_tr_b16 v[84:85], v112 offset:61440
    ds_read_b64_tr_b16 v[86:87], v112 offset:62464
    v_mfma_f32_32x32x16_bf16 v[192:207], v[24:27], v[20:23], v[192:207]
    ds_read_b128 v[92:95], v114 offset:31744
    ds_read_b64_tr_b16 v[96:97], v112 offset:63488
    ds_read_b64_tr_b16 v[98:99], v112 offset:64512
    s_waitcnt lgkmcnt(12)
    v_mfma_f32_32x32x16_bf16 v[192:207], v[36:39], v[32:35], v[192:207]
    v_mfma_f32_32x32x16_bf16 v[192:207], v[48:51], v[44:47], v[192:207]
    s_waitcnt lgkmcnt(6)
    v_mfma_f32_32x32x16_bf16 v[192:207], v[60:63], v[56:59], v[192:207]
    v_mfma_f32_32x32x16_bf16 v[192:207], v[72:75], v[68:71], v[192:207]
    s_waitcnt lgkmcnt(0)
    v_mfma_f32_32x32x16_bf16 v[192:207], v[84:87], v[80:83], v[192:207]
    v_mfma_f32_32x32x16_bf16 v[192:207], v[96:99], v[92:95], v[192:207]
    s_barrier
    s_nop 11
    v_lshlrev_b32 v16, 16, v208
    v_and_b32 v17, 0xffff0000, v208
    v_lshlrev_b32 v18, 16, v209
    v_and_b32 v19, 0xffff0000, v209
    v_lshlrev_b32 v20, 16, v210
    v_and_b32 v21, 0xffff0000, v210
    v_lshlrev_b32 v22, 16, v211
    v_and_b32 v23, 0xffff0000, v211
    v_lshlrev_b32 v24, 16, v212
    v_and_b32 v25, 0xffff0000, v212
    v_lshlrev_b32 v26, 16, v213
    v_and_b32 v27, 0xffff0000, v213
    v_lshlrev_b32 v28, 16, v214
    v_and_b32 v29, 0xffff0000, v214
    v_lshlrev_b32 v30, 16, v215
    v_and_b32 v31, 0xffff0000, v215
    v_fma_f32 v192, v192, v216, v16
    v_fma_f32 v193, v193, v217, v17
    v_fma_f32 v194, v194, v218, v18
    v_fma_f32 v195, v195, v219, v19
    v_fma_f32 v196, v196, v220, v20
    v_fma_f32 v197, v197, v221, v21
    v_fma_f32 v198, v198, v222, v22
    v_fma_f32 v199, v199, v223, v23
    v_fma_f32 v200, v200, v224, v24
    v_fma_f32 v201, v201, v225, v25
    v_fma_f32 v202, v202, v226, v26
    v_fma_f32 v203, v203, v227, v27
    v_fma_f32 v204, v204, v228, v28
    v_fma_f32 v205, v205, v229, v29
    v_fma_f32 v206, v206, v230, v30
    v_fma_f32 v207, v207, v231, v31
    v_cvt_pk_bf16_f32 v8, v192, v193
    v_cvt_pk_bf16_f32 v9, v194, v195
    v_cvt_pk_bf16_f32 v10, v196, v197
    v_cvt_pk_bf16_f32 v11, v198, v199
    v_cvt_pk_bf16_f32 v12, v200, v201
    v_cvt_pk_bf16_f32 v13, v202, v203
    v_cvt_pk_bf16_f32 v14, v204, v205
    v_cvt_pk_bf16_f32 v15, v206, v207
    s_lshl_b32 s46, s42, 1
    s_add_u32 s46, s46, s51
    s_lshl_b32 s46, s46, 5
    s_lshr_b32 s47, s53, 4
    s_add_u32 s46, s46, s47
    s_lshl_b32 s46, s46, 10
    s_add_u32 s46, s46, 9437184
    v_lshlrev_b32 v16, 4, v1
    v_add_u32 v16, s46, v16
    global_store_dwordx4 v16, v[8:11], s[40:41] sc1
    global_store_dwordx4 v16, v[12:15], s[40:41] offset:1024 sc1
    v_pk_add_f32 v[20:21], v[192:193], v[194:195]
    v_pk_mul_f32 v[22:23], v[192:193], v[192:193]
    v_pk_fma_f32 v[22:23], v[194:195], v[194:195], v[22:23]
    v_pk_add_f32 v[20:21], v[20:21], v[196:197]
    v_pk_fma_f32 v[22:23], v[196:197], v[196:197], v[22:23]
    v_pk_add_f32 v[20:21], v[20:21], v[198:199]
    v_pk_fma_f32 v[22:23], v[198:199], v[198:199], v[22:23]
    v_pk_add_f32 v[20:21], v[20:21], v[200:201]
    v_pk_fma_f32 v[22:23], v[200:201], v[200:201], v[22:23]
    v_pk_add_f32 v[20:21], v[20:21], v[202:203]
    v_pk_fma_f32 v[22:23], v[202:203], v[202:203], v[22:23]
    v_pk_add_f32 v[20:21], v[20:21], v[204:205]
    v_pk_fma_f32 v[22:23], v[204:205], v[204:205], v[22:23]
    v_pk_add_f32 v[20:21], v[20:21], v[206:207]
    v_pk_fma_f32 v[22:23], v[206:207], v[206:207], v[22:23]
    v_add_f32 v24, v20, v21
    v_add_f32 v25, v22, v23
    v_mov_b32 v26, v24
    v_mov_b32 v27, v25
    s_nop 1
    v_permlane32_swap_b32 v24, v26
    v_permlane32_swap_b32 v25, v27
    s_nop 1
    v_add_f32 v24, v24, v26
    v_add_f32 v25, v25, v27
    s_lshl_b32 s46, s42, 3
    s_add_u32 s46, s46, s43
    s_lshl_b32 s46, s46, 1
    s_add_u32 s46, s46, s52
    s_lshl_b32 s46, s46, 9
    s_lshl_b32 s47, s51, 8
    s_add_u32 s46, s46, s47
    s_add_u32 s46, s46, 24641536
    v_lshlrev_b32 v28, 3, v2
    v_add_u32 v28, s46, v28
    s_mov_b64 exec, 0xffffffff
    global_store_dwordx2 v28, v[24:25], s[40:41] sc1
    s_mov_b64 exec, -1
    s_waitcnt vmcnt(0)
    s_branch L_p3done_59
L_p3load_58:
    s_waitcnt vmcnt(0)
    s_barrier
    s_and_b32 s49, s3, 3
    s_lshl_b32 s56, s49, 12
    v_lshrrev_b32 v5, 4, v1
    v_lshlrev_b32 v6, 2, v5
    v_and_b32 v7, 15, v1
    v_xor_b32 v6, v6, v7
    s_lshl_b32 s46, s49, 4
    v_add_u32 v5, s46, v5
    v_mul_u32_u24 v5, 3584, v5
    v_lshl_add_u32 v240, v6, 4, v5
    v_add_u32 v241, 14336, v240
    v_add_u32 v242, 28672, v240
    v_add_u32 v243, 43008, v240
    s_bfe_u32 s46, s2, 0x30003
    s_lshl_b32 s57, s46, 2
    s_cmp_eq_u32 s46, 7
    s_cselect_b32 s57, 26, s57
    s_lshl_b32 s57, s57, 6
    s_mov_b32 s12, s24
    s_mov_b32 s13, s25
    s_mov_b32 s14, 1835008
    s_mov_b32 s15, 0x20000
    s_add_u32 s49, s57, 1792
    s_add_u32 m0, s56, 131072
    s_nop 0
    buffer_load_dwordx4 v240, s[12:15], s49 offen lds
    s_add_u32 m0, s56, 132096
    s_nop 0
    buffer_load_dwordx4 v241, s[12:15], s49 offen lds
    s_add_u32 m0, s56, 133120
    s_nop 0
    buffer_load_dwordx4 v242, s[12:15], s49 offen lds
    s_add_u32 m0, s56, 134144
    s_nop 0
    buffer_load_dwordx4 v243, s[12:15], s49 offen lds
    s_add_u32 s49, s57, 231168
    s_add_u32 m0, s56, 147456
    s_nop 0
    buffer_load_dwordx4 v240, s[12:15], s49 offen lds
    s_add_u32 m0, s56, 148480
    s_nop 0
    buffer_load_dwordx4 v241, s[12:15], s49 offen lds
    s_add_u32 m0, s56, 149504
    s_nop 0
    buffer_load_dwordx4 v242, s[12:15], s49 offen lds
    s_add_u32 m0, s56, 150528
    s_nop 0
    buffer_load_dwordx4 v243, s[12:15], s49 offen lds
    s_getpc_b64 s[62:63]
L_pc_60:
    s_add_u32 s62, s62, (L_P4 - L_pc_60)
    s_addc_u32 s63, s63, 0
    v_lshlrev_b32 v252, 7, v1
    v_min_u32 v253, (L_P5 - L_P4 - 4), v252
    global_load_dword v251, v253, s[62:63]
    v_add_u32 v252, 0x2000, v252
    v_min_u32 v253, (L_P5 - L_P4 - 4), v252
    global_load_dword v251, v253, s[62:63]
    s_barrier
    s_cmp_lg_u32 s3, 7
    s_cbranch_scc1 L_p4m_61
    s_add_u32 s4, s40, 71680
    s_addc_u32 s5, s41, 0
    s_mov_b32 s6, 4096
    s_mov_b32 s7, 0x20000
    v_lshlrev_b32 v5, 4, v1
    s_mov_b32 m0, 114688
    s_mov_b32 s49, 0
    buffer_load_dwordx4 v5, s[4:7], s49 offen offset:0 sc1 lds
    buffer_load_dwordx4 v5, s[4:7], s49 offen offset:1024 sc1 lds
    buffer_load_dwordx4 v5, s[4:7], s49 offen offset:2048 sc1 lds
    buffer_load_dwordx4 v5, s[4:7], s49 offen offset:3072 sc1 lds
L_p4m_61:
    s_add_u32 s49, s57, 460544
    s_add_u32 m0, s56, 65536
    s_nop 0
    buffer_load_dwordx4 v240, s[12:15], s49 offen lds
    s_add_u32 m0, s56, 66560
    s_nop 0
    buffer_load_dwordx4 v241, s[12:15], s49 offen lds
    s_add_u32 m0, s56, 67584
    s_nop 0
    buffer_load_dwordx4 v242, s[12:15], s49 offen lds
    s_add_u32 m0, s56, 68608
    s_nop 0
    buffer_load_dwordx4 v243, s[12:15], s49 offen lds
L_p3done_59:
    s_lshl_b32 s58, s42, 8
    s_add_u32 s58, s58, 4096
    s_barrier
    s_cmp_lg_u32 s3, 0
    s_cbranch_scc1 L_sig_62
    v_mov_b32 v254, s58
    v_mov_b32 v255, 1
    s_mov_b64 exec, 1
    global_atomic_add v254, v255, s[40:41] sc1
    s_mov_b64 exec, -1
L_sig_62:
L_P4:
    s_and_b32 s42, s2, 7
    s_lshl_b32 s42, s42, 2
    s_lshr_b32 s43, s2, 6
    s_add_u32 s42, s42, s43
    s_bfe_u32 s43, s2, 0x30003
    s_and_b32 s50, s3, 1
    s_lshr_b32 s51, s3, 1
    s_lshl_b32 s46, s42, 1
    s_add_u32 s46, s46, s50
    s_lshl_b32 s46, s46, 5
    s_lshl_b32 s47, s51, 3
    s_add_u32 s46, s46, s47
    s_lshl_b32 s46, s46, 10
    s_add_u32 s46, s46, 9437184
    s_add_u32 s4, s40, s46
    s_addc_u32 s5, s41, 0
    s_mov_b32 s6, 8192
    s_mov_b32 s7, 0x20000
    v_lshlrev_b32 v5, 4, v1
    s_lshl_b32 s46, s42, 13
    s_lshl_b32 s47, s50, 8
    s_add_u32 s46, s46, s47
    s_add_u32 s46, s46, 24641536
    v_lshlrev_b32 v6, 12, v3
    v_lshl_add_u32 v6, v2, 3, v6
    v_add_u32 v6, s46, v6
    s_mov_b32 s47, 4096
    s_lshl_b32 s46, s42, 8
    s_add_u32 s46, s46, 4096
    s_waitcnt vmcnt(0)
    s_cmp_lg_u32 s3, 0
    s_cbranch_scc1 L_wait_63
    v_lshlrev_b32 v254, 8, v1
    v_add_u32 v254, s46, v254
    s_mov_b64 exec, 1
    s_mov_b32 s60, 0x200000
L_poll_64:
    global_load_dword v255, v254, s[40:41] sc1
    s_sub_u32 s60, s60, 1
    s_cbranch_scc1 L_poll_64_out
    s_waitcnt vmcnt(0)
    v_cmp_gt_u32 vcc, 8, v255
    s_cbranch_vccnz L_poll_64
L_poll_64_out:
    s_waitcnt vmcnt(0)
    s_mov_b64 exec, -1
L_wait_63:
    s_barrier
    global_load_dwordx2 v[184:185], v6, s[40:41] offset:0 sc1
    global_load_dwordx2 v[186:187], v6, s[40:41] offset:512 sc1
    global_load_dwordx2 v[188:189], v6, s[40:41] offset:1024 sc1
    global_load_dwordx2 v[190:191], v6, s[40:41] offset:1536 sc1
    global_load_dwordx2 v[192:193], v6, s[40:41] offset:2048 sc1
    global_load_dwordx2 v[194:195], v6, s[40:41] offset:2560 sc1
    global_load_dwordx2 v[196:197], v6, s[40:41] offset:3072 sc1
    global_load_dwordx2 v[198:199], v6, s[40:41] offset:3584 sc1
    buffer_load_dwordx4 v[200:203], v5, s[4:7], 0 offen offset:0 sc1
    buffer_load_dwordx4 v[204:207], v5, s[4:7], 0 offen offset:1024 sc1
    buffer_load_dwordx4 v[208:211], v5, s[4:7], 0 offen offset:2048 sc1
    buffer_load_dwordx4 v[212:215], v5, s[4:7], 0 offen offset:3072 sc1
    buffer_load_dwordx4 v[216:219], v5, s[4:7], s47 offen offset:0 sc1
    buffer_load_dwordx4 v[220:223], v5, s[4:7], s47 offen offset:1024 sc1
    buffer_load_dwordx4 v[224:227], v5, s[4:7], s47 offen offset:2048 sc1
    buffer_load_dwordx4 v[228:231], v5, s[4:7], s47 offen offset:3072 sc1
    s_waitcnt vmcnt(8)
    v_add_f32 v184, v184, v186
    v_add_f32 v185, v185, v187
    v_add_f32 v184, v184, v188
    v_add_f32 v185, v185, v189
    v_add_f32 v184, v184, v190
    v_add_f32 v185, v185, v191
    v_add_f32 v184, v184, v192
    v_add_f32 v185, v185, v193
    v_add_f32 v184, v184, v194
    v_add_f32 v185, v185, v195
    v_add_f32 v184, v184, v196
    v_add_f32 v185, v185, v197
    v_add_f32 v184, v184, v198
    v_add_f32 v185, v185, v199
    v_mov_b32 v232, v184
    v_mov_b32 v233, v185
    s_nop 1
    v_permlane32_swap_b32 v184, v232
    v_permlane32_swap_b32 v185, v233
    s_nop 1
    v_add_f32 v232, v184, v232
    v_add_f32 v233, v185, v233
    v_mul_f32 v232, 0x3b000000, v232
    v_mul_f32 v233, 0x3b000000, v233
    v_fma_f32 v233, -v232, v232, v233
    v_max_f32 v233, 0, v233
    v_add_f32 v233, 0x3727c5ac, v233
    v_rsq_f32 v246, v233
    s_nop 0
    v_mul_f32 v247, v232, v246
    v_sub_f32 v247, 0, v247
    s_waitcnt vmcnt(0)
    s_lshl_b32 s46, s51, 9
    s_add_u32 s46, s46, 114688
    v_lshlrev_b32 v7, 4, v3
    v_add_u32 v7, s46, v7
    s_lshl_b32 s46, s50, 15
    s_lshl_b32 s47, s51, 13
    s_add_u32 s46, s46, s47
    v_add_u32 v5, s46, v5
    ds_read_b128 v[184:187], v7 offset:0
    ds_read_b128 v[188:191], v7 offset:32
    ds_read_b128 v[192:195], v7 offset:2048
    ds_read_b128 v[196:199], v7 offset:2080
    v_lshlrev_b32 v232, 16, v200
    v_and_b32 v233, 0xffff0000, v200
    v_lshlrev_b32 v234, 16, v201
    v_and_b32 v235, 0xffff0000, v201
    v_lshlrev_b32 v236, 16, v202
    v_and_b32 v237, 0xffff0000, v202
    v_lshlrev_b32 v238, 16, v203
    v_and_b32 v239, 0xffff0000, v203
    v_pk_fma_f32 v[232:233], v[232:233], v[246:247], v[246:247] op_sel:[0,0,1] op_sel_hi:[1,0,1]
    v_pk_fma_f32 v[234:235], v[234:235], v[246:247], v[246:247] op_sel:[0,0,1] op_sel_hi:[1,0,1]
    v_pk_fma_f32 v[236:237], v[236:237], v[246:247], v[246:247] op_sel:[0,0,1] op_sel_hi:[1,0,1]
    v_pk_fma_f32 v[238:239], v[238:239], v[246:247], v[246:247] op_sel:[0,0,1] op_sel_hi:[1,0,1]
    s_waitcnt lgkmcnt(0)
    v_pk_fma_f32 v[232:233], v[232:233], v[192:193], v[184:185]
    v_pk_fma_f32 v[234:235], v[234:235], v[194:195], v[186:187]
    v_pk_fma_f32 v[236:237], v[236:237], v[196:197], v[188:189]
    v_pk_fma_f32 v[238:239], v[238:239], v[198:199], v[190:191]
    ds_read_b128 v[184:187], v7 offset:64
    ds_read_b128 v[188:191], v7 offset:96
    ds_read_b128 v[192:195], v7 offset:2112
    ds_read_b128 v[196:199], v7 offset:2144
    v_cvt_pk_bf16_f32 v200, v232, v233
    v_cvt_pk_bf16_f32 v201, v234, v235
    v_cvt_pk_bf16_f32 v202, v236, v237
    v_cvt_pk_bf16_f32 v203, v238, v239
    ds_write_b128 v5, v[200:203] offset:0
    v_lshlrev_b32 v232, 16, v204
    v_and_b32 v233, 0xffff0000, v204
    v_lshlrev_b32 v234, 16, v205
    v_and_b32 v235, 0xffff0000, v205
    v_lshlrev_b32 v236, 16, v206
    v_and_b32 v237, 0xffff0000, v206
    v_lshlrev_b32 v238, 16, v207
    v_and_b32 v239, 0xffff0000, v207
    v_pk_fma_f32 v[232:233], v[232:233], v[246:247], v[246:247] op_sel:[0,0,1] op_sel_hi:[1,0,1]
    v_pk_fma_f32 v[234:235], v[234:235], v[246:247], v[246:247] op_sel:[0,0,1] op_sel_hi:[1,0,1]
    v_pk_fma_f32 v[236:237], v[236:237], v[246:247], v[246:247] op_sel:[0,0,1] op_sel_hi:[1,0,1]
    v_pk_fma_f32 v[238:239], v[238:239], v[246:247], v[246:247] op_sel:[0,0,1] op_sel_hi:[1,0,1]
    s_waitcnt lgkmcnt(1)
    v_pk_fma_f32 v[232:233], v[232:233], v[192:193], v[184:185]
    v_pk_fma_f32 v[234:235], v[234:235], v[194:195], v[186:187]
    v_pk_fma_f32 v[236:237], v[236:237], v[196:197], v[188:189]
    v_pk_fma_f32 v[238:239], v[238:239], v[198:199], v[190:191]
    ds_read_b128 v[184:187], v7 offset:128
    ds_read_b128 v[188:191], v7 offset:160
    ds_read_b128 v[192:195], v7 offset:2176
    ds_read_b128 v[196:199], v7 offset:2208
    v_cvt_pk_bf16_f32 v204, v232, v233
    v_cvt_pk_bf16_f32 v205, v234, v235
    v_cvt_pk_bf16_f32 v206, v236, v237
    v_cvt_pk_bf16_f32 v207, v238, v239
    ds_write_b128 v5, v[204:207] offset:1024
    v_lshlrev_b32 v232, 16, v208
    v_and_b32 v233, 0xffff0000, v208
    v_lshlrev_b32 v234, 16, v209
    v_and_b32 v235, 0xffff0000, v209
    v_lshlrev_b32 v236, 16, v210
    v_and_b32 v237, 0xffff0000, v210
    v_lshlrev_b32 v238, 16, v211
    v_and_b32 v239, 0xffff0000, v211
    v_pk_fma_f32 v[232:233], v[232:233], v[246:247], v[246:247] op_sel:[0,0,1] op_sel_hi:[1,0,1]
    v_pk_fma_f32 v[234:235], v[234:235], v[246:247], v[246:247] op_sel:[0,0,1] op_sel_hi:[1,0,1]
    v_pk_fma_f32 v[236:237], v[236:237], v[246:247], v[246:247] op_sel:[0,0,1] op_sel_hi:[1,0,1]
    v_pk_fma_f32 v[238:239], v[238:239], v[246:247], v[246:247] op_sel:[0,0,1] op_sel_hi:[1,0,1]
    s_waitcnt lgkmcnt(1)
    v_pk_fma_f32 v[232:233], v[232:233], v[192:193], v[184:185]
    v_pk_fma_f32 v[234:235], v[234:235], v[194:195], v[186:187]
    v_pk_fma_f32 v[236:237], v[236:237], v[196:197], v[188:189]
    v_pk_fma_f32 v[238:239], v[238:239], v[198:199], v[190:191]
    ds_read_b128 v[184:187], v7 offset:192
    ds_read_b128 v[188:191], v7 offset:224
    ds_read_b128 v[192:195], v7 offset:2240
    ds_read_b128 v[196:199], v7 offset:2272
    v_cvt_pk_bf16_f32 v208, v232, v233
    v_cvt_pk_bf16_f32 v209, v234, v235
    v_cvt_pk_bf16_f32 v210, v236, v237
    v_cvt_pk_bf16_f32 v211, v238, v239
    ds_write_b128 v5, v[208:211] offset:2048
    v_lshlrev_b32 v232, 16, v212
    v_and_b32 v233, 0xffff0000, v212
    v_lshlrev_b32 v234, 16, v213
    v_and_b32 v235, 0xffff0000, v213
    v_lshlrev_b32 v236, 16, v214
    v_and_b32 v237, 0xffff0000, v214
    v_lshlrev_b32 v238, 16, v215
    v_and_b32 v239, 0xffff0000, v215
    v_pk_fma_f32 v[232:233], v[232:233], v[246:247], v[246:247] op_sel:[0,0,1] op_sel_hi:[1,0,1]
    v_pk_fma_f32 v[234:235], v[234:235], v[246:247], v[246:247] op_sel:[0,0,1] op_sel_hi:[1,0,1]
    v_pk_fma_f32 v[236:237], v[236:237], v[246:247], v[246:247] op_sel:[0,0,1] op_sel_hi:[1,0,1]
    v_pk_fma_f32 v[238:239], v[238:239], v[246:247], v[246:247] op_sel:[0,0,1] op_sel_hi:[1,0,1]
    s_waitcnt lgkmcnt(1)
    v_pk_fma_f32 v[232:233], v[232:233], v[192:193], v[184:185]
    v_pk_fma_f32 v[234:235], v[234:235], v[194:195], v[186:187]
    v_pk_fma_f32 v[236:237], v[236:237], v[196:197], v[188:189]
    v_pk_fma_f32 v[238:239], v[238:239], v[198:199], v[190:191]
    ds_read_b128 v[184:187], v7 offset:256
    ds_read_b128 v[188:191], v7 offset:288
    ds_read_b128 v[192:195], v7 offset:2304
    ds_read_b128 v[196:199], v7 offset:2336
    v_cvt_pk_bf16_f32 v212, v232, v233
    v_cvt_pk_bf16_f32 v213, v234, v235
    v_cvt_pk_bf16_f32 v214, v236, v237
    v_cvt_pk_bf16_f32 v215, v238, v239
    ds_write_b128 v5, v[212:215] offset:3072
    v_lshlrev_b32 v232, 16, v216
    v_and_b32 v233, 0xffff0000, v216
    v_lshlrev_b32 v234, 16, v217
    v_and_b32 v235, 0xffff0000, v217
    v_lshlrev_b32 v236, 16, v218
    v_and_b32 v237, 0xffff0000, v218
    v_lshlrev_b32 v238, 16, v219
    v_and_b32 v239, 0xffff0000, v219
    v_pk_fma_f32 v[232:233], v[232:233], v[246:247], v[246:247] op_sel:[0,0,1] op_sel_hi:[1,0,1]
    v_pk_fma_f32 v[234:235], v[234:235], v[246:247], v[246:247] op_sel:[0,0,1] op_sel_hi:[1,0,1]
    v_pk_fma_f32 v[236:237], v[236:237], v[246:247], v[246:247] op_sel:[0,0,1] op_sel_hi:[1,0,1]
    v_pk_fma_f32 v[238:239], v[238:239], v[246:247], v[246:247] op_sel:[0,0,1] op_sel_hi:[1,0,1]
    s_waitcnt lgkmcnt(1)
    v_pk_fma_f32 v[232:233], v[232:233], v[192:193], v[184:185]
    v_pk_fma_f32 v[234:235], v[234:235], v[194:195], v[186:187]
    v_pk_fma_f32 v[236:237], v[236:237], v[196:197], v[188:189]
    v_pk_fma_f32 v[238:239], v[238:239], v[198:199], v[190:191]
    ds_read_b128 v[184:187], v7 offset:320
    ds_read_b128 v[188:191], v7 offset:352
    ds_read_b128 v[192:195], v7 offset:2368
    ds_read_b128 v[196:199], v7 offset:2400
    v_cvt_pk_bf16_f32 v216, v232, v233
    v_cvt_pk_bf16_f32 v217, v234, v235
    v_cvt_pk_bf16_f32 v218, v236, v237
    v_cvt_pk_bf16_f32 v219, v238, v239
    ds_write_b128 v5, v[216:219] offset:4096
    v_lshlrev_b32 v232, 16, v220
    v_and_b32 v233, 0xffff0000, v220
    v_lshlrev_b32 v234, 16, v221
    v_and_b32 v235, 0xffff0000, v221
    v_lshlrev_b32 v236, 16, v222
    v_and_b32 v237, 0xffff0000, v222
    v_lshlrev_b32 v238, 16, v223
    v_and_b32 v239, 0xffff0000, v223
    v_pk_fma_f32 v[232:233], v[232:233], v[246:247], v[246:247] op_sel:[0,0,1] op_sel_hi:[1,0,1]
    v_pk_fma_f32 v[234:235], v[234:235], v[246:247], v[246:247] op_sel:[0,0,1] op_sel_hi:[1,0,1]
    v_pk_fma_f32 v[236:237], v[236:237], v[246:247], v[246:247] op_sel:[0,0,1] op_sel_hi:[1,0,1]
    v_pk_fma_f32 v[238:239], v[238:239], v[246:247], v[246:247] op_sel:[0,0,1] op_sel_hi:[1,0,1]
    s_waitcnt lgkmcnt(1)
    v_pk_fma_f32 v[232:233], v[232:233], v[192:193], v[184:185]
    v_pk_fma_f32 v[234:235], v[234:235], v[194:195], v[186:187]
    v_pk_fma_f32 v[236:237], v[236:237], v[196:197], v[188:189]
    v_pk_fma_f32 v[238:239], v[238:239], v[198:199], v[190:191]
    ds_read_b128 v[184:187], v7 offset:384
    ds_read_b128 v[188:191], v7 offset:416
    ds_read_b128 v[192:195], v7 offset:2432
    ds_read_b128 v[196:199], v7 offset:2464
    v_cvt_pk_bf16_f32 v220, v232, v233
    v_cvt_pk_bf16_f32 v221, v234, v235
    v_cvt_pk_bf16_f32 v222, v236, v237
    v_cvt_pk_bf16_f32 v223, v238, v239
    ds_write_b128 v5, v[220:223] offset:5120
    v_lshlrev_b32 v232, 16, v224
    v_and_b32 v233, 0xffff0000, v224
    v_lshlrev_b32 v234, 16, v225
    v_and_b32 v235, 0xffff0000, v225
    v_lshlrev_b32 v236, 16, v226
    v_and_b32 v237, 0xffff0000, v226
    v_lshlrev_b32 v238, 16, v227
    v_and_b32 v239, 0xffff0000, v227
    v_pk_fma_f32 v[232:233], v[232:233], v[246:247], v[246:247] op_sel:[0,0,1] op_sel_hi:[1,0,1]
    v_pk_fma_f32 v[234:235], v[234:235], v[246:247], v[246:247] op_sel:[0,0,1] op_sel_hi:[1,0,1]
    v_pk_fma_f32 v[236:237], v[236:237], v[246:247], v[246:247] op_sel:[0,0,1] op_sel_hi:[1,0,1]
    v_pk_fma_f32 v[238:239], v[238:239], v[246:247], v[246:247] op_sel:[0,0,1] op_sel_hi:[1,0,1]
    s_waitcnt lgkmcnt(1)
    v_pk_fma_f32 v[232:233], v[232:233], v[192:193], v[184:185]
    v_pk_fma_f32 v[234:235], v[234:235], v[194:195], v[186:187]
    v_pk_fma_f32 v[236:237], v[236:237], v[196:197], v[188:189]
    v_pk_fma_f32 v[238:239], v[238:239], v[198:199], v[190:191]
    ds_read_b128 v[184:187], v7 offset:448
    ds_read_b128 v[188:191], v7 offset:480
    ds_read_b128 v[192:195], v7 offset:2496
    ds_read_b128 v[196:199], v7 offset:2528
    v_cvt_pk_bf16_f32 v224, v232, v233
    v_cvt_pk_bf16_f32 v225, v234, v235
    v_cvt_pk_bf16_f32 v226, v236, v237
    v_cvt_pk_bf16_f32 v227, v238, v239
    ds_write_b128 v5, v[224:227] offset:6144
    v_lshlrev_b32 v232, 16, v228
    v_and_b32 v233, 0xffff0000, v228
    v_lshlrev_b32 v234, 16, v229
    v_and_b32 v235, 0xffff0000, v229
    v_lshlrev_b32 v236, 16, v230
    v_and_b32 v237, 0xffff0000, v230
    v_lshlrev_b32 v238, 16, v231
    v_and_b32 v239, 0xffff0000, v231
    v_pk_fma_f32 v[232:233], v[232:233], v[246:247], v[246:247] op_sel:[0,0,1] op_sel_hi:[1,0,1]
    v_pk_fma_f32 v[234:235], v[234:235], v[246:247], v[246:247] op_sel:[0,0,1] op_sel_hi:[1,0,1]
    v_pk_fma_f32 v[236:237], v[236:237], v[246:247], v[246:247] op_sel:[0,0,1] op_sel_hi:[1,0,1]
    v_pk_fma_f32 v[238:239], v[238:239], v[246:247], v[246:247] op_sel:[0,0,1] op_sel_hi:[1,0,1]
    s_waitcnt lgkmcnt(1)
    v_pk_fma_f32 v[232:233], v[232:233], v[192:193], v[184:185]
    v_pk_fma_f32 v[234:235], v[234:235], v[194:195], v[186:187]
    v_pk_fma_f32 v[236:237], v[236:237], v[196:197], v[188:189]
    v_pk_fma_f32 v[238:239], v[238:239], v[198:199], v[190:191]
    v_cvt_pk_bf16_f32 v228, v232, v233
    v_cvt_pk_bf16_f32 v229, v234, v235
    v_cvt_pk_bf16_f32 v230, v236, v237
    v_cvt_pk_bf16_f32 v231, v238, v239
    ds_write_b128 v5, v[228:231] offset:7168
    s_waitcnt lgkmcnt(0)
    s_barrier
    s_bfe_u32 s46, s2, 0x30003
    s_lshl_b32 s52, s46, 2
    s_cmp_eq_u32 s46, 7
    s_cselect_b32 s52, 26, s52
    s_cmp_ge_u32 s3, 4
    s_cbranch_scc1 L_p4load_65
    v_lshlrev_b32 v56, 4, v1
    v_bfe_u32 v5, v1, 2, 2
    v_xor_b32 v6, s3, v5
    v_lshl_add_u32 v5, v3, 2, v5
    v_lshlrev_b32 v5, 8, v5
    v_lshl_add_u32 v5, v6, 6, v5
    v_bfe_u32 v6, v1, 4, 1
    v_lshl_add_u32 v5, v6, 5, v5
    v_and_b32 v6, 3, v1
    v_lshl_add_u32 v5, v6, 3, v5
    v_add_u32 v57, 131072, v5
    v_add_u32 v58, 147456, v5
    v_add_u32 v59, 65536, v5
    v_add_u32 v60, 81920, v5
    v_add_u32 v61, 98304, v5
    v_mov_b32 v128, 0
    v_mov_b32 v129, 0
    v_mov_b32 v130, 0
    v_mov_b32 v131, 0
    v_mov_b32 v132, 0
    v_mov_b32 v133, 0
    v_mov_b32 v134, 0
    v_mov_b32 v135, 0
    v_mov_b32 v136, 0
    v_mov_b32 v137, 0
    v_mov_b32 v138, 0
    v_mov_b32 v139, 0
    v_mov_b32 v140, 0
    v_mov_b32 v141, 0
    v_mov_b32 v142, 0
    v_mov_b32 v143, 0
    v_mov_b32 v144, 0
    v_mov_b32 v145, 0
    v_mov_b32 v146, 0
    v_mov_b32 v147, 0
    v_mov_b32 v148, 0
    v_mov_b32 v149, 0
    v_mov_b32 v150, 0
    v_mov_b32 v151, 0
    v_mov_b32 v152, 0
    v_mov_b32 v153, 0
    v_mov_b32 v154, 0
    v_mov_b32 v155, 0
    v_mov_b32 v156, 0
    v_mov_b32 v157, 0
    v_mov_b32 v158, 0
    v_mov_b32 v159, 0
    v_mov_b32 v160, 0
    v_mov_b32 v161, 0
    v_mov_b32 v162, 0
    v_mov_b32 v163, 0
    v_mov_b32 v164, 0
    v_mov_b32 v165, 0
    v_mov_b32 v166, 0
    v_mov_b32 v167, 0
    v_mov_b32 v168, 0
    v_mov_b32 v169, 0
    v_mov_b32 v170, 0
    v_mov_b32 v171, 0
    v_mov_b32 v172, 0
    v_mov_b32 v173, 0
    v_mov_b32 v174, 0
    v_mov_b32 v175, 0
    v_mov_b32 v176, 0
    v_mov_b32 v177, 0
    v_mov_b32 v178, 0
    v_mov_b32 v179, 0
    v_mov_b32 v180, 0
    v_mov_b32 v181, 0
    v_mov_b32 v182, 0
    v_mov_b32 v183, 0
    v_mov_b32 v184, 0
    v_mov_b32 v185, 0
    v_mov_b32 v186, 0
    v_mov_b32 v187, 0
    v_mov_b32 v188, 0
    v_mov_b32 v189, 0
    v_mov_b32 v190, 0
    v_mov_b32 v191, 0
    s_cmp_ge_u32 s3, 2
    s_cselect_b32 s46, 1, 0
    s_cmp_ge_u32 s43, 6
    s_cselect_b32 s47, 1, 0
    s_and_b32 s46, s46, s47
    s_xor_b32 s53, s46, 1
    ds_read_b128 v[8:11], v56 offset:0
    ds_read_b64_tr_b16 v[16:17], v57 offset:0
    ds_read_b64_tr_b16 v[18:19], v57 offset:2048
    ds_read_b128 v[12:15], v56 offset:32768
    ds_read_b128 v[20:23], v56 offset:1024
    ds_read_b64_tr_b16 v[28:29], v57 offset:4096
    ds_read_b64_tr_b16 v[30:31], v57 offset:6144
    ds_read_b128 v[24:27], v56 offset:33792
    ds_read_b128 v[32:35], v56 offset:2048
    ds_read_b64_tr_b16 v[40:41], v57 offset:8192
    ds_read_b64_tr_b16 v[42:43], v57 offset:10240
    ds_read_b128 v[36:39], v56 offset:34816
    s_waitcnt lgkmcnt(8)
    v_mfma_f32_32x32x16_bf16 v[128:143], v[16:19], v[8:11], v[128:143]
    ds_read_b128 v[44:47], v56 offset:3072
    ds_read_b64_tr_b16 v[52:53], v57 offset:12288
    v_mfma_f32_32x32x16_bf16 v[144:159], v[16:19], v[12:15], v[144:159]
    ds_read_b64_tr_b16 v[54:55], v57 offset:14336
    ds_read_b128 v[48:51], v56 offset:35840
    s_waitcnt lgkmcnt(8)
    s_barrier
    v_mfma_f32_32x32x16_bf16 v[128:143], v[28:31], v[20:23], v[128:143]
    ds_read_b128 v[8:11], v56 offset:4096
    ds_read_b64_tr_b16 v[16:17], v58 offset:0
    v_mfma_f32_32x32x16_bf16 v[144:159], v[28:31], v[24:27], v[144:159]
    ds_read_b64_tr_b16 v[18:19], v58 offset:2048
    ds_read_b128 v[12:15], v56 offset:36864
    s_waitcnt lgkmcnt(8)
    v_mfma_f32_32x32x16_bf16 v[128:143], v[40:43], v[32:35], v[128:143]
    ds_read_b128 v[20:23], v56 offset:5120
    ds_read_b64_tr_b16 v[28:29], v58 offset:4096
    v_mfma_f32_32x32x16_bf16 v[144:159], v[40:43], v[36:39], v[144:159]
    ds_read_b64_tr_b16 v[30:31], v58 offset:6144
    ds_read_b128 v[24:27], v56 offset:37888
    s_waitcnt lgkmcnt(8)
    v_mfma_f32_32x32x16_bf16 v[128:143], v[52:55], v[44:47], v[128:143]
    ds_read_b128 v[32:35], v56 offset:6144
    ds_read_b64_tr_b16 v[40:41], v58 offset:8192
    v_mfma_f32_32x32x16_bf16 v[144:159], v[52:55], v[48:51], v[144:159]
    ds_read_b64_tr_b16 v[42:43], v58 offset:10240
    ds_read_b128 v[36:39], v56 offset:38912
    s_waitcnt lgkmcnt(8)
    v_mfma_f32_32x32x16_bf16 v[128:143], v[16:19], v[8:11], v[128:143]
    ds_read_b128 v[44:47], v56 offset:7168
    ds_read_b64_tr_b16 v[52:53], v58 offset:12288
    v_mfma_f32_32x32x16_bf16 v[144:159], v[16:19], v[12:15], v[144:159]
    ds_read_b64_tr_b16 v[54:55], v58 offset:14336
    ds_read_b128 v[48:51], v56 offset:39936
    s_waitcnt lgkmcnt(8)
    s_barrier
    v_mfma_f32_32x32x16_bf16 v[128:143], v[28:31], v[20:23], v[128:143]
    ds_read_b128 v[8:11], v56 offset:8192
    ds_read_b64_tr_b16 v[16:17], v59 offset:0
    v_mfma_f32_32x32x16_bf16 v[144:159], v[28:31], v[24:27], v[144:159]
    ds_read_b64_tr_b16 v[18:19], v59 offset:2048
    ds_read_b128 v[12:15], v56 offset:40960
    s_waitcnt lgkmcnt(8)
    v_mfma_f32_32x32x16_bf16 v[128:143], v[40:43], v[32:35], v[128:143]
    ds_read_b128 v[20:23], v56 offset:9216
    ds_read_b64_tr_b16 v[28:29], v59 offset:4096
    v_mfma_f32_32x32x16_bf16 v[144:159], v[40:43], v[36:39], v[144:159]
    ds_read_b64_tr_b16 v[30:31], v59 offset:6144
    ds_read_b128 v[24:27], v56 offset:41984
    s_waitcnt lgkmcnt(8)
    v_mfma_f32_32x32x16_bf16 v[128:143], v[52:55], v[44:47], v[128:143]
    ds_read_b128 v[32:35], v56 offset:10240
    ds_read_b64_tr_b16 v[40:41], v59 offset:8192
    v_mfma_f32_32x32x16_bf16 v[144:159], v[52:55], v[48:51], v[144:159]
    ds_read_b64_tr_b16 v[42:43], v59 offset:10240
    ds_read_b128 v[36:39], v56 offset:43008
    s_waitcnt lgkmcnt(8)
    v_mfma_f32_32x32x16_bf16 v[128:143], v[16:19], v[8:11], v[128:143]
    ds_read_b128 v[44:47], v56 offset:11264
    ds_read_b64_tr_b16 v[52:53], v59 offset:12288
    v_mfma_f32_32x32x16_bf16 v[144:159], v[16:19], v[12:15], v[144:159]
    ds_read_b64_tr_b16 v[54:55], v59 offset:14336
    ds_read_b128 v[48:51], v56 offset:44032
    s_waitcnt lgkmcnt(8)
    s_barrier
    v_mfma_f32_32x32x16_bf16 v[128:143], v[28:31], v[20:23], v[128:143]
    ds_read_b128 v[8:11], v56 offset:12288
    ds_read_b64_tr_b16 v[16:17], v60 offset:0
    v_mfma_f32_32x32x16_bf16 v[144:159], v[28:31], v[24:27], v[144:159]
    ds_read_b64_tr_b16 v[18:19], v60 offset:2048
    ds_read_b128 v[12:15], v56 offset:45056
    s_waitcnt lgkmcnt(8)
    v_mfma_f32_32x32x16_bf16 v[128:143], v[40:43], v[32:35], v[128:143]
    ds_read_b128 v[20:23], v56 offset:13312
    ds_read_b64_tr_b16 v[28:29], v60 offset:4096
    v_mfma_f32_32x32x16_bf16 v[144:159], v[40:43], v[36:39], v[144:159]
    ds_read_b64_tr_b16 v[30:31], v60 offset:6144
    ds_read_b128 v[24:27], v56 offset:46080
    s_waitcnt lgkmcnt(8)
    v_mfma_f32_32x32x16_bf16 v[128:143], v[52:55], v[44:47], v[128:143]
    ds_read_b128 v[32:35], v56 offset:14336
    ds_read_b64_tr_b16 v[40:41], v60 offset:8192
    v_mfma_f32_32x32x16_bf16 v[144:159], v[52:55], v[48:51], v[144:159]
    ds_read_b64_tr_b16 v[42:43], v60 offset:10240
    ds_read_b128 v[36:39], v56 offset:47104
    s_waitcnt lgkmcnt(8)
    v_mfma_f32_32x32x16_bf16 v[128:143], v[16:19], v[8:11], v[128:143]
    ds_read_b128 v[44:47], v56 offset:15360
    ds_read_b64_tr_b16 v[52:53], v60 offset:12288
    v_mfma_f32_32x32x16_bf16 v[144:159], v[16:19], v[12:15], v[144:159]
    ds_read_b64_tr_b16 v[54:55], v60 offset:14336
    ds_read_b128 v[48:51], v56 offset:48128
    s_waitcnt lgkmcnt(8)
    s_barrier
    v_mfma_f32_32x32x16_bf16 v[128:143], v[28:31], v[20:23], v[128:143]
    ds_read_b128 v[8:11], v56 offset:16384
    ds_read_b64_tr_b16 v[16:17], v61 offset:0
    v_mfma_f32_32x32x16_bf16 v[144:159], v[28:31], v[24:27], v[144:159]
    ds_read_b64_tr_b16 v[18:19], v61 offset:2048
    ds_read_b128 v[12:15], v56 offset:49152
    s_waitcnt lgkmcnt(8)
    v_mfma_f32_32x32x16_bf16 v[128:143], v[40:43], v[32:35], v[128:143]
    ds_read_b128 v[20:23], v56 offset:17408
    ds_read_b64_tr_b16 v[28:29], v61 offset:4096
    v_mfma_f32_32x32x16_bf16 v[144:159], v[40:43], v[36:39], v[144:159]
    ds_read_b64_tr_b16 v[30:31], v61 offset:6144
    ds_read_b128 v[24:27], v56 offset:50176
    s_waitcnt lgkmcnt(8)
    v_mfma_f32_32x32x16_bf16 v[128:143], v[52:55], v[44:47], v[128:143]
    ds_read_b128 v[32:35], v56 offset:18432
    ds_read_b64_tr_b16 v[40:41], v61 offset:8192
    v_mfma_f32_32x32x16_bf16 v[144:159], v[52:55], v[48:51], v[144:159]
    ds_read_b64_tr_b16 v[42:43], v61 offset:10240
    ds_read_b128 v[36:39], v56 offset:51200
    s_waitcnt lgkmcnt(8)
    v_mfma_f32_32x32x16_bf16 v[128:143], v[16:19], v[8:11], v[128:143]
    ds_read_b128 v[44:47], v56 offset:19456
    ds_read_b64_tr_b16 v[52:53], v61 offset:12288
    v_mfma_f32_32x32x16_bf16 v[144:159], v[16:19], v[12:15], v[144:159]
    ds_read_b64_tr_b16 v[54:55], v61 offset:14336
    ds_read_b128 v[48:51], v56 offset:52224
    s_waitcnt lgkmcnt(8)
    s_barrier
    v_mfma_f32_32x32x16_bf16 v[128:143], v[28:31], v[20:23], v[128:143]
    ds_read_b128 v[8:11], v56 offset:20480
    ds_read_b64_tr_b16 v[16:17], v57 offset:0
    v_mfma_f32_32x32x16_bf16 v[144:159], v[28:31], v[24:27], v[144:159]
    ds_read_b64_tr_b16 v[18:19], v57 offset:2048
    ds_read_b128 v[12:15], v56 offset:53248
    s_waitcnt lgkmcnt(8)
    v_mfma_f32_32x32x16_bf16 v[128:143], v[40:43], v[32:35], v[128:143]
    ds_read_b128 v[20:23], v56 offset:21504
    ds_read_b64_tr_b16 v[28:29], v57 offset:4096
    v_mfma_f32_32x32x16_bf16 v[144:159], v[40:43], v[36:39], v[144:159]
    ds_read_b64_tr_b16 v[30:31], v57 offset:6144
    ds_read_b128 v[24:27], v56 offset:54272
    s_waitcnt lgkmcnt(8)
    v_mfma_f32_32x32x16_bf16 v[128:143], v[52:55], v[44:47], v[128:143]
    ds_read_b128 v[32:35], v56 offset:22528
    ds_read_b64_tr_b16 v[40:41], v57 offset:8192
    v_mfma_f32_32x32x16_bf16 v[144:159], v[52:55], v[48:51], v[144:159]
    ds_read_b64_tr_b16 v[42:43], v57 offset:10240
    ds_read_b128 v[36:39], v56 offset:55296
    s_waitcnt lgkmcnt(8)
    v_mfma_f32_32x32x16_bf16 v[128:143], v[16:19], v[8:11], v[128:143]
    ds_read_b128 v[44:47], v56 offset:23552
    ds_read_b64_tr_b16 v[52:53], v57 offset:12288
    v_mfma_f32_32x32x16_bf16 v[144:159], v[16:19], v[12:15], v[144:159]
    ds_read_b64_tr_b16 v[54:55], v57 offset:14336
    ds_read_b128 v[48:51], v56 offset:56320
    s_waitcnt lgkmcnt(8)
    s_barrier
    v_mfma_f32_32x32x16_bf16 v[128:143], v[28:31], v[20:23], v[128:143]
    ds_read_b128 v[8:11], v56 offset:24576
    ds_read_b64_tr_b16 v[16:17], v58 offset:0
    v_mfma_f32_32x32x16_bf16 v[144:159], v[28:31], v[24:27], v[144:159]
    ds_read_b64_tr_b16 v[18:19], v58 offset:2048
    ds_read_b128 v[12:15], v56 offset:57344
    s_waitcnt lgkmcnt(8)
    v_mfma_f32_32x32x16_bf16 v[128:143], v[40:43], v[32:35], v[128:143]
    ds_read_b128 v[20:23], v56 offset:25600
    ds_read_b64_tr_b16 v[28:29], v58 offset:4096
    v_mfma_f32_32x32x16_bf16 v[144:159], v[40:43], v[36:39], v[144:159]
    ds_read_b64_tr_b16 v[30:31], v58 offset:6144
    ds_read_b128 v[24:27], v56 offset:58368
    s_waitcnt lgkmcnt(8)
    v_mfma_f32_32x32x16_bf16 v[128:143], v[52:55], v[44:47], v[128:143]
    ds_read_b128 v[32:35], v56 offset:26624
    ds_read_b64_tr_b16 v[40:41], v58 offset:8192
    v_mfma_f32_32x32x16_bf16 v[144:159], v[52:55], v[48:51], v[144:159]
    ds_read_b64_tr_b16 v[42:43], v58 offset:10240
    ds_read_b128 v[36:39], v56 offset:59392
    s_waitcnt lgkmcnt(8)
    v_mfma_f32_32x32x16_bf16 v[128:143], v[16:19], v[8:11], v[128:143]
    ds_read_b128 v[44:47], v56 offset:27648
    ds_read_b64_tr_b16 v[52:53], v58 offset:12288
    v_mfma_f32_32x32x16_bf16 v[144:159], v[16:19], v[12:15], v[144:159]
    ds_read_b64_tr_b16 v[54:55], v58 offset:14336
    ds_read_b128 v[48:51], v56 offset:60416
    s_waitcnt lgkmcnt(8)
    s_barrier
    v_mfma_f32_32x32x16_bf16 v[128:143], v[28:31], v[20:23], v[128:143]
    ds_read_b128 v[8:11], v56 offset:28672
    ds_read_b64_tr_b16 v[16:17], v59 offset:0
    v_mfma_f32_32x32x16_bf16 v[144:159], v[28:31], v[24:27], v[144:159]
    ds_read_b64_tr_b16 v[18:19], v59 offset:2048
    ds_read_b128 v[12:15], v56 offset:61440
    s_waitcnt lgkmcnt(8)
    v_mfma_f32_32x32x16_bf16 v[128:143], v[40:43], v[32:35], v[128:143]
    ds_read_b128 v[20:23], v56 offset:29696
    ds_read_b64_tr_b16 v[28:29], v59 offset:4096
    v_mfma_f32_32x32x16_bf16 v[144:159], v[40:43], v[36:39], v[144:159]
    ds_read_b64_tr_b16 v[30:31], v59 offset:6144
    ds_read_b128 v[24:27], v56 offset:62464
    s_waitcnt lgkmcnt(8)
    v_mfma_f32_32x32x16_bf16 v[128:143], v[52:55], v[44:47], v[128:143]
    ds_read_b128 v[32:35], v56 offset:30720
    ds_read_b64_tr_b16 v[40:41], v59 offset:8192
    v_mfma_f32_32x32x16_bf16 v[144:159], v[52:55], v[48:51], v[144:159]
    ds_read_b64_tr_b16 v[42:43], v59 offset:10240
    ds_read_b128 v[36:39], v56 offset:63488
    s_waitcnt lgkmcnt(8)
    v_mfma_f32_32x32x16_bf16 v[128:143], v[16:19], v[8:11], v[128:143]
    ds_read_b128 v[44:47], v56 offset:31744
    ds_read_b64_tr_b16 v[52:53], v59 offset:12288
    v_mfma_f32_32x32x16_bf16 v[144:159], v[16:19], v[12:15], v[144:159]
    ds_read_b64_tr_b16 v[54:55], v59 offset:14336
    ds_read_b128 v[48:51], v56 offset:64512
    s_waitcnt lgkmcnt(8)
    s_barrier
    v_mfma_f32_32x32x16_bf16 v[128:143], v[28:31], v[20:23], v[128:143]
    ds_read_b128 v[8:11], v56 offset:0
    ds_read_b64_tr_b16 v[16:17], v60 offset:0
    v_mfma_f32_32x32x16_bf16 v[144:159], v[28:31], v[24:27], v[144:159]
    ds_read_b64_tr_b16 v[18:19], v60 offset:2048
    ds_read_b128 v[12:15], v56 offset:32768
    s_waitcnt lgkmcnt(8)
    v_mfma_f32_32x32x16_bf16 v[128:143], v[40:43], v[32:35], v[128:143]
    ds_read_b128 v[20:23], v56 offset:1024
    ds_read_b64_tr_b16 v[28:29], v60 offset:4096
    v_mfma_f32_32x32x16_bf16 v[144:159], v[40:43], v[36:39], v[144:159]
    ds_read_b64_tr_b16 v[30:31], v60 offset:6144
    ds_read_b128 v[24:27], v56 offset:33792
    s_waitcnt lgkmcnt(8)
    v_mfma_f32_32x32x16_bf16 v[128:143], v[52:55], v[44:47], v[128:143]
    ds_read_b128 v[32:35], v56 offset:2048
    ds_read_b64_tr_b16 v[40:41], v60 offset:8192
    v_mfma_f32_32x32x16_bf16 v[144:159], v[52:55], v[48:51], v[144:159]
    ds_read_b64_tr_b16 v[42:43], v60 offset:10240
    ds_read_b128 v[36:39], v56 offset:34816
    s_nop 13
    s_mov_b32 s48, 0xbdd2d3e8
    s_mov_b32 s49, s48
    v_mov_b32 v80, 0xc0135761
    v_mov_b32 v81, 0xc0135761
    v_mov_b32 v82, 1.0
    v_mov_b32 v83, 1.0
    v_pk_mul_f32 v[64:65], v[128:129], v[128:129]
    v_pk_mul_f32 v[66:67], v[130:131], v[130:131]
    v_pk_mul_f32 v[68:69], v[132:133], v[132:133]
    v_pk_mul_f32 v[70:71], v[134:135], v[134:135]
    v_pk_mul_f32 v[72:73], v[136:137], v[136:137]
    v_pk_mul_f32 v[74:75], v[138:139], v[138:139]
    v_pk_mul_f32 v[76:77], v[140:141], v[140:141]
    v_pk_mul_f32 v[78:79], v[142:143], v[142:143]
    v_pk_fma_f32 v[64:65], v[64:65], s[48:49], v[80:81]
    v_pk_fma_f32 v[66:67], v[66:67], s[48:49], v[80:81]
    v_pk_fma_f32 v[68:69], v[68:69], s[48:49], v[80:81]
    v_pk_fma_f32 v[70:71], v[70:71], s[48:49], v[80:81]
    v_pk_fma_f32 v[72:73], v[72:73], s[48:49], v[80:81]
    v_pk_fma_f32 v[74:75], v[74:75], s[48:49], v[80:81]
    v_pk_fma_f32 v[76:77], v[76:77], s[48:49], v[80:81]
    v_pk_fma_f32 v[78:79], v[78:79], s[48:49], v[80:81]
    v_pk_mul_f32 v[64:65], v[64:65], v[128:129]
    v_pk_mul_f32 v[66:67], v[66:67], v[130:131]
    v_pk_mul_f32 v[68:69], v[68:69], v[132:133]
    v_pk_mul_f32 v[70:71], v[70:71], v[134:135]
    v_pk_mul_f32 v[72:73], v[72:73], v[136:137]
    v_pk_mul_f32 v[74:75], v[74:75], v[138:139]
    v_pk_mul_f32 v[76:77], v[76:77], v[140:141]
    v_pk_mul_f32 v[78:79], v[78:79], v[142:143]
    v_exp_f32 v64, v64
    v_exp_f32 v65, v65
    v_exp_f32 v66, v66
    v_exp_f32 v67, v67
    v_exp_f32 v68, v68
    v_exp_f32 v69, v69
    v_exp_f32 v70, v70
    v_exp_f32 v71, v71
    v_exp_f32 v72, v72
    v_exp_f32 v73, v73
    v_exp_f32 v74, v74
    v_exp_f32 v75, v75
    v_exp_f32 v76, v76
    v_exp_f32 v77, v77
    v_exp_f32 v78, v78
    v_exp_f32 v79, v79
    v_pk_add_f32 v[64:65], v[64:65], v[82:83]
    v_pk_add_f32 v[66:67], v[66:67], v[82:83]
    v_pk_add_f32 v[68:69], v[68:69], v[82:83]
    v_pk_add_f32 v[70:71], v[70:71], v[82:83]
    v_pk_add_f32 v[72:73], v[72:73], v[82:83]
    v_pk_add_f32 v[74:75], v[74:75], v[82:83]
    v_pk_add_f32 v[76:77], v[76:77], v[82:83]
    v_pk_add_f32 v[78:79], v[78:79], v[82:83]
    v_rcp_f32 v64, v64
    v_rcp_f32 v65, v65
    v_rcp_f32 v66, v66
    v_rcp_f32 v67, v67
    v_rcp_f32 v68, v68
    v_rcp_f32 v69, v69
    v_rcp_f32 v70, v70
    v_rcp_f32 v71, v71
    v_rcp_f32 v72, v72
    v_rcp_f32 v73, v73
    v_rcp_f32 v74, v74
    v_rcp_f32 v75, v75
    v_rcp_f32 v76, v76
    v_rcp_f32 v77, v77
    v_rcp_f32 v78, v78
    v_rcp_f32 v79, v79
    v_pk_mul_f32 v[128:129], v[128:129], v[64:65]
    v_pk_mul_f32 v[130:131], v[130:131], v[66:67]
    v_pk_mul_f32 v[132:133], v[132:133], v[68:69]
    v_pk_mul_f32 v[134:135], v[134:135], v[70:71]
    v_pk_mul_f32 v[136:137], v[136:137], v[72:73]
    v_pk_mul_f32 v[138:139], v[138:139], v[74:75]
    v_pk_mul_f32 v[140:141], v[140:141], v[76:77]
    v_pk_mul_f32 v[142:143], v[142:143], v[78:79]
    v_pk_mul_f32 v[64:65], v[144:145], v[144:145]
    v_pk_mul_f32 v[66:67], v[146:147], v[146:147]
    v_pk_mul_f32 v[68:69], v[148:149], v[148:149]
    v_pk_mul_f32 v[70:71], v[150:151], v[150:151]
    v_pk_mul_f32 v[72:73], v[152:153], v[152:153]
    v_pk_mul_f32 v[74:75], v[154:155], v[154:155]
    v_pk_mul_f32 v[76:77], v[156:157], v[156:157]
    v_pk_mul_f32 v[78:79], v[158:159], v[158:159]
    v_pk_fma_f32 v[64:65], v[64:65], s[48:49], v[80:81]
    v_pk_fma_f32 v[66:67], v[66:67], s[48:49], v[80:81]
    v_pk_fma_f32 v[68:69], v[68:69], s[48:49], v[80:81]
    v_pk_fma_f32 v[70:71], v[70:71], s[48:49], v[80:81]
    v_pk_fma_f32 v[72:73], v[72:73], s[48:49], v[80:81]
    v_pk_fma_f32 v[74:75], v[74:75], s[48:49], v[80:81]
    v_pk_fma_f32 v[76:77], v[76:77], s[48:49], v[80:81]
    v_pk_fma_f32 v[78:79], v[78:79], s[48:49], v[80:81]
    v_pk_mul_f32 v[64:65], v[64:65], v[144:145]
    v_pk_mul_f32 v[66:67], v[66:67], v[146:147]
    v_pk_mul_f32 v[68:69], v[68:69], v[148:149]
    v_pk_mul_f32 v[70:71], v[70:71], v[150:151]
    v_pk_mul_f32 v[72:73], v[72:73], v[152:153]
    v_pk_mul_f32 v[74:75], v[74:75], v[154:155]
    v_pk_mul_f32 v[76:77], v[76:77], v[156:157]
    v_pk_mul_f32 v[78:79], v[78:79], v[158:159]
    v_exp_f32 v64, v64
    v_exp_f32 v65, v65
    v_exp_f32 v66, v66
    v_exp_f32 v67, v67
    v_exp_f32 v68, v68
    v_exp_f32 v69, v69
    v_exp_f32 v70, v70
    v_exp_f32 v71, v71
    v_exp_f32 v72, v72
    v_exp_f32 v73, v73
    v_exp_f32 v74, v74
    v_exp_f32 v75, v75
    v_exp_f32 v76, v76
    v_exp_f32 v77, v77
    v_exp_f32 v78, v78
    v_exp_f32 v79, v79
    v_pk_add_f32 v[64:65], v[64:65], v[82:83]
    v_pk_add_f32 v[66:67], v[66:67], v[82:83]
    v_pk_add_f32 v[68:69], v[68:69], v[82:83]
    v_pk_add_f32 v[70:71], v[70:71], v[82:83]
    v_pk_add_f32 v[72:73], v[72:73], v[82:83]
    v_pk_add_f32 v[74:75], v[74:75], v[82:83]
    v_pk_add_f32 v[76:77], v[76:77], v[82:83]
    v_pk_add_f32 v[78:79], v[78:79], v[82:83]
    v_rcp_f32 v64, v64
    v_rcp_f32 v65, v65
    v_rcp_f32 v66, v66
    v_rcp_f32 v67, v67
    v_rcp_f32 v68, v68
    v_rcp_f32 v69, v69
    v_rcp_f32 v70, v70
    v_rcp_f32 v71, v71
    v_rcp_f32 v72, v72
    v_rcp_f32 v73, v73
    v_rcp_f32 v74, v74
    v_rcp_f32 v75, v75
    v_rcp_f32 v76, v76
    v_rcp_f32 v77, v77
    v_rcp_f32 v78, v78
    v_rcp_f32 v79, v79
    v_pk_mul_f32 v[144:145], v[144:145], v[64:65]
    v_pk_mul_f32 v[146:147], v[146:147], v[66:67]
    v_pk_mul_f32 v[148:149], v[148:149], v[68:69]
    v_pk_mul_f32 v[150:151], v[150:151], v[70:71]
    v_pk_mul_f32 v[152:153], v[152:153], v[72:73]
    v_pk_mul_f32 v[154:155], v[154:155], v[74:75]
    v_pk_mul_f32 v[156:157], v[156:157], v[76:77]
    v_pk_mul_f32 v[158:159], v[158:159], v[78:79]
    v_pk_add_f32 v[64:65], v[128:129], v[130:131]
    v_pk_mul_f32 v[66:67], v[128:129], v[128:129]
    v_pk_fma_f32 v[66:67], v[130:131], v[130:131], v[66:67]
    v_pk_add_f32 v[64:65], v[64:65], v[132:133]
    v_pk_fma_f32 v[66:67], v[132:133], v[132:133], v[66:67]
    v_pk_add_f32 v[64:65], v[64:65], v[134:135]
    v_pk_fma_f32 v[66:67], v[134:135], v[134:135], v[66:67]
    v_pk_add_f32 v[64:65], v[64:65], v[136:137]
    v_pk_fma_f32 v[66:67], v[136:137], v[136:137], v[66:67]
    v_pk_add_f32 v[64:65], v[64:65], v[138:139]
    v_pk_fma_f32 v[66:67], v[138:139], v[138:139], v[66:67]
    v_pk_add_f32 v[64:65], v[64:65], v[140:141]
    v_pk_fma_f32 v[66:67], v[140:141], v[140:141], v[66:67]
    v_pk_add_f32 v[64:65], v[64:65], v[142:143]
    v_pk_fma_f32 v[66:67], v[142:143], v[142:143], v[66:67]
    v_add_f32 v72, v64, v65
    v_add_f32 v73, v66, v67
    v_pk_add_f32 v[68:69], v[144:145], v[146:147]
    v_pk_mul_f32 v[70:71], v[144:145], v[144:145]
    v_pk_fma_f32 v[70:71], v[146:147], v[146:147], v[70:71]
    v_pk_add_f32 v[68:69], v[68:69], v[148:149]
    v_pk_fma_f32 v[70:71], v[148:149], v[148:149], v[70:71]
    v_pk_add_f32 v[68:69], v[68:69], v[150:151]
    v_pk_fma_f32 v[70:71], v[150:151], v[150:151], v[70:71]
    v_pk_add_f32 v[68:69], v[68:69], v[152:153]
    v_pk_fma_f32 v[70:71], v[152:153], v[152:153], v[70:71]
    v_pk_add_f32 v[68:69], v[68:69], v[154:155]
    v_pk_fma_f32 v[70:71], v[154:155], v[154:155], v[70:71]
    v_pk_add_f32 v[68:69], v[68:69], v[156:157]
    v_pk_fma_f32 v[70:71], v[156:157], v[156:157], v[70:71]
    v_pk_add_f32 v[68:69], v[68:69], v[158:159]
    v_pk_fma_f32 v[70:71], v[158:159], v[158:159], v[70:71]
    v_add_f32 v74, v68, v69
    v_add_f32 v75, v70, v71
    s_cmp_lg_u32 s53, 0
    s_cbranch_scc1 L_p4v_67
    v_mov_b32 v72, 0
    v_mov_b32 v73, 0
    v_mov_b32 v74, 0
    v_mov_b32 v75, 0
L_p4v_67:
    s_lshl_b32 s46, s3, 10
    s_add_u32 s46, s46, 114688
    v_lshlrev_b32 v64, 3, v1
    v_add_u32 v64, s46, v64
    ds_write_b64 v64, v[72:73]
    ds_write_b64 v64, v[74:75] offset:512
    s_waitcnt lgkmcnt(0)
    s_barrier
    s_cmp_lg_u32 s3, 0
    s_cbranch_scc1 L_z2w_68
    v_lshlrev_b32 v64, 9, v3
    v_lshl_add_u32 v64, v2, 3, v64
    v_add_u32 v64, 114688, v64
    ds_read_b64 v[66:67], v64 offset:0
    ds_read_b64 v[68:69], v64 offset:256
    ds_read_b64 v[70:71], v64 offset:1024
    ds_read_b64 v[72:73], v64 offset:1280
    ds_read_b64 v[74:75], v64 offset:2048
    ds_read_b64 v[76:77], v64 offset:2304
    ds_read_b64 v[78:79], v64 offset:3072
    ds_read_b64 v[80:81], v64 offset:3328
    s_lshl_b32 s46, s42, 3
    s_add_u32 s46, s46, s43
    s_lshl_b32 s46, s46, 10
    s_add_u32 s46, s46, 24117248
    s_waitcnt lgkmcnt(0)
    v_add_f32 v66, v66, v68
    v_add_f32 v67, v67, v69
    v_add_f32 v66, v66, v70
    v_add_f32 v67, v67, v71
    v_add_f32 v66, v66, v72
    v_add_f32 v67, v67, v73
    v_add_f32 v66, v66, v74
    v_add_f32 v67, v67, v75
    v_add_f32 v66, v66, v76
    v_add_f32 v67, v67, v77
    v_add_f32 v66, v66, v78
    v_add_f32 v67, v67, v79
    v_add_f32 v66, v66, v80
    v_add_f32 v67, v67, v81
    v_mov_b32 v68, 1.0
    v_mov_b32 v69, 0
    v_lshlrev_b32 v64, 4, v1
    v_add_u32 v64, s46, v64
    global_store_dwordx4 v64, v[66:69], s[40:41] sc1
L_z2w_68:
    s_waitcnt lgkmcnt(0)
    v_mfma_f32_32x32x16_bf16 v[160:175], v[16:19], v[8:11], v[160:175]
    ds_read_b128 v[44:47], v56 offset:3072
    ds_read_b64_tr_b16 v[52:53], v60 offset:12288
    v_mfma_f32_32x32x16_bf16 v[176:191], v[16:19], v[12:15], v[176:191]
    ds_read_b64_tr_b16 v[54:55], v60 offset:14336
    ds_read_b128 v[48:51], v56 offset:35840
    s_waitcnt lgkmcnt(8)
    s_barrier
    v_mfma_f32_32x32x16_bf16 v[160:175], v[28:31], v[20:23], v[160:175]
    ds_read_b128 v[8:11], v56 offset:4096
    ds_read_b64_tr_b16 v[16:17], v61 offset:0
    v_mfma_f32_32x32x16_bf16 v[176:191], v[28:31], v[24:27], v[176:191]
    ds_read_b64_tr_b16 v[18:19], v61 offset:2048
    ds_read_b128 v[12:15], v56 offset:36864
    s_waitcnt lgkmcnt(8)
    v_mfma_f32_32x32x16_bf16 v[160:175], v[40:43], v[32:35], v[160:175]
    ds_read_b128 v[20:23], v56 offset:5120
    ds_read_b64_tr_b16 v[28:29], v61 offset:4096
    v_mfma_f32_32x32x16_bf16 v[176:191], v[40:43], v[36:39], v[176:191]
    ds_read_b64_tr_b16 v[30:31], v61 offset:6144
    ds_read_b128 v[24:27], v56 offset:37888
    s_waitcnt lgkmcnt(8)
    v_mfma_f32_32x32x16_bf16 v[160:175], v[52:55], v[44:47], v[160:175]
    ds_read_b128 v[32:35], v56 offset:6144
    ds_read_b64_tr_b16 v[40:41], v61 offset:8192
    v_mfma_f32_32x32x16_bf16 v[176:191], v[52:55], v[48:51], v[176:191]
    ds_read_b64_tr_b16 v[42:43], v61 offset:10240
    ds_read_b128 v[36:39], v56 offset:38912
    s_waitcnt lgkmcnt(8)
    v_mfma_f32_32x32x16_bf16 v[160:175], v[16:19], v[8:11], v[160:175]
    ds_read_b128 v[44:47], v56 offset:7168
    ds_read_b64_tr_b16 v[52:53], v61 offset:12288
    v_mfma_f32_32x32x16_bf16 v[176:191], v[16:19], v[12:15], v[176:191]
    ds_read_b64_tr_b16 v[54:55], v61 offset:14336
    ds_read_b128 v[48:51], v56 offset:39936
    s_waitcnt lgkmcnt(8)
    s_barrier
    v_mfma_f32_32x32x16_bf16 v[160:175], v[28:31], v[20:23], v[160:175]
    ds_read_b128 v[8:11], v56 offset:8192
    ds_read_b64_tr_b16 v[16:17], v57 offset:0
    v_mfma_f32_32x32x16_bf16 v[176:191], v[28:31], v[24:27], v[176:191]
    ds_read_b64_tr_b16 v[18:19], v57 offset:2048
    ds_read_b128 v[12:15], v56 offset:40960
    s_waitcnt lgkmcnt(8)
    v_mfma_f32_32x32x16_bf16 v[160:175], v[40:43], v[32:35], v[160:175]
    ds_read_b128 v[20:23], v56 offset:9216
    ds_read_b64_tr_b16 v[28:29], v57 offset:4096
    v_mfma_f32_32x32x16_bf16 v[176:191], v[40:43], v[36:39], v[176:191]
    ds_read_b64_tr_b16 v[30:31], v57 offset:6144
    ds_read_b128 v[24:27], v56 offset:41984
    s_waitcnt lgkmcnt(8)
    v_mfma_f32_32x32x16_bf16 v[160:175], v[52:55], v[44:47], v[160:175]
    ds_read_b128 v[32:35], v56 offset:10240
    ds_read_b64_tr_b16 v[40:41], v57 offset:8192
    v_mfma_f32_32x32x16_bf16 v[176:191], v[52:55], v[48:51], v[176:191]
    ds_read_b64_tr_b16 v[42:43], v57 offset:10240
    ds_read_b128 v[36:39], v56 offset:43008
    s_waitcnt lgkmcnt(8)
    v_mfma_f32_32x32x16_bf16 v[160:175], v[16:19], v[8:11], v[160:175]
    ds_read_b128 v[44:47], v56 offset:11264
    ds_read_b64_tr_b16 v[52:53], v57 offset:12288
    v_mfma_f32_32x32x16_bf16 v[176:191], v[16:19], v[12:15], v[176:191]
    ds_read_b64_tr_b16 v[54:55], v57 offset:14336
    ds_read_b128 v[48:51], v56 offset:44032
    s_waitcnt lgkmcnt(8)
    s_barrier
    v_mfma_f32_32x32x16_bf16 v[160:175], v[28:31], v[20:23], v[160:175]
    ds_read_b128 v[8:11], v56 offset:12288
    ds_read_b64_tr_b16 v[16:17], v58 offset:0
    v_mfma_f32_32x32x16_bf16 v[176:191], v[28:31], v[24:27], v[176:191]
    ds_read_b64_tr_b16 v[18:19], v58 offset:2048
    ds_read_b128 v[12:15], v56 offset:45056
    s_waitcnt lgkmcnt(8)
    v_mfma_f32_32x32x16_bf16 v[160:175], v[40:43], v[32:35], v[160:175]
    ds_read_b128 v[20:23], v56 offset:13312
    ds_read_b64_tr_b16 v[28:29], v58 offset:4096
    v_mfma_f32_32x32x16_bf16 v[176:191], v[40:43], v[36:39], v[176:191]
    ds_read_b64_tr_b16 v[30:31], v58 offset:6144
    ds_read_b128 v[24:27], v56 offset:46080
    s_waitcnt lgkmcnt(8)
    v_mfma_f32_32x32x16_bf16 v[160:175], v[52:55], v[44:47], v[160:175]
    ds_read_b128 v[32:35], v56 offset:14336
    ds_read_b64_tr_b16 v[40:41], v58 offset:8192
    v_mfma_f32_32x32x16_bf16 v[176:191], v[52:55], v[48:51], v[176:191]
    ds_read_b64_tr_b16 v[42:43], v58 offset:10240
    ds_read_b128 v[36:39], v56 offset:47104
    s_waitcnt lgkmcnt(8)
    v_mfma_f32_32x32x16_bf16 v[160:175], v[16:19], v[8:11], v[160:175]
    ds_read_b128 v[44:47], v56 offset:15360
    ds_read_b64_tr_b16 v[52:53], v58 offset:12288
    v_mfma_f32_32x32x16_bf16 v[176:191], v[16:19], v[12:15], v[176:191]
    ds_read_b64_tr_b16 v[54:55], v58 offset:14336
    ds_read_b128 v[48:51], v56 offset:48128
    s_waitcnt lgkmcnt(8)
    s_barrier
    v_mfma_f32_32x32x16_bf16 v[160:175], v[28:31], v[20:23], v[160:175]
    ds_read_b128 v[8:11], v56 offset:16384
    ds_read_b64_tr_b16 v[16:17], v59 offset:0
    v_mfma_f32_32x32x16_bf16 v[176:191], v[28:31], v[24:27], v[176:191]
    ds_read_b64_tr_b16 v[18:19], v59 offset:2048
    ds_read_b128 v[12:15], v56 offset:49152
    s_waitcnt lgkmcnt(8)
    v_mfma_f32_32x32x16_bf16 v[160:175], v[40:43], v[32:35], v[160:175]
    ds_read_b128 v[20:23], v56 offset:17408
    ds_read_b64_tr_b16 v[28:29], v59 offset:4096
    v_mfma_f32_32x32x16_bf16 v[176:191], v[40:43], v[36:39], v[176:191]
    ds_read_b64_tr_b16 v[30:31], v59 offset:6144
    ds_read_b128 v[24:27], v56 offset:50176
    s_waitcnt lgkmcnt(8)
    v_mfma_f32_32x32x16_bf16 v[160:175], v[52:55], v[44:47], v[160:175]
    ds_read_b128 v[32:35], v56 offset:18432
    ds_read_b64_tr_b16 v[40:41], v59 offset:8192
    v_mfma_f32_32x32x16_bf16 v[176:191], v[52:55], v[48:51], v[176:191]
    ds_read_b64_tr_b16 v[42:43], v59 offset:10240
    ds_read_b128 v[36:39], v56 offset:51200
    s_waitcnt lgkmcnt(8)
    v_mfma_f32_32x32x16_bf16 v[160:175], v[16:19], v[8:11], v[160:175]
    ds_read_b128 v[44:47], v56 offset:19456
    ds_read_b64_tr_b16 v[52:53], v59 offset:12288
    v_mfma_f32_32x32x16_bf16 v[176:191], v[16:19], v[12:15], v[176:191]
    ds_read_b64_tr_b16 v[54:55], v59 offset:14336
    ds_read_b128 v[48:51], v56 offset:52224
    s_waitcnt lgkmcnt(8)
    s_barrier
    v_mfma_f32_32x32x16_bf16 v[160:175], v[28:31], v[20:23], v[160:175]
    ds_read_b128 v[8:11], v56 offset:20480
    ds_read_b64_tr_b16 v[16:17], v60 offset:0
    v_mfma_f32_32x32x16_bf16 v[176:191], v[28:31], v[24:27], v[176:191]
    ds_read_b64_tr_b16 v[18:19], v60 offset:2048
    ds_read_b128 v[12:15], v56 offset:53248
    s_waitcnt lgkmcnt(8)
    v_mfma_f32_32x32x16_bf16 v[160:175], v[40:43], v[32:35], v[160:175]
    ds_read_b128 v[20:23], v56 offset:21504
    ds_read_b64_tr_b16 v[28:29], v60 offset:4096
    v_mfma_f32_32x32x16_bf16 v[176:191], v[40:43], v[36:39], v[176:191]
    ds_read_b64_tr_b16 v[30:31], v60 offset:6144
    ds_read_b128 v[24:27], v56 offset:54272
    s_waitcnt lgkmcnt(8)
    v_mfma_f32_32x32x16_bf16 v[160:175], v[52:55], v[44:47], v[160:175]
    ds_read_b128 v[32:35], v56 offset:22528
    ds_read_b64_tr_b16 v[40:41], v60 offset:8192
    v_mfma_f32_32x32x16_bf16 v[176:191], v[52:55], v[48:51], v[176:191]
    ds_read_b64_tr_b16 v[42:43], v60 offset:10240
    ds_read_b128 v[36:39], v56 offset:55296
    s_waitcnt lgkmcnt(8)
    v_mfma_f32_32x32x16_bf16 v[160:175], v[16:19], v[8:11], v[160:175]
    ds_read_b128 v[44:47], v56 offset:23552
    ds_read_b64_tr_b16 v[52:53], v60 offset:12288
    v_mfma_f32_32x32x16_bf16 v[176:191], v[16:19], v[12:15], v[176:191]
    ds_read_b64_tr_b16 v[54:55], v60 offset:14336
    ds_read_b128 v[48:51], v56 offset:56320
    s_waitcnt lgkmcnt(8)
    s_barrier
    v_mfma_f32_32x32x16_bf16 v[160:175], v[28:31], v[20:23], v[160:175]
    ds_read_b128 v[8:11], v56 offset:24576
    ds_read_b64_tr_b16 v[16:17], v61 offset:0
    v_mfma_f32_32x32x16_bf16 v[176:191], v[28:31], v[24:27], v[176:191]
    ds_read_b64_tr_b16 v[18:19], v61 offset:2048
    ds_read_b128 v[12:15], v56 offset:57344
    s_waitcnt lgkmcnt(8)
    v_mfma_f32_32x32x16_bf16 v[160:175], v[40:43], v[32:35], v[160:175]
    ds_read_b128 v[20:23], v56 offset:25600
    ds_read_b64_tr_b16 v[28:29], v61 offset:4096
    v_mfma_f32_32x32x16_bf16 v[176:191], v[40:43], v[36:39], v[176:191]
    ds_read_b64_tr_b16 v[30:31], v61 offset:6144
    ds_read_b128 v[24:27], v56 offset:58368
    s_waitcnt lgkmcnt(8)
    v_mfma_f32_32x32x16_bf16 v[160:175], v[52:55], v[44:47], v[160:175]
    ds_read_b128 v[32:35], v56 offset:26624
    ds_read_b64_tr_b16 v[40:41], v61 offset:8192
    v_mfma_f32_32x32x16_bf16 v[176:191], v[52:55], v[48:51], v[176:191]
    ds_read_b64_tr_b16 v[42:43], v61 offset:10240
    ds_read_b128 v[36:39], v56 offset:59392
    s_waitcnt lgkmcnt(8)
    v_mfma_f32_32x32x16_bf16 v[160:175], v[16:19], v[8:11], v[160:175]
    ds_read_b128 v[44:47], v56 offset:27648
    ds_read_b64_tr_b16 v[52:53], v61 offset:12288
    v_mfma_f32_32x32x16_bf16 v[176:191], v[16:19], v[12:15], v[176:191]
    ds_read_b64_tr_b16 v[54:55], v61 offset:14336
    ds_read_b128 v[48:51], v56 offset:60416
    s_waitcnt lgkmcnt(8)
    s_barrier
    v_mfma_f32_32x32x16_bf16 v[160:175], v[28:31], v[20:23], v[160:175]
    ds_read_b128 v[8:11], v56 offset:28672
    ds_read_b64_tr_b16 v[16:17], v57 offset:0
    v_mfma_f32_32x32x16_bf16 v[176:191], v[28:31], v[24:27], v[176:191]
    ds_read_b64_tr_b16 v[18:19], v57 offset:2048
    ds_read_b128 v[12:15], v56 offset:61440
    s_waitcnt lgkmcnt(8)
    v_mfma_f32_32x32x16_bf16 v[160:175], v[40:43], v[32:35], v[160:175]
    ds_read_b128 v[20:23], v56 offset:29696
    ds_read_b64_tr_b16 v[28:29], v57 offset:4096
    v_mfma_f32_32x32x16_bf16 v[176:191], v[40:43], v[36:39], v[176:191]
    ds_read_b64_tr_b16 v[30:31], v57 offset:6144
    ds_read_b128 v[24:27], v56 offset:62464
    s_waitcnt lgkmcnt(8)
    v_mfma_f32_32x32x16_bf16 v[160:175], v[52:55], v[44:47], v[160:175]
    ds_read_b128 v[32:35], v56 offset:30720
    ds_read_b64_tr_b16 v[40:41], v57 offset:8192
    v_mfma_f32_32x32x16_bf16 v[176:191], v[52:55], v[48:51], v[176:191]
    ds_read_b64_tr_b16 v[42:43], v57 offset:10240
    ds_read_b128 v[36:39], v56 offset:63488
    s_waitcnt lgkmcnt(8)
    v_mfma_f32_32x32x16_bf16 v[160:175], v[16:19], v[8:11], v[160:175]
    ds_read_b128 v[44:47], v56 offset:31744
    ds_read_b64_tr_b16 v[52:53], v57 offset:12288
    v_mfma_f32_32x32x16_bf16 v[176:191], v[16:19], v[12:15], v[176:191]
    ds_read_b64_tr_b16 v[54:55], v57 offset:14336
    ds_read_b128 v[48:51], v56 offset:64512
    s_waitcnt lgkmcnt(8)
    v_mfma_f32_32x32x16_bf16 v[160:175], v[28:31], v[20:23], v[160:175]
    v_mfma_f32_32x32x16_bf16 v[176:191], v[28:31], v[24:27], v[176:191]
    s_waitcnt lgkmcnt(4)
    v_mfma_f32_32x32x16_bf16 v[160:175], v[40:43], v[32:35], v[160:175]
    v_mfma_f32_32x32x16_bf16 v[176:191], v[40:43], v[36:39], v[176:191]
    s_waitcnt lgkmcnt(0)
    v_mfma_f32_32x32x16_bf16 v[160:175], v[52:55], v[44:47], v[160:175]
    v_mfma_f32_32x32x16_bf16 v[176:191], v[52:55], v[48:51], v[176:191]
    s_barrier
    s_lshl_b32 s46, s42, 13
    s_add_u32 s46, s46, 24117248
    v_lshlrev_b32 v5, 4, v2
    v_add_u32 v5, s46, v5
    v_add_u32 v6, 4096, v5
    s_mov_b32 s60, 0x100000
L_zpoll_69:
    global_load_dwordx4 v[8:11], v5, s[40:41] offset:0 sc1
    global_load_dwordx4 v[12:15], v5, s[40:41] offset:1024 sc1
    global_load_dwordx4 v[16:19], v5, s[40:41] offset:2048 sc1
    global_load_dwordx4 v[20:23], v5, s[40:41] offset:3072 sc1
    global_load_dwordx4 v[24:27], v6, s[40:41] offset:0 sc1
    global_load_dwordx4 v[28:31], v6, s[40:41] offset:1024 sc1
    global_load_dwordx4 v[32:35], v6, s[40:41] offset:2048 sc1
    global_load_dwordx4 v[36:39], v6, s[40:41] offset:3072 sc1
    global_load_dwordx4 v[40:43], v5, s[40:41] offset:512 sc1
    global_load_dwordx4 v[44:47], v5, s[40:41] offset:1536 sc1
    global_load_dwordx4 v[48:51], v5, s[40:41] offset:2560 sc1
    global_load_dwordx4 v[52:55], v5, s[40:41] offset:3584 sc1
    global_load_dwordx4 v[56:59], v6, s[40:41] offset:512 sc1
    global_load_dwordx4 v[60:63], v6, s[40:41] offset:1536 sc1
    global_load_dwordx4 v[64:67], v6, s[40:41] offset:2560 sc1
    global_load_dwordx4 v[68:71], v6, s[40:41] offset:3584 sc1
    s_sub_u32 s60, s60, 1
    s_cbranch_scc1 L_zpoll_69_out
    s_waitcnt vmcnt(0)
    v_and_b32 v4, v10, v14
    v_and_b32 v4, v4, v18
    v_and_b32 v4, v4, v22
    v_and_b32 v4, v4, v26
    v_and_b32 v4, v4, v30
    v_and_b32 v4, v4, v34
    v_and_b32 v4, v4, v38
    v_and_b32 v4, v4, v42
    v_and_b32 v4, v4, v46
    v_and_b32 v4, v4, v50
    v_and_b32 v4, v4, v54
    v_and_b32 v4, v4, v58
    v_and_b32 v4, v4, v62
    v_and_b32 v4, v4, v66
    v_and_b32 v4, v4, v70
    v_cmp_ne_u32 vcc, 1.0, v4
    s_cbranch_vccnz L_zpoll_69
L_zpoll_69_out:
    s_waitcnt vmcnt(0)
    v_add_f32 v8, v8, v12
    v_add_f32 v9, v9, v13
    v_add_f32 v8, v8, v16
    v_add_f32 v9, v9, v17
    v_add_f32 v8, v8, v20
    v_add_f32 v9, v9, v21
    v_add_f32 v8, v8, v24
    v_add_f32 v9, v9, v25
    v_add_f32 v8, v8, v28
    v_add_f32 v9, v9, v29
    v_add_f32 v8, v8, v32
    v_add_f32 v9, v9, v33
    v_add_f32 v8, v8, v36
    v_add_f32 v9, v9, v37
    v_add_f32 v40, v40, v44
    v_add_f32 v41, v41, v45
    v_add_f32 v40, v40, v48
    v_add_f32 v41, v41, v49
    v_add_f32 v40, v40, v52
    v_add_f32 v41, v41, v53
    v_add_f32 v40, v40, v56
    v_add_f32 v41, v41, v57
    v_add_f32 v40, v40, v60
    v_add_f32 v41, v41, v61
    v_add_f32 v40, v40, v64
    v_add_f32 v41, v41, v65
    v_add_f32 v40, v40, v68
    v_add_f32 v41, v41, v69
    v_mov_b32 v72, v8
    v_mov_b32 v73, v40
    v_mov_b32 v74, v9
    v_mov_b32 v75, v41
    v_mul_f32 v72, 0x3a924925, v72
    v_mul_f32 v74, 0x3a924925, v74
    v_mul_f32 v73, 0x3a924925, v73
    v_mul_f32 v75, 0x3a924925, v75
    v_fma_f32 v74, -v72, v72, v74
    v_fma_f32 v75, -v73, v73, v75
    v_max_f32 v74, 0, v74
    v_max_f32 v75, 0, v75
    v_add_f32 v74, 0x3727c5ac, v74
    v_add_f32 v75, 0x3727c5ac, v75
    v_rsq_f32 v76, v74
    v_rsq_f32 v77, v75
    s_nop 0
    v_mul_f32 v78, v72, v76
    v_mul_f32 v79, v73, v77
    v_sub_f32 v78, 0, v78
    v_sub_f32 v79, 0, v79
    s_cmp_eq_u32 s53, 0
    s_cbranch_scc1 L_p4sk_70
    v_fma_f32 v128, v128, v76, v78
    v_fma_f32 v129, v129, v76, v78
    v_fma_f32 v130, v130, v76, v78
    v_fma_f32 v131, v131, v76, v78
    v_fma_f32 v132, v132, v76, v78
    v_fma_f32 v133, v133, v76, v78
    v_fma_f32 v134, v134, v76, v78
    v_fma_f32 v135, v135, v76, v78
    v_fma_f32 v136, v136, v76, v78
    v_fma_f32 v137, v137, v76, v78
    v_fma_f32 v138, v138, v76, v78
    v_fma_f32 v139, v139, v76, v78
    v_fma_f32 v140, v140, v76, v78
    v_fma_f32 v141, v141, v76, v78
    v_fma_f32 v142, v142, v76, v78
    v_fma_f32 v143, v143, v76, v78
    v_fma_f32 v144, v144, v77, v79
    v_fma_f32 v145, v145, v77, v79
    v_fma_f32 v146, v146, v77, v79
    v_fma_f32 v147, v147, v77, v79
    v_fma_f32 v148, v148, v77, v79
    v_fma_f32 v149, v149, v77, v79
    v_fma_f32 v150, v150, v77, v79
    v_fma_f32 v151, v151, v77, v79
    v_fma_f32 v152, v152, v77, v79
    v_fma_f32 v153, v153, v77, v79
    v_fma_f32 v154, v154, v77, v79
    v_fma_f32 v155, v155, v77, v79
    v_fma_f32 v156, v156, v77, v79
    v_fma_f32 v157, v157, v77, v79
    v_fma_f32 v158, v158, v77, v79
    v_fma_f32 v159, v159, v77, v79
    v_cvt_pk_bf16_f32 v16, v128, v129
    v_cvt_pk_bf16_f32 v17, v130, v131
    v_cvt_pk_bf16_f32 v18, v132, v133
    v_cvt_pk_bf16_f32 v19, v134, v135
    v_cvt_pk_bf16_f32 v20, v136, v137
    v_cvt_pk_bf16_f32 v21, v138, v139
    v_cvt_pk_bf16_f32 v22, v140, v141
    v_cvt_pk_bf16_f32 v23, v142, v143
    v_cvt_pk_bf16_f32 v24, v144, v145
    v_cvt_pk_bf16_f32 v25, v146, v147
    v_cvt_pk_bf16_f32 v26, v148, v149
    v_cvt_pk_bf16_f32 v27, v150, v151
    v_cvt_pk_bf16_f32 v28, v152, v153
    v_cvt_pk_bf16_f32 v29, v154, v155
    v_cvt_pk_bf16_f32 v30, v156, v157
    v_cvt_pk_bf16_f32 v31, v158, v159
    v_permlane32_swap_b32 v16, v18
    v_permlane32_swap_b32 v17, v19
    v_permlane32_swap_b32 v20, v22
    v_permlane32_swap_b32 v21, v23
    v_permlane32_swap_b32 v24, v26
    v_permlane32_swap_b32 v25, v27
    v_permlane32_swap_b32 v28, v30
    v_permlane32_swap_b32 v29, v31
    s_lshl_b32 s46, s3, 12
    v_lshlrev_b32 v7, 6, v2
    v_lshl_add_u32 v7, v3, 4, v7
    v_add_u32 v7, s46, v7
    ds_write_b128 v7, v[16:19]
    ds_write_b128 v7, v[20:23] offset:32
    ds_write_b128 v7, v[24:27] offset:2048
    ds_write_b128 v7, v[28:31] offset:2080
    v_bfe_u32 v5, v1, 2, 2
    v_lshl_add_u32 v5, v3, 3, v5
    v_lshlrev_b32 v5, 6, v5
    v_bfe_u32 v6, v1, 4, 1
    v_lshl_add_u32 v5, v6, 5, v5
    v_and_b32 v6, 3, v1
    v_lshl_add_u32 v5, v6, 3, v5
    v_add_u32 v5, s46, v5
    s_waitcnt lgkmcnt(0)
    ds_read_b64_tr_b16 v[32:33], v5 offset:0
    ds_read_b64_tr_b16 v[34:35], v5 offset:256
    ds_read_b64_tr_b16 v[36:37], v5 offset:1024
    ds_read_b64_tr_b16 v[38:39], v5 offset:1280
    ds_read_b64_tr_b16 v[40:41], v5 offset:2048
    ds_read_b64_tr_b16 v[42:43], v5 offset:2304
    ds_read_b64_tr_b16 v[44:45], v5 offset:3072
    ds_read_b64_tr_b16 v[46:47], v5 offset:3328
    s_add_u32 s46, s52, s3
    s_lshl_b32 s46, s46, 7
    s_lshl_b32 s47, s42, 2
    s_add_u32 s46, s46, s47
    s_lshl_b32 s46, s46, 10
    s_add_u32 s46, s46, 15728640
    v_lshlrev_b32 v6, 4, v1
    v_add_u32 v6, s46, v6
    s_waitcnt lgkmcnt(0)
    global_store_dwordx4 v6, v[32:35], s[40:41] offset:0 sc1
    global_store_dwordx4 v6, v[36:39], s[40:41] offset:1024 sc1
    global_store_dwordx4 v6, v[40:43], s[40:41] offset:2048 sc1
    global_store_dwordx4 v6, v[44:47], s[40:41] offset:3072 sc1
L_p4sk_70:
    s_mov_b32 s48, 0xbdd2d3e8
    s_mov_b32 s49, s48
    v_mov_b32 v80, 0xc0135761
    v_mov_b32 v81, 0xc0135761
    v_mov_b32 v82, 1.0
    v_mov_b32 v83, 1.0
    v_pk_mul_f32 v[64:65], v[160:161], v[160:161]
    v_pk_mul_f32 v[66:67], v[162:163], v[162:163]
    v_pk_mul_f32 v[68:69], v[164:165], v[164:165]
    v_pk_mul_f32 v[70:71], v[166:167], v[166:167]
    v_pk_mul_f32 v[72:73], v[168:169], v[168:169]
    v_pk_mul_f32 v[74:75], v[170:171], v[170:171]
    v_pk_mul_f32 v[76:77], v[172:173], v[172:173]
    v_pk_mul_f32 v[78:79], v[174:175], v[174:175]
    v_pk_fma_f32 v[64:65], v[64:65], s[48:49], v[80:81]
    v_pk_fma_f32 v[66:67], v[66:67], s[48:49], v[80:81]
    v_pk_fma_f32 v[68:69], v[68:69], s[48:49], v[80:81]
    v_pk_fma_f32 v[70:71], v[70:71], s[48:49], v[80:81]
    v_pk_fma_f32 v[72:73], v[72:73], s[48:49], v[80:81]
    v_pk_fma_f32 v[74:75], v[74:75], s[48:49], v[80:81]
    v_pk_fma_f32 v[76:77], v[76:77], s[48:49], v[80:81]
    v_pk_fma_f32 v[78:79], v[78:79], s[48:49], v[80:81]
    v_pk_mul_f32 v[64:65], v[64:65], v[160:161]
    v_pk_mul_f32 v[66:67], v[66:67], v[162:163]
    v_pk_mul_f32 v[68:69], v[68:69], v[164:165]
    v_pk_mul_f32 v[70:71], v[70:71], v[166:167]
    v_pk_mul_f32 v[72:73], v[72:73], v[168:169]
    v_pk_mul_f32 v[74:75], v[74:75], v[170:171]
    v_pk_mul_f32 v[76:77], v[76:77], v[172:173]
    v_pk_mul_f32 v[78:79], v[78:79], v[174:175]
    v_exp_f32 v64, v64
    v_exp_f32 v65, v65
    v_exp_f32 v66, v66
    v_exp_f32 v67, v67
    v_exp_f32 v68, v68
    v_exp_f32 v69, v69
    v_exp_f32 v70, v70
    v_exp_f32 v71, v71
    v_exp_f32 v72, v72
    v_exp_f32 v73, v73
    v_exp_f32 v74, v74
    v_exp_f32 v75, v75
    v_exp_f32 v76, v76
    v_exp_f32 v77, v77
    v_exp_f32 v78, v78
    v_exp_f32 v79, v79
    v_pk_add_f32 v[64:65], v[64:65], v[82:83]
    v_pk_add_f32 v[66:67], v[66:67], v[82:83]
    v_pk_add_f32 v[68:69], v[68:69], v[82:83]
    v_pk_add_f32 v[70:71], v[70:71], v[82:83]
    v_pk_add_f32 v[72:73], v[72:73], v[82:83]
    v_pk_add_f32 v[74:75], v[74:75], v[82:83]
    v_pk_add_f32 v[76:77], v[76:77], v[82:83]
    v_pk_add_f32 v[78:79], v[78:79], v[82:83]
    v_rcp_f32 v64, v64
    v_rcp_f32 v65, v65
    v_rcp_f32 v66, v66
    v_rcp_f32 v67, v67
    v_rcp_f32 v68, v68
    v_rcp_f32 v69, v69
    v_rcp_f32 v70, v70
    v_rcp_f32 v71, v71
    v_rcp_f32 v72, v72
    v_rcp_f32 v73, v73
    v_rcp_f32 v74, v74
    v_rcp_f32 v75, v75
    v_rcp_f32 v76, v76
    v_rcp_f32 v77, v77
    v_rcp_f32 v78, v78
    v_rcp_f32 v79, v79
    v_pk_mul_f32 v[160:161], v[160:161], v[64:65]
    v_pk_mul_f32 v[162:163], v[162:163], v[66:67]
    v_pk_mul_f32 v[164:165], v[164:165], v[68:69]
    v_pk_mul_f32 v[166:167], v[166:167], v[70:71]
    v_pk_mul_f32 v[168:169], v[168:169], v[72:73]
    v_pk_mul_f32 v[170:171], v[170:171], v[74:75]
    v_pk_mul_f32 v[172:173], v[172:173], v[76:77]
    v_pk_mul_f32 v[174:175], v[174:175], v[78:79]
    v_pk_mul_f32 v[64:65], v[176:177], v[176:177]
    v_pk_mul_f32 v[66:67], v[178:179], v[178:179]
    v_pk_mul_f32 v[68:69], v[180:181], v[180:181]
    v_pk_mul_f32 v[70:71], v[182:183], v[182:183]
    v_pk_mul_f32 v[72:73], v[184:185], v[184:185]
    v_pk_mul_f32 v[74:75], v[186:187], v[186:187]
    v_pk_mul_f32 v[76:77], v[188:189], v[188:189]
    v_pk_mul_f32 v[78:79], v[190:191], v[190:191]
    v_pk_fma_f32 v[64:65], v[64:65], s[48:49], v[80:81]
    v_pk_fma_f32 v[66:67], v[66:67], s[48:49], v[80:81]
    v_pk_fma_f32 v[68:69], v[68:69], s[48:49], v[80:81]
    v_pk_fma_f32 v[70:71], v[70:71], s[48:49], v[80:81]
    v_pk_fma_f32 v[72:73], v[72:73], s[48:49], v[80:81]
    v_pk_fma_f32 v[74:75], v[74:75], s[48:49], v[80:81]
    v_pk_fma_f32 v[76:77], v[76:77], s[48:49], v[80:81]
    v_pk_fma_f32 v[78:79], v[78:79], s[48:49], v[80:81]
    v_pk_mul_f32 v[64:65], v[64:65], v[176:177]
    v_pk_mul_f32 v[66:67], v[66:67], v[178:179]
    v_pk_mul_f32 v[68:69], v[68:69], v[180:181]
    v_pk_mul_f32 v[70:71], v[70:71], v[182:183]
    v_pk_mul_f32 v[72:73], v[72:73], v[184:185]
    v_pk_mul_f32 v[74:75], v[74:75], v[186:187]
    v_pk_mul_f32 v[76:77], v[76:77], v[188:189]
    v_pk_mul_f32 v[78:79], v[78:79], v[190:191]
    v_exp_f32 v64, v64
    v_exp_f32 v65, v65
    v_exp_f32 v66, v66
    v_exp_f32 v67, v67
    v_exp_f32 v68, v68
    v_exp_f32 v69, v69
    v_exp_f32 v70, v70
    v_exp_f32 v71, v71
    v_exp_f32 v72, v72
    v_exp_f32 v73, v73
    v_exp_f32 v74, v74
    v_exp_f32 v75, v75
    v_exp_f32 v76, v76
    v_exp_f32 v77, v77
    v_exp_f32 v78, v78
    v_exp_f32 v79, v79
    v_pk_add_f32 v[64:65], v[64:65], v[82:83]
    v_pk_add_f32 v[66:67], v[66:67], v[82:83]
    v_pk_add_f32 v[68:69], v[68:69], v[82:83]
    v_pk_add_f32 v[70:71], v[70:71], v[82:83]
    v_pk_add_f32 v[72:73], v[72:73], v[82:83]
    v_pk_add_f32 v[74:75], v[74:75], v[82:83]
    v_pk_add_f32 v[76:77], v[76:77], v[82:83]
    v_pk_add_f32 v[78:79], v[78:79], v[82:83]
    v_rcp_f32 v64, v64
    v_rcp_f32 v65, v65
    v_rcp_f32 v66, v66
    v_rcp_f32 v67, v67
    v_rcp_f32 v68, v68
    v_rcp_f32 v69, v69
    v_rcp_f32 v70, v70
    v_rcp_f32 v71, v71
    v_rcp_f32 v72, v72
    v_rcp_f32 v73, v73
    v_rcp_f32 v74, v74
    v_rcp_f32 v75, v75
    v_rcp_f32 v76, v76
    v_rcp_f32 v77, v77
    v_rcp_f32 v78, v78
    v_rcp_f32 v79, v79
    v_pk_mul_f32 v[176:177], v[176:177], v[64:65]
    v_pk_mul_f32 v[178:179], v[178:179], v[66:67]
    v_pk_mul_f32 v[180:181], v[180:181], v[68:69]
    v_pk_mul_f32 v[182:183], v[182:183], v[70:71]
    v_pk_mul_f32 v[184:185], v[184:185], v[72:73]
    v_pk_mul_f32 v[186:187], v[186:187], v[74:75]
    v_pk_mul_f32 v[188:189], v[188:189], v[76:77]
    v_pk_mul_f32 v[190:191], v[190:191], v[78:79]
    s_cmp_eq_u32 s53, 0
    s_cbranch_scc1 L_p4sk2_71
    v_cvt_pk_bf16_f32 v16, v160, v161
    v_cvt_pk_bf16_f32 v17, v162, v163
    v_cvt_pk_bf16_f32 v18, v164, v165
    v_cvt_pk_bf16_f32 v19, v166, v167
    v_cvt_pk_bf16_f32 v20, v168, v169
    v_cvt_pk_bf16_f32 v21, v170, v171
    v_cvt_pk_bf16_f32 v22, v172, v173
    v_cvt_pk_bf16_f32 v23, v174, v175
    v_cvt_pk_bf16_f32 v24, v176, v177
    v_cvt_pk_bf16_f32 v25, v178, v179
    v_cvt_pk_bf16_f32 v26, v180, v181
    v_cvt_pk_bf16_f32 v27, v182, v183
    v_cvt_pk_bf16_f32 v28, v184, v185
    v_cvt_pk_bf16_f32 v29, v186, v187
    v_cvt_pk_bf16_f32 v30, v188, v189
    v_cvt_pk_bf16_f32 v31, v190, v191
    s_add_u32 s46, s52, s3
    s_lshl_b32 s46, s46, 1
    s_mul_i32 s47, s42, 112
    s_add_u32 s46, s46, s47
    s_lshl_b32 s46, s46, 10
    s_add_u32 s46, s46, 11534336
    v_lshlrev_b32 v5, 4, v1
    v_add_u32 v5, s46, v5
    v_add_u32 v6, 57344, v5
    global_store_dwordx4 v5, v[16:19], s[40:41] sc1
    global_store_dwordx4 v5, v[20:23], s[40:41] offset:1024 sc1
    global_store_dwordx4 v6, v[24:27], s[40:41] sc1
    global_store_dwordx4 v6, v[28:31], s[40:41] offset:1024 sc1
L_p4sk2_71:
    s_waitcnt vmcnt(0)
    s_barrier
    s_cmp_lg_u32 s3, 0
    s_cbranch_scc1 L_p4ar_73
    s_min_u32 s47, s43, 6
    s_lshl_b32 s47, s47, 8
    s_add_u32 s47, s47, 20480
    v_mov_b32 v254, s47
    v_mov_b32 v255, 1
    s_mov_b64 exec, 1
    global_atomic_add v254, v255, s[40:41] sc1
    s_mov_b64 exec, -1
L_p4ar_73:
    s_waitcnt vmcnt(0)
    s_branch L_p4done_66
L_p4load_65:
    s_add_u32 s49, s57, 689920
    s_add_u32 m0, s56, 81920
    s_nop 0
    buffer_load_dwordx4 v240, s[12:15], s49 offen lds
    s_add_u32 m0, s56, 82944
    s_nop 0
    buffer_load_dwordx4 v241, s[12:15], s49 offen lds
    s_add_u32 m0, s56, 83968
    s_nop 0
    buffer_load_dwordx4 v242, s[12:15], s49 offen lds
    s_add_u32 m0, s56, 84992
    s_nop 0
    buffer_load_dwordx4 v243, s[12:15], s49 offen lds
    s_add_u32 s49, s57, 919296
    s_add_u32 m0, s56, 98304
    s_nop 0
    buffer_load_dwordx4 v240, s[12:15], s49 offen lds
    s_add_u32 m0, s56, 99328
    s_nop 0
    buffer_load_dwordx4 v241, s[12:15], s49 offen lds
    s_add_u32 m0, s56, 100352
    s_nop 0
    buffer_load_dwordx4 v242, s[12:15], s49 offen lds
    s_add_u32 m0, s56, 101376
    s_nop 0
    buffer_load_dwordx4 v243, s[12:15], s49 offen lds
    s_waitcnt vmcnt(12)
    s_barrier
    s_waitcnt vmcnt(8)
    s_barrier
    s_add_u32 s49, s57, 1148672
    s_add_u32 m0, s56, 131072
    s_nop 0
    buffer_load_dwordx4 v240, s[12:15], s49 offen lds
    s_add_u32 m0, s56, 132096
    s_nop 0
    buffer_load_dwordx4 v241, s[12:15], s49 offen lds
    s_add_u32 m0, s56, 133120
    s_nop 0
    buffer_load_dwordx4 v242, s[12:15], s49 offen lds
    s_add_u32 m0, s56, 134144
    s_nop 0
    buffer_load_dwordx4 v243, s[12:15], s49 offen lds
    s_waitcnt vmcnt(8)
    s_barrier
    s_add_u32 s49, s57, 1378048
    s_add_u32 m0, s56, 147456
    s_nop 0
    buffer_load_dwordx4 v240, s[12:15], s49 offen lds
    s_add_u32 m0, s56, 148480
    s_nop 0
    buffer_load_dwordx4 v241, s[12:15], s49 offen lds
    s_add_u32 m0, s56, 149504
    s_nop 0
    buffer_load_dwordx4 v242, s[12:15], s49 offen lds
    s_add_u32 m0, s56, 150528
    s_nop 0
    buffer_load_dwordx4 v243, s[12:15], s49 offen lds
    s_waitcnt vmcnt(8)
    s_barrier
    s_add_u32 s49, s57, 1607424
    s_add_u32 m0, s56, 65536
    s_nop 0
    buffer_load_dwordx4 v240, s[12:15], s49 offen lds
    s_add_u32 m0, s56, 66560
    s_nop 0
    buffer_load_dwordx4 v241, s[12:15], s49 offen lds
    s_add_u32 m0, s56, 67584
    s_nop 0
    buffer_load_dwordx4 v242, s[12:15], s49 offen lds
    s_add_u32 m0, s56, 68608
    s_nop 0
    buffer_load_dwordx4 v243, s[12:15], s49 offen lds
    s_waitcnt vmcnt(8)
    s_barrier
    s_add_u32 s49, s57, 0
    s_add_u32 m0, s56, 81920
    s_nop 0
    buffer_load_dwordx4 v240, s[12:15], s49 offen lds
    s_add_u32 m0, s56, 82944
    s_nop 0
    buffer_load_dwordx4 v241, s[12:15], s49 offen lds
    s_add_u32 m0, s56, 83968
    s_nop 0
    buffer_load_dwordx4 v242, s[12:15], s49 offen lds
    s_add_u32 m0, s56, 84992
    s_nop 0
    buffer_load_dwordx4 v243, s[12:15], s49 offen lds
    s_waitcnt vmcnt(8)
    s_barrier
    s_add_u32 s49, s57, 229376
    s_add_u32 m0, s56, 98304
    s_nop 0
    buffer_load_dwordx4 v240, s[12:15], s49 offen lds
    s_add_u32 m0, s56, 99328
    s_nop 0
    buffer_load_dwordx4 v241, s[12:15], s49 offen lds
    s_add_u32 m0, s56, 100352
    s_nop 0
    buffer_load_dwordx4 v242, s[12:15], s49 offen lds
    s_add_u32 m0, s56, 101376
    s_nop 0
    buffer_load_dwordx4 v243, s[12:15], s49 offen lds
    s_waitcnt vmcnt(8)
    s_barrier
    s_add_u32 s49, s57, 458752
    s_add_u32 m0, s56, 131072
    s_nop 0
    buffer_load_dwordx4 v240, s[12:15], s49 offen lds
    s_add_u32 m0, s56, 132096
    s_nop 0
    buffer_load_dwordx4 v241, s[12:15], s49 offen lds
    s_add_u32 m0, s56, 133120
    s_nop 0
    buffer_load_dwordx4 v242, s[12:15], s49 offen lds
    s_add_u32 m0, s56, 134144
    s_nop 0
    buffer_load_dwordx4 v243, s[12:15], s49 offen lds
    s_waitcnt vmcnt(8)
    s_barrier
    s_add_u32 s49, s57, 688128
    s_add_u32 m0, s56, 147456
    s_nop 0
    buffer_load_dwordx4 v240, s[12:15], s49 offen lds
    s_add_u32 m0, s56, 148480
    s_nop 0
    buffer_load_dwordx4 v241, s[12:15], s49 offen lds
    s_add_u32 m0, s56, 149504
    s_nop 0
    buffer_load_dwordx4 v242, s[12:15], s49 offen lds
    s_add_u32 m0, s56, 150528
    s_nop 0
    buffer_load_dwordx4 v243, s[12:15], s49 offen lds
    s_barrier
    s_waitcnt vmcnt(8)
    s_barrier
    s_add_u32 s49, s57, 917504
    s_add_u32 m0, s56, 65536
    s_nop 0
    buffer_load_dwordx4 v240, s[12:15], s49 offen lds
    s_add_u32 m0, s56, 66560
    s_nop 0
    buffer_load_dwordx4 v241, s[12:15], s49 offen lds
    s_add_u32 m0, s56, 67584
    s_nop 0
    buffer_load_dwordx4 v242, s[12:15], s49 offen lds
    s_add_u32 m0, s56, 68608
    s_nop 0
    buffer_load_dwordx4 v243, s[12:15], s49 offen lds
    s_waitcnt vmcnt(8)
    s_barrier
    s_add_u32 s49, s57, 1146880
    s_add_u32 m0, s56, 81920
    s_nop 0
    buffer_load_dwordx4 v240, s[12:15], s49 offen lds
    s_add_u32 m0, s56, 82944
    s_nop 0
    buffer_load_dwordx4 v241, s[12:15], s49 offen lds
    s_add_u32 m0, s56, 83968
    s_nop 0
    buffer_load_dwordx4 v242, s[12:15], s49 offen lds
    s_add_u32 m0, s56, 84992
    s_nop 0
    buffer_load_dwordx4 v243, s[12:15], s49 offen lds
    s_waitcnt vmcnt(8)
    s_barrier
    s_add_u32 s49, s57, 1376256
    s_add_u32 m0, s56, 98304
    s_nop 0
    buffer_load_dwordx4 v240, s[12:15], s49 offen lds
    s_add_u32 m0, s56, 99328
    s_nop 0
    buffer_load_dwordx4 v241, s[12:15], s49 offen lds
    s_add_u32 m0, s56, 100352
    s_nop 0
    buffer_load_dwordx4 v242, s[12:15], s49 offen lds
    s_add_u32 m0, s56, 101376
    s_nop 0
    buffer_load_dwordx4 v243, s[12:15], s49 offen lds
    s_waitcnt vmcnt(8)
    s_barrier
    s_add_u32 s49, s57, 1605632
    s_add_u32 m0, s56, 131072
    s_nop 0
    buffer_load_dwordx4 v240, s[12:15], s49 offen lds
    s_add_u32 m0, s56, 132096
    s_nop 0
    buffer_load_dwordx4 v241, s[12:15], s49 offen lds
    s_add_u32 m0, s56, 133120
    s_nop 0
    buffer_load_dwordx4 v242, s[12:15], s49 offen lds
    s_add_u32 m0, s56, 134144
    s_nop 0
    buffer_load_dwordx4 v243, s[12:15], s49 offen lds
    s_waitcnt vmcnt(8)
    s_barrier
    s_waitcnt vmcnt(4)
    s_barrier
    s_waitcnt vmcnt(0)
    s_barrier
    s_barrier
    s_getpc_b64 s[62:63]
L_pc_74:
    s_add_u32 s62, s62, (L_P5 - L_pc_74)
    s_addc_u32 s63, s63, 0
    v_lshlrev_b32 v252, 7, v1
    v_min_u32 v253, (L_P6 - L_P5 - 4), v252
    global_load_dword v251, v253, s[62:63]
    v_add_u32 v252, 0x2000, v252
    v_min_u32 v253, (L_P6 - L_P5 - 4), v252
    global_load_dword v251, v253, s[62:63]
    s_barrier
    s_lshr_b32 s59, s2, 3
    s_bfe_u32 s46, s2, 0x20001
    s_lshl_b32 s44, s46, 3
    s_and_b32 s46, s2, 1
    s_cmp_ge_u32 s59, 24
    s_cbranch_scc1 L_p5i_75
    s_mul_i32 s47, s59, 86
    s_lshr_b32 s47, s47, 8
    s_add_u32 s44, s44, s47
    s_mul_i32 s47, s47, 3
    s_sub_u32 s45, s59, s47
    s_lshl_b32 s46, s46, 2
    s_add_u32 s45, s45, s46
    s_branch L_p5j_76
L_p5i_75:
    s_lshl_b32 s46, s46, 2
    s_add_u32 s44, s44, s46
    s_sub_u32 s47, s59, 24
    s_and_b32 s47, s47, 3
    s_add_u32 s44, s44, s47
    s_mov_b32 s45, 3
L_p5j_76:
    s_and_b32 s49, s3, 3
    v_lshrrev_b32 v5, 3, v1
    s_lshl_b32 s46, s49, 4
    s_add_u32 s46, s46, 0
    v_add_u32 v5, s46, v5
    v_bfe_u32 v6, v5, 1, 3
    v_and_b32 v7, 7, v1
    v_xor_b32 v6, v6, v7
    v_lshlrev_b32 v5, 12, v5
    v_lshl_add_u32 v240, v6, 4, v5
    v_lshrrev_b32 v5, 3, v1
    s_lshl_b32 s46, s49, 4
    s_add_u32 s46, s46, 8
    v_add_u32 v5, s46, v5
    v_bfe_u32 v6, v5, 1, 3
    v_and_b32 v7, 7, v1
    v_xor_b32 v6, v6, v7
    v_lshlrev_b32 v5, 12, v5
    v_lshl_add_u32 v241, v6, 4, v5
    s_lshl_b32 s54, s49, 11
    s_add_u32 s54, s54, 114688
    v_lshlrev_b32 v244, 4, v1
    v_add_u32 v244, s54, v244
    s_lshl_b32 s46, s44, 18
    s_add_u32 s8, s26, s46
    s_addc_u32 s9, s27, 0
    s_mov_b32 s10, 262144
    s_mov_b32 s11, 0x20000
    s_add_u32 m0, s54, 0
    s_mov_b32 s56, 0
    buffer_load_dwordx4 v240, s[8:11], s56 offen lds
    s_add_u32 m0, s54, 1024
    s_nop 0
    buffer_load_dwordx4 v241, s[8:11], s56 offen lds
    s_add_u32 m0, s54, 8192
    s_mov_b32 s56, 128
    buffer_load_dwordx4 v240, s[8:11], s56 offen lds
    s_add_u32 m0, s54, 9216
    s_nop 0
    buffer_load_dwordx4 v241, s[8:11], s56 offen lds
    s_add_u32 m0, s54, 16384
    s_mov_b32 s56, 256
    buffer_load_dwordx4 v240, s[8:11], s56 offen lds
    s_add_u32 m0, s54, 17408
    s_nop 0
    buffer_load_dwordx4 v241, s[8:11], s56 offen lds
    s_add_u32 m0, s54, 24576
    s_mov_b32 s56, 384
    buffer_load_dwordx4 v240, s[8:11], s56 offen lds
    s_add_u32 m0, s54, 25600
    s_nop 0
    buffer_load_dwordx4 v241, s[8:11], s56 offen lds
    s_add_u32 m0, s54, 32768
    s_mov_b32 s56, 512
    buffer_load_dwordx4 v240, s[8:11], s56 offen lds
    s_add_u32 m0, s54, 33792
    s_nop 0
    buffer_load_dwordx4 v241, s[8:11], s56 offen lds
    s_add_u32 m0, s54, 40960
    s_mov_b32 s56, 640
    buffer_load_dwordx4 v240, s[8:11], s56 offen lds
    s_add_u32 m0, s54, 41984
    s_nop 0
    buffer_load_dwordx4 v241, s[8:11], s56 offen lds
    v_lshrrev_b32 v5, 3, v1
    v_lshlrev_b32 v5, 10, v5
    v_bfe_u32 v6, v1, 4, 1
    v_lshlrev_b32 v6, 2, v6
    v_and_b32 v7, 7, v1
    v_xor_b32 v6, v6, v7
    v_lshl_add_u32 v243, v6, 4, v5
    s_bfe_u32 s46, s2, 0x30003
    s_lshl_b32 s46, s46, 7
    s_add_u32 s4, s30, s46
    s_addc_u32 s5, s31, 0
    s_sub_u32 s6, 917504, s46
    s_mov_b32 s7, 0x20000
    s_and_b32 s46, s3, 3
    s_lshl_b32 s53, s46, 10
    s_lshl_b32 s52, s46, 13
    s_cmp_lg_u32 s3, 4
    s_cbranch_scc1 L_p4q0_77
    s_cmp_ge_u32 s59, 28
    s_cbranch_scc1 L_p4q0_77
    s_lshl_b32 s46, s45, 8
    s_add_u32 s46, s46, 20480
    v_mov_b32 v254, s46
    s_cmp_ge_u32 s45, 6
    s_cselect_b32 s48, 64, 32
    s_mov_b64 exec, 1
    s_mov_b32 s60, 0x200000
L_p4poll_79:
    global_load_dword v255, v254, s[40:41] sc1
    s_sub_u32 s60, s60, 1
    s_cbranch_scc1 L_p4poll_79_out
    s_waitcnt vmcnt(0)
    v_cmp_gt_u32 vcc, s48, v255
    s_cbranch_vccnz L_p4poll_79
L_p4poll_79_out:
    s_waitcnt vmcnt(0)
    s_mov_b64 exec, -1
L_p4q0_77:
    s_add_u32 m0, s53, 16384
    s_add_u32 s49, s52, 131072
    buffer_load_dwordx4 v243, s[4:7], s49 offen lds
    s_add_u32 m0, s53, 20480
    s_add_u32 s49, s52, 163840
    buffer_load_dwordx4 v243, s[4:7], s49 offen lds
    s_add_u32 m0, s53, 24576
    s_add_u32 s49, s52, 196608
    buffer_load_dwordx4 v243, s[4:7], s49 offen lds
    s_add_u32 m0, s53, 28672
    s_add_u32 s49, s52, 229376
    buffer_load_dwordx4 v243, s[4:7], s49 offen lds
    s_add_u32 m0, s53, 32768
    s_add_u32 s49, s52, 262144
    buffer_load_dwordx4 v243, s[4:7], s49 offen lds
    s_add_u32 m0, s53, 36864
    s_add_u32 s49, s52, 294912
    buffer_load_dwordx4 v243, s[4:7], s49 offen lds
    s_add_u32 m0, s53, 40960
    s_add_u32 s49, s52, 327680
    buffer_load_dwordx4 v243, s[4:7], s49 offen lds
    s_add_u32 m0, s53, 45056
    s_add_u32 s49, s52, 360448
    buffer_load_dwordx4 v243, s[4:7], s49 offen lds
    s_add_u32 m0, s53, 49152
    s_add_u32 s49, s52, 393216
    buffer_load_dwordx4 v243, s[4:7], s49 offen lds
    s_add_u32 m0, s53, 53248
    s_add_u32 s49, s52, 425984
    buffer_load_dwordx4 v243, s[4:7], s49 offen lds
    s_add_u32 m0, s53, 57344
    s_add_u32 s49, s52, 458752
    buffer_load_dwordx4 v243, s[4:7], s49 offen lds
    s_add_u32 m0, s53, 61440
    s_add_u32 s49, s52, 491520
    buffer_load_dwordx4 v243, s[4:7], s49 offen lds
    s_add_u32 m0, s53, 65536
    s_add_u32 s49, s52, 524288
    buffer_load_dwordx4 v243, s[4:7], s49 offen lds
    s_add_u32 m0, s53, 69632
    s_add_u32 s49, s52, 557056
    buffer_load_dwordx4 v243, s[4:7], s49 offen lds
    s_add_u32 m0, s53, 73728
    s_add_u32 s49, s52, 589824
    buffer_load_dwordx4 v243, s[4:7], s49 offen lds
    s_add_u32 m0, s53, 77824
    s_add_u32 s49, s52, 622592
    buffer_load_dwordx4 v243, s[4:7], s49 offen lds
    s_add_u32 m0, s53, 81920
    s_add_u32 s49, s52, 655360
    buffer_load_dwordx4 v243, s[4:7], s49 offen lds
    s_add_u32 m0, s53, 86016
    s_add_u32 s49, s52, 688128
    buffer_load_dwordx4 v243, s[4:7], s49 offen lds
    s_add_u32 m0, s53, 90112
    s_add_u32 s49, s52, 720896
    buffer_load_dwordx4 v243, s[4:7], s49 offen lds
    s_add_u32 m0, s53, 94208
    s_add_u32 s49, s52, 753664
    buffer_load_dwordx4 v243, s[4:7], s49 offen lds
    s_add_u32 m0, s53, 98304
    s_add_u32 s49, s52, 786432
    buffer_load_dwordx4 v243, s[4:7], s49 offen lds
    s_add_u32 m0, s53, 102400
    s_add_u32 s49, s52, 819200
    buffer_load_dwordx4 v243, s[4:7], s49 offen lds
    s_add_u32 m0, s53, 106496
    s_add_u32 s49, s52, 851968
    buffer_load_dwordx4 v243, s[4:7], s49 offen lds
    s_add_u32 m0, s53, 110592
    s_add_u32 s49, s52, 884736
    buffer_load_dwordx4 v243, s[4:7], s49 offen lds
L_p4done_66:
    s_lshl_b32 s58, s42, 8
    s_add_u32 s58, s58, 12288
    s_barrier
    s_cmp_lg_u32 s3, 0
    s_cbranch_scc1 L_sig_80
    v_mov_b32 v254, s58
    v_mov_b32 v255, 1
    s_mov_b64 exec, 1
    global_atomic_add v254, v255, s[40:41] sc1
    s_mov_b64 exec, -1
L_sig_80:
L_P5:
    s_lshr_b32 s59, s2, 3
    s_bfe_u32 s46, s2, 0x20001
    s_lshl_b32 s44, s46, 3
    s_and_b32 s46, s2, 1
    s_cmp_ge_u32 s59, 24
    s_cbranch_scc1 L_p5i_81
    s_mul_i32 s47, s59, 86
    s_lshr_b32 s47, s47, 8
    s_add_u32 s44, s44, s47
    s_mul_i32 s47, s47, 3
    s_sub_u32 s45, s59, s47
    s_lshl_b32 s46, s46, 2
    s_add_u32 s45, s45, s46
    s_branch L_p5j_82
L_p5i_81:
    s_lshl_b32 s46, s46, 2
    s_add_u32 s44, s44, s46
    s_sub_u32 s47, s59, 24
    s_and_b32 s47, s47, 3
    s_add_u32 s44, s44, s47
    s_mov_b32 s45, 3
L_p5j_82:
    s_cmp_ge_u32 s59, 28
    s_cbranch_scc1 L_p5skip_83
    s_cmp_lt_u32 s3, 4
    s_cbranch_scc1 L_p5ls_86
    s_add_u32 m0, s53, 0
    s_add_u32 s49, s52, 0
    buffer_load_dwordx4 v243, s[4:7], s49 offen lds
    s_add_u32 m0, s53, 4096
    s_add_u32 s49, s52, 32768
    buffer_load_dwordx4 v243, s[4:7], s49 offen lds
    s_add_u32 m0, s53, 8192
    s_add_u32 s49, s52, 65536
    buffer_load_dwordx4 v243, s[4:7], s49 offen lds
    s_add_u32 m0, s53, 12288
    s_add_u32 s49, s52, 98304
    buffer_load_dwordx4 v243, s[4:7], s49 offen lds
L_p5ls_86:
    s_cmp_ge_u32 s3, 4
    s_cbranch_scc1 L_p5w_85
    v_bfe_u32 v5, v2, 1, 3
    v_xor_b32 v5, v5, v3
    v_lshlrev_b32 v5, 4, v5
    v_lshl_add_u32 v5, v2, 7, v5
    v_add_u32 v40, 114688, v5
    v_xor_b32 v41, 32, v40
    v_xor_b32 v42, 64, v40
    v_xor_b32 v43, 96, v40
    v_mov_b32 v176, 0
    v_mov_b32 v177, 0
    v_mov_b32 v178, 0
    v_mov_b32 v179, 0
    v_mov_b32 v180, 0
    v_mov_b32 v181, 0
    v_mov_b32 v182, 0
    v_mov_b32 v183, 0
    v_mov_b32 v184, 0
    v_mov_b32 v185, 0
    v_mov_b32 v186, 0
    v_mov_b32 v187, 0
    v_mov_b32 v188, 0
    v_mov_b32 v189, 0
    v_mov_b32 v190, 0
    v_mov_b32 v191, 0
    v_mov_b32 v192, 0
    v_mov_b32 v193, 0
    v_mov_b32 v194, 0
    v_mov_b32 v195, 0
    v_mov_b32 v196, 0
    v_mov_b32 v197, 0
    v_mov_b32 v198, 0
    v_mov_b32 v199, 0
    v_mov_b32 v200, 0
    v_mov_b32 v201, 0
    v_mov_b32 v202, 0
    v_mov_b32 v203, 0
    v_mov_b32 v204, 0
    v_mov_b32 v205, 0
    v_mov_b32 v206, 0
    v_mov_b32 v207, 0
    s_lshl_b32 s46, s45, 2
    s_add_u32 s46, s46, s3
    s_lshl_b32 s46, s46, 17
    s_add_u32 s46, s46, 15728640
    s_add_u32 s4, s40, s46
    s_addc_u32 s5, s41, 0
    s_mov_b32 s6, 131072
    s_mov_b32 s7, 0x20000
    v_lshlrev_b32 v226, 4, v1
    s_lshl_b32 s46, s44, 7
    v_lshlrev_b32 v5, 1, v2
    v_add_u32 v5, s46, v5
    global_load_ushort v224, v5, s[28:29]
    global_load_ushort v225, v5, s[28:29] offset:64
L_p5w_85:
    s_lshl_b32 s46, s45, 8
    s_add_u32 s46, s46, 20480
    s_cmp_ge_u32 s45, 6
    s_cselect_b32 s48, 64, 32
    s_cmp_ge_u32 s3, 4
    s_cbranch_scc1 L_p5load_87
    s_lshl_b32 s46, s44, 1
    s_mul_i32 s46, s46, 56
    s_lshl_b32 s47, s45, 3
    s_add_u32 s46, s46, s47
    s_lshl_b32 s47, s3, 1
    s_add_u32 s46, s46, s47
    s_lshl_b32 s61, s46, 10
    s_mov_b32 s56, 0
    buffer_load_dwordx4 v[48:51], v226, s[4:7], s56 offen offset:0 sc1
    buffer_load_dwordx4 v[52:55], v226, s[4:7], s56 offen offset:1024 sc1
    buffer_load_dwordx4 v[56:59], v226, s[4:7], s56 offen offset:2048 sc1
    buffer_load_dwordx4 v[60:63], v226, s[4:7], s56 offen offset:3072 sc1
    s_mov_b32 s56, 4096
    buffer_load_dwordx4 v[64:67], v226, s[4:7], s56 offen offset:0 sc1
    buffer_load_dwordx4 v[68:71], v226, s[4:7], s56 offen offset:1024 sc1
    buffer_load_dwordx4 v[72:75], v226, s[4:7], s56 offen offset:2048 sc1
    buffer_load_dwordx4 v[76:79], v226, s[4:7], s56 offen offset:3072 sc1
    s_mov_b32 s56, 8192
    buffer_load_dwordx4 v[80:83], v226, s[4:7], s56 offen offset:0 sc1
    buffer_load_dwordx4 v[84:87], v226, s[4:7], s56 offen offset:1024 sc1
    buffer_load_dwordx4 v[88:91], v226, s[4:7], s56 offen offset:2048 sc1
    buffer_load_dwordx4 v[92:95], v226, s[4:7], s56 offen offset:3072 sc1
    s_mov_b32 s56, 12288
    buffer_load_dwordx4 v[96:99], v226, s[4:7], s56 offen offset:0 sc1
    buffer_load_dwordx4 v[100:103], v226, s[4:7], s56 offen offset:1024 sc1
    buffer_load_dwordx4 v[104:107], v226, s[4:7], s56 offen offset:2048 sc1
    buffer_load_dwordx4 v[108:111], v226, s[4:7], s56 offen offset:3072 sc1
    s_mov_b32 s56, 16384
    buffer_load_dwordx4 v[112:115], v226, s[4:7], s56 offen offset:0 sc1
    buffer_load_dwordx4 v[116:119], v226, s[4:7], s56 offen offset:1024 sc1
    buffer_load_dwordx4 v[120:123], v226, s[4:7], s56 offen offset:2048 sc1
    buffer_load_dwordx4 v[124:127], v226, s[4:7], s56 offen offset:3072 sc1
    s_mov_b32 s56, 20480
    buffer_load_dwordx4 v[128:131], v226, s[4:7], s56 offen offset:0 sc1
    buffer_load_dwordx4 v[132:135], v226, s[4:7], s56 offen offset:1024 sc1
    buffer_load_dwordx4 v[136:139], v226, s[4:7], s56 offen offset:2048 sc1
    buffer_load_dwordx4 v[140:143], v226, s[4:7], s56 offen offset:3072 sc1
    s_mov_b32 s56, 24576
    buffer_load_dwordx4 v[144:147], v226, s[4:7], s56 offen offset:0 sc1
    buffer_load_dwordx4 v[148:151], v226, s[4:7], s56 offen offset:1024 sc1
    buffer_load_dwordx4 v[152:155], v226, s[4:7], s56 offen offset:2048 sc1
    buffer_load_dwordx4 v[156:159], v226, s[4:7], s56 offen offset:3072 sc1
    s_mov_b32 s56, 28672
    buffer_load_dwordx4 v[160:163], v226, s[4:7], s56 offen offset:0 sc1
    buffer_load_dwordx4 v[164:167], v226, s[4:7], s56 offen offset:1024 sc1
    buffer_load_dwordx4 v[168:171], v226, s[4:7], s56 offen offset:2048 sc1
    buffer_load_dwordx4 v[172:175], v226, s[4:7], s56 offen offset:3072 sc1
    s_mov_b32 s62, 0
    v_add_u32 v44, s62, v40
    v_add_u32 v45, s62, v41
    v_add_u32 v46, s62, v42
    v_add_u32 v47, s62, v43
    s_barrier
    ds_read_b128 v[8:11], v44
    ds_read_b128 v[12:15], v44 offset:4096
    ds_read_b128 v[16:19], v45
    ds_read_b128 v[20:23], v45 offset:4096
    ds_read_b128 v[24:27], v46
    ds_read_b128 v[28:31], v46 offset:4096
    s_mov_b32 s60, 0
    s_mov_b32 s56, 32768
.p2align 6
L_p5loop_88:
    s_waitcnt vmcnt(31) lgkmcnt(4)
    v_mfma_f32_32x32x16_bf16 v[176:191], v[48:51], v[8:11], v[176:191]
    ds_read_b128 v[32:35], v47
    v_mfma_f32_32x32x16_bf16 v[192:207], v[48:51], v[12:15], v[192:207]
    ds_read_b128 v[36:39], v47 offset:4096
    buffer_load_dwordx4 v[48:51], v226, s[4:7], s56 offen offset:0 sc1
    s_waitcnt vmcnt(31) lgkmcnt(4)
    s_barrier
    s_add_u32 s62, s62, 8192
    s_cmp_eq_u32 s62, 49152
    s_cselect_b32 s62, 0, s62
    v_mfma_f32_32x32x16_bf16 v[176:191], v[52:55], v[16:19], v[176:191]
    v_add_u32 v44, s62, v40
    v_add_u32 v45, s62, v41
    v_add_u32 v46, s62, v42
    v_add_u32 v47, s62, v43
    ds_read_b128 v[8:11], v44
    v_mfma_f32_32x32x16_bf16 v[192:207], v[52:55], v[20:23], v[192:207]
    ds_read_b128 v[12:15], v44 offset:4096
    buffer_load_dwordx4 v[52:55], v226, s[4:7], s56 offen offset:1024 sc1
    s_waitcnt vmcnt(31) lgkmcnt(4)
    v_mfma_f32_32x32x16_bf16 v[176:191], v[56:59], v[24:27], v[176:191]
    ds_read_b128 v[16:19], v45
    v_mfma_f32_32x32x16_bf16 v[192:207], v[56:59], v[28:31], v[192:207]
    ds_read_b128 v[20:23], v45 offset:4096
    s_cmp_lg_u32 s60, 24
    s_cbranch_scc1 L_p5z1_89
    s_add_u32 s46, s61, 11534336
    v_lshlrev_b32 v5, 4, v1
    v_add_u32 v5, s46, v5
    global_load_dwordx4 v[208:211], v5, s[40:41] sc1
    global_load_dwordx4 v[212:215], v5, s[40:41] offset:1024 sc1
    v_add_u32 v5, 57344, v5
    global_load_dwordx4 v[216:219], v5, s[40:41] sc1
    global_load_dwordx4 v[220:223], v5, s[40:41] offset:1024 sc1
L_p5z1_89:
    buffer_load_dwordx4 v[56:59], v226, s[4:7], s56 offen offset:2048 sc1
    s_waitcnt vmcnt(31) lgkmcnt(4)
    v_mfma_f32_32x32x16_bf16 v[176:191], v[60:63], v[32:35], v[176:191]
    ds_read_b128 v[24:27], v46
    v_mfma_f32_32x32x16_bf16 v[192:207], v[60:63], v[36:39], v[192:207]
    ds_read_b128 v[28:31], v46 offset:4096
    buffer_load_dwordx4 v[60:63], v226, s[4:7], s56 offen offset:3072 sc1
    s_add_u32 s56, s56, 4096
    s_waitcnt vmcnt(31) lgkmcnt(4)
    v_mfma_f32_32x32x16_bf16 v[176:191], v[64:67], v[8:11], v[176:191]
    ds_read_b128 v[32:35], v47
    v_mfma_f32_32x32x16_bf16 v[192:207], v[64:67], v[12:15], v[192:207]
    ds_read_b128 v[36:39], v47 offset:4096
    buffer_load_dwordx4 v[64:67], v226, s[4:7], s56 offen offset:0 sc1
    s_waitcnt vmcnt(31) lgkmcnt(4)
    s_barrier
    s_add_u32 s62, s62, 8192
    s_cmp_eq_u32 s62, 49152
    s_cselect_b32 s62, 0, s62
    v_mfma_f32_32x32x16_bf16 v[176:191], v[68:71], v[16:19], v[176:191]
    v_add_u32 v44, s62, v40
    v_add_u32 v45, s62, v41
    v_add_u32 v46, s62, v42
    v_add_u32 v47, s62, v43
    ds_read_b128 v[8:11], v44
    v_mfma_f32_32x32x16_bf16 v[192:207], v[68:71], v[20:23], v[192:207]
    ds_read_b128 v[12:15], v44 offset:4096
    buffer_load_dwordx4 v[68:71], v226, s[4:7], s56 offen offset:1024 sc1
    s_waitcnt vmcnt(31) lgkmcnt(4)
    v_mfma_f32_32x32x16_bf16 v[176:191], v[72:75], v[24:27], v[176:191]
    ds_read_b128 v[16:19], v45
    v_mfma_f32_32x32x16_bf16 v[192:207], v[72:75], v[28:31], v[192:207]
    ds_read_b128 v[20:23], v45 offset:4096
    buffer_load_dwordx4 v[72:75], v226, s[4:7], s56 offen offset:2048 sc1
    s_waitcnt vmcnt(31) lgkmcnt(4)
    v_mfma_f32_32x32x16_bf16 v[176:191], v[76:79], v[32:35], v[176:191]
    ds_read_b128 v[24:27], v46
    v_mfma_f32_32x32x16_bf16 v[192:207], v[76:79], v[36:39], v[192:207]
    ds_read_b128 v[28:31], v46 offset:4096
    buffer_load_dwordx4 v[76:79], v226, s[4:7], s56 offen offset:3072 sc1
    s_add_u32 s56, s56, 4096
    s_waitcnt vmcnt(31) lgkmcnt(4)
    v_mfma_f32_32x32x16_bf16 v[176:191], v[80:83], v[8:11], v[176:191]
    ds_read_b128 v[32:35], v47
    v_mfma_f32_32x32x16_bf16 v[192:207], v[80:83], v[12:15], v[192:207]
    ds_read_b128 v[36:39], v47 offset:4096
    buffer_load_dwordx4 v[80:83], v226, s[4:7], s56 offen offset:0 sc1
    s_waitcnt vmcnt(31) lgkmcnt(4)
    s_barrier
    s_add_u32 s62, s62, 8192
    s_cmp_eq_u32 s62, 49152
    s_cselect_b32 s62, 0, s62
    v_mfma_f32_32x32x16_bf16 v[176:191], v[84:87], v[16:19], v[176:191]
    v_add_u32 v44, s62, v40
    v_add_u32 v45, s62, v41
    v_add_u32 v46, s62, v42
    v_add_u32 v47, s62, v43
    ds_read_b128 v[8:11], v44
    v_mfma_f32_32x32x16_bf16 v[192:207], v[84:87], v[20:23], v[192:207]
    ds_read_b128 v[12:15], v44 offset:4096
    buffer_load_dwordx4 v[84:87], v226, s[4:7], s56 offen offset:1024 sc1
    s_waitcnt vmcnt(31) lgkmcnt(4)
    v_mfma_f32_32x32x16_bf16 v[176:191], v[88:91], v[24:27], v[176:191]
    ds_read_b128 v[16:19], v45
    v_mfma_f32_32x32x16_bf16 v[192:207], v[88:91], v[28:31], v[192:207]
    ds_read_b128 v[20:23], v45 offset:4096
    buffer_load_dwordx4 v[88:91], v226, s[4:7], s56 offen offset:2048 sc1
    s_waitcnt vmcnt(31) lgkmcnt(4)
    v_mfma_f32_32x32x16_bf16 v[176:191], v[92:95], v[32:35], v[176:191]
    ds_read_b128 v[24:27], v46
    v_mfma_f32_32x32x16_bf16 v[192:207], v[92:95], v[36:39], v[192:207]
    ds_read_b128 v[28:31], v46 offset:4096
    buffer_load_dwordx4 v[92:95], v226, s[4:7], s56 offen offset:3072 sc1
    s_add_u32 s56, s56, 4096
    s_waitcnt vmcnt(31) lgkmcnt(4)
    v_mfma_f32_32x32x16_bf16 v[176:191], v[96:99], v[8:11], v[176:191]
    ds_read_b128 v[32:35], v47
    v_mfma_f32_32x32x16_bf16 v[192:207], v[96:99], v[12:15], v[192:207]
    ds_read_b128 v[36:39], v47 offset:4096
    buffer_load_dwordx4 v[96:99], v226, s[4:7], s56 offen offset:0 sc1
    s_waitcnt vmcnt(31) lgkmcnt(4)
    s_barrier
    s_add_u32 s62, s62, 8192
    s_cmp_eq_u32 s62, 49152
    s_cselect_b32 s62, 0, s62
    v_mfma_f32_32x32x16_bf16 v[176:191], v[100:103], v[16:19], v[176:191]
    v_add_u32 v44, s62, v40
    v_add_u32 v45, s62, v41
    v_add_u32 v46, s62, v42
    v_add_u32 v47, s62, v43
    ds_read_b128 v[8:11], v44
    v_mfma_f32_32x32x16_bf16 v[192:207], v[100:103], v[20:23], v[192:207]
    ds_read_b128 v[12:15], v44 offset:4096
    buffer_load_dwordx4 v[100:103], v226, s[4:7], s56 offen offset:1024 sc1
    s_waitcnt vmcnt(31) lgkmcnt(4)
    v_mfma_f32_32x32x16_bf16 v[176:191], v[104:107], v[24:27], v[176:191]
    ds_read_b128 v[16:19], v45
    v_mfma_f32_32x32x16_bf16 v[192:207], v[104:107], v[28:31], v[192:207]
    ds_read_b128 v[20:23], v45 offset:4096
    buffer_load_dwordx4 v[104:107], v226, s[4:7], s56 offen offset:2048 sc1
    s_waitcnt vmcnt(31) lgkmcnt(4)
    v_mfma_f32_32x32x16_bf16 v[176:191], v[108:111], v[32:35], v[176:191]
    ds_read_b128 v[24:27], v46
    v_mfma_f32_32x32x16_bf16 v[192:207], v[108:111], v[36:39], v[192:207]
    ds_read_b128 v[28:31], v46 offset:4096
    buffer_load_dwordx4 v[108:111], v226, s[4:7], s56 offen offset:3072 sc1
    s_add_u32 s56, s56, 4096
    s_waitcnt vmcnt(31) lgkmcnt(4)
    v_mfma_f32_32x32x16_bf16 v[176:191], v[112:115], v[8:11], v[176:191]
    ds_read_b128 v[32:35], v47
    v_mfma_f32_32x32x16_bf16 v[192:207], v[112:115], v[12:15], v[192:207]
    ds_read_b128 v[36:39], v47 offset:4096
    buffer_load_dwordx4 v[112:115], v226, s[4:7], s56 offen offset:0 sc1
    s_waitcnt vmcnt(31) lgkmcnt(4)
    s_barrier
    s_add_u32 s62, s62, 8192
    s_cmp_eq_u32 s62, 49152
    s_cselect_b32 s62, 0, s62
    v_mfma_f32_32x32x16_bf16 v[176:191], v[116:119], v[16:19], v[176:191]
    v_add_u32 v44, s62, v40
    v_add_u32 v45, s62, v41
    v_add_u32 v46, s62, v42
    v_add_u32 v47, s62, v43
    ds_read_b128 v[8:11], v44
    v_mfma_f32_32x32x16_bf16 v[192:207], v[116:119], v[20:23], v[192:207]
    ds_read_b128 v[12:15], v44 offset:4096
    buffer_load_dwordx4 v[116:119], v226, s[4:7], s56 offen offset:1024 sc1
    s_waitcnt vmcnt(31) lgkmcnt(4)
    v_mfma_f32_32x32x16_bf16 v[176:191], v[120:123], v[24:27], v[176:191]
    ds_read_b128 v[16:19], v45
    v_mfma_f32_32x32x16_bf16 v[192:207], v[120:123], v[28:31], v[192:207]
    ds_read_b128 v[20:23], v45 offset:4096
    buffer_load_dwordx4 v[120:123], v226, s[4:7], s56 offen offset:2048 sc1
    s_waitcnt vmcnt(31) lgkmcnt(4)
    v_mfma_f32_32x32x16_bf16 v[176:191], v[124:127], v[32:35], v[176:191]
    ds_read_b128 v[24:27], v46
    v_mfma_f32_32x32x16_bf16 v[192:207], v[124:127], v[36:39], v[192:207]
    ds_read_b128 v[28:31], v46 offset:4096
    buffer_load_dwordx4 v[124:127], v226, s[4:7], s56 offen offset:3072 sc1
    s_add_u32 s56, s56, 4096
    s_waitcnt vmcnt(31) lgkmcnt(4)
    v_mfma_f32_32x32x16_bf16 v[176:191], v[128:131], v[8:11], v[176:191]
    ds_read_b128 v[32:35], v47
    v_mfma_f32_32x32x16_bf16 v[192:207], v[128:131], v[12:15], v[192:207]
    ds_read_b128 v[36:39], v47 offset:4096
    buffer_load_dwordx4 v[128:131], v226, s[4:7], s56 offen offset:0 sc1
    s_waitcnt vmcnt(31) lgkmcnt(4)
    s_barrier
    s_add_u32 s62, s62, 8192
    s_cmp_eq_u32 s62, 49152
    s_cselect_b32 s62, 0, s62
    v_mfma_f32_32x32x16_bf16 v[176:191], v[132:135], v[16:19], v[176:191]
    v_add_u32 v44, s62, v40
    v_add_u32 v45, s62, v41
    v_add_u32 v46, s62, v42
    v_add_u32 v47, s62, v43
    ds_read_b128 v[8:11], v44
    v_mfma_f32_32x32x16_bf16 v[192:207], v[132:135], v[20:23], v[192:207]
    ds_read_b128 v[12:15], v44 offset:4096
    buffer_load_dwordx4 v[132:135], v226, s[4:7], s56 offen offset:1024 sc1
    s_waitcnt vmcnt(31) lgkmcnt(4)
    v_mfma_f32_32x32x16_bf16 v[176:191], v[136:139], v[24:27], v[176:191]
    ds_read_b128 v[16:19], v45
    v_mfma_f32_32x32x16_bf16 v[192:207], v[136:139], v[28:31], v[192:207]
    ds_read_b128 v[20:23], v45 offset:4096
    buffer_load_dwordx4 v[136:139], v226, s[4:7], s56 offen offset:2048 sc1
    s_waitcnt vmcnt(31) lgkmcnt(4)
    v_mfma_f32_32x32x16_bf16 v[176:191], v[140:143], v[32:35], v[176:191]
    ds_read_b128 v[24:27], v46
    v_mfma_f32_32x32x16_bf16 v[192:207], v[140:143], v[36:39], v[192:207]
    ds_read_b128 v[28:31], v46 offset:4096
    buffer_load_dwordx4 v[140:143], v226, s[4:7], s56 offen offset:3072 sc1
    s_add_u32 s56, s56, 4096
    s_waitcnt vmcnt(31) lgkmcnt(4)
    v_mfma_f32_32x32x16_bf16 v[176:191], v[144:147], v[8:11], v[176:191]
    ds_read_b128 v[32:35], v47
    v_mfma_f32_32x32x16_bf16 v[192:207], v[144:147], v[12:15], v[192:207]
    ds_read_b128 v[36:39], v47 offset:4096
    buffer_load_dwordx4 v[144:147], v226, s[4:7], s56 offen offset:0 sc1
    s_waitcnt vmcnt(31) lgkmcnt(4)
    s_barrier
    s_add_u32 s62, s62, 8192
    s_cmp_eq_u32 s62, 49152
    s_cselect_b32 s62, 0, s62
    v_mfma_f32_32x32x16_bf16 v[176:191], v[148:151], v[16:19], v[176:191]
    v_add_u32 v44, s62, v40
    v_add_u32 v45, s62, v41
    v_add_u32 v46, s62, v42
    v_add_u32 v47, s62, v43
    ds_read_b128 v[8:11], v44
    v_mfma_f32_32x32x16_bf16 v[192:207], v[148:151], v[20:23], v[192:207]
    ds_read_b128 v[12:15], v44 offset:4096
    buffer_load_dwordx4 v[148:151], v226, s[4:7], s56 offen offset:1024 sc1
    s_waitcnt vmcnt(31) lgkmcnt(4)
    v_mfma_f32_32x32x16_bf16 v[176:191], v[152:155], v[24:27], v[176:191]
    ds_read_b128 v[16:19], v45
    v_mfma_f32_32x32x16_bf16 v[192:207], v[152:155], v[28:31], v[192:207]
    ds_read_b128 v[20:23], v45 offset:4096
    buffer_load_dwordx4 v[152:155], v226, s[4:7], s56 offen offset:2048 sc1
    s_waitcnt vmcnt(31) lgkmcnt(4)
    v_mfma_f32_32x32x16_bf16 v[176:191], v[156:159], v[32:35], v[176:191]
    ds_read_b128 v[24:27], v46
    v_mfma_f32_32x32x16_bf16 v[192:207], v[156:159], v[36:39], v[192:207]
    ds_read_b128 v[28:31], v46 offset:4096
    buffer_load_dwordx4 v[156:159], v226, s[4:7], s56 offen offset:3072 sc1
    s_add_u32 s56, s56, 4096
    s_waitcnt vmcnt(31) lgkmcnt(4)
    v_mfma_f32_32x32x16_bf16 v[176:191], v[160:163], v[8:11], v[176:191]
    ds_read_b128 v[32:35], v47
    v_mfma_f32_32x32x16_bf16 v[192:207], v[160:163], v[12:15], v[192:207]
    ds_read_b128 v[36:39], v47 offset:4096
    buffer_load_dwordx4 v[160:163], v226, s[4:7], s56 offen offset:0 sc1
    s_waitcnt vmcnt(31) lgkmcnt(4)
    s_barrier
    s_add_u32 s62, s62, 8192
    s_cmp_eq_u32 s62, 49152
    s_cselect_b32 s62, 0, s62
    v_mfma_f32_32x32x16_bf16 v[176:191], v[164:167], v[16:19], v[176:191]
    v_add_u32 v44, s62, v40
    v_add_u32 v45, s62, v41
    v_add_u32 v46, s62, v42
    v_add_u32 v47, s62, v43
    ds_read_b128 v[8:11], v44
    v_mfma_f32_32x32x16_bf16 v[192:207], v[164:167], v[20:23], v[192:207]
    ds_read_b128 v[12:15], v44 offset:4096
    buffer_load_dwordx4 v[164:167], v226, s[4:7], s56 offen offset:1024 sc1
    s_waitcnt vmcnt(31) lgkmcnt(4)
    v_mfma_f32_32x32x16_bf16 v[176:191], v[168:171], v[24:27], v[176:191]
    ds_read_b128 v[16:19], v45
    v_mfma_f32_32x32x16_bf16 v[192:207], v[168:171], v[28:31], v[192:207]
    ds_read_b128 v[20:23], v45 offset:4096
    buffer_load_dwordx4 v[168:171], v226, s[4:7], s56 offen offset:2048 sc1
    s_waitcnt vmcnt(31) lgkmcnt(4)
    v_mfma_f32_32x32x16_bf16 v[176:191], v[172:175], v[32:35], v[176:191]
    ds_read_b128 v[24:27], v46
    v_mfma_f32_32x32x16_bf16 v[192:207], v[172:175], v[36:39], v[192:207]
    ds_read_b128 v[28:31], v46 offset:4096
    buffer_load_dwordx4 v[172:175], v226, s[4:7], s56 offen offset:3072 sc1
    s_add_u32 s56, s56, 4096
    s_add_u32 s60, s60, 8
    s_cmp_lt_u32 s60, 32
    s_cbranch_scc1 L_p5loop_88
    s_waitcnt lgkmcnt(0)
    s_barrier
    s_nop 3
    s_add_u32 s46, s61, 19922944
    v_lshlrev_b32 v5, 4, v1
    v_add_u32 v5, s46, v5
    v_add_u32 v6, 57344, v5
    v_lshlrev_b32 v224, 16, v224
    v_lshlrev_b32 v225, 16, v225
    v_add_f32 v176, v176, v224
    v_add_f32 v177, v177, v224
    v_add_f32 v178, v178, v224
    v_add_f32 v179, v179, v224
    v_add_f32 v180, v180, v224
    v_add_f32 v181, v181, v224
    v_add_f32 v182, v182, v224
    v_add_f32 v183, v183, v224
    v_add_f32 v184, v184, v224
    v_add_f32 v185, v185, v224
    v_add_f32 v186, v186, v224
    v_add_f32 v187, v187, v224
    v_add_f32 v188, v188, v224
    v_add_f32 v189, v189, v224
    v_add_f32 v190, v190, v224
    v_add_f32 v191, v191, v224
    v_add_f32 v192, v192, v225
    v_add_f32 v193, v193, v225
    v_add_f32 v194, v194, v225
    v_add_f32 v195, v195, v225
    v_add_f32 v196, v196, v225
    v_add_f32 v197, v197, v225
    v_add_f32 v198, v198, v225
    v_add_f32 v199, v199, v225
    v_add_f32 v200, v200, v225
    v_add_f32 v201, v201, v225
    v_add_f32 v202, v202, v225
    v_add_f32 v203, v203, v225
    v_add_f32 v204, v204, v225
    v_add_f32 v205, v205, v225
    v_add_f32 v206, v206, v225
    v_add_f32 v207, v207, v225
    s_waitcnt vmcnt(0)
    v_lshlrev_b32 v16, 16, v208
    v_and_b32 v17, 0xffff0000, v208
    v_lshlrev_b32 v18, 16, v209
    v_and_b32 v19, 0xffff0000, v209
    v_lshlrev_b32 v20, 16, v210
    v_and_b32 v21, 0xffff0000, v210
    v_lshlrev_b32 v22, 16, v211
    v_and_b32 v23, 0xffff0000, v211
    v_lshlrev_b32 v24, 16, v212
    v_and_b32 v25, 0xffff0000, v212
    v_lshlrev_b32 v26, 16, v213
    v_and_b32 v27, 0xffff0000, v213
    v_lshlrev_b32 v28, 16, v214
    v_and_b32 v29, 0xffff0000, v214
    v_lshlrev_b32 v30, 16, v215
    v_and_b32 v31, 0xffff0000, v215
    v_mul_f32 v176, v176, v16
    v_mul_f32 v177, v177, v17
    v_mul_f32 v178, v178, v18
    v_mul_f32 v179, v179, v19
    v_mul_f32 v180, v180, v20
    v_mul_f32 v181, v181, v21
    v_mul_f32 v182, v182, v22
    v_mul_f32 v183, v183, v23
    v_mul_f32 v184, v184, v24
    v_mul_f32 v185, v185, v25
    v_mul_f32 v186, v186, v26
    v_mul_f32 v187, v187, v27
    v_mul_f32 v188, v188, v28
    v_mul_f32 v189, v189, v29
    v_mul_f32 v190, v190, v30
    v_mul_f32 v191, v191, v31
    v_cvt_pk_bf16_f32 v48, v176, v177
    v_cvt_pk_bf16_f32 v49, v178, v179
    v_cvt_pk_bf16_f32 v50, v180, v181
    v_cvt_pk_bf16_f32 v51, v182, v183
    v_cvt_pk_bf16_f32 v52, v184, v185
    v_cvt_pk_bf16_f32 v53, v186, v187
    v_cvt_pk_bf16_f32 v54, v188, v189
    v_cvt_pk_bf16_f32 v55, v190, v191
    global_store_dwordx4 v5, v[48:51], s[40:41] sc1
    global_store_dwordx4 v5, v[52:55], s[40:41] offset:1024 sc1
    v_lshlrev_b32 v16, 16, v216
    v_and_b32 v17, 0xffff0000, v216
    v_lshlrev_b32 v18, 16, v217
    v_and_b32 v19, 0xffff0000, v217
    v_lshlrev_b32 v20, 16, v218
    v_and_b32 v21, 0xffff0000, v218
    v_lshlrev_b32 v22, 16, v219
    v_and_b32 v23, 0xffff0000, v219
    v_lshlrev_b32 v24, 16, v220
    v_and_b32 v25, 0xffff0000, v220
    v_lshlrev_b32 v26, 16, v221
    v_and_b32 v27, 0xffff0000, v221
    v_lshlrev_b32 v28, 16, v222
    v_and_b32 v29, 0xffff0000, v222
    v_lshlrev_b32 v30, 16, v223
    v_and_b32 v31, 0xffff0000, v223
    v_mul_f32 v192, v192, v16
    v_mul_f32 v193, v193, v17
    v_mul_f32 v194, v194, v18
    v_mul_f32 v195, v195, v19
    v_mul_f32 v196, v196, v20
    v_mul_f32 v197, v197, v21
    v_mul_f32 v198, v198, v22
    v_mul_f32 v199, v199, v23
    v_mul_f32 v200, v200, v24
    v_mul_f32 v201, v201, v25
    v_mul_f32 v202, v202, v26
    v_mul_f32 v203, v203, v27
    v_mul_f32 v204, v204, v28
    v_mul_f32 v205, v205, v29
    v_mul_f32 v206, v206, v30
    v_mul_f32 v207, v207, v31
    v_cvt_pk_bf16_f32 v56, v192, v193
    v_cvt_pk_bf16_f32 v57, v194, v195
    v_cvt_pk_bf16_f32 v58, v196, v197
    v_cvt_pk_bf16_f32 v59, v198, v199
    v_cvt_pk_bf16_f32 v60, v200, v201
    v_cvt_pk_bf16_f32 v61, v202, v203
    v_cvt_pk_bf16_f32 v62, v204, v205
    v_cvt_pk_bf16_f32 v63, v206, v207
    global_store_dwordx4 v6, v[56:59], s[40:41] sc1
    global_store_dwordx4 v6, v[60:63], s[40:41] offset:1024 sc1
    s_waitcnt vmcnt(0)
    s_branch L_p5done_90
L_p5load_87:
    s_waitcnt vmcnt(38)
    s_barrier
    s_waitcnt vmcnt(36) lgkmcnt(0)
    s_barrier
    s_waitcnt vmcnt(34) lgkmcnt(0)
    s_barrier
    ds_write_b128 v244, v[8:11] offset:0
    ds_write_b128 v244, v[12:15] offset:1024
    s_waitcnt vmcnt(32) lgkmcnt(0)
    s_barrier
    ds_write_b128 v244, v[16:19] offset:8192
    ds_write_b128 v244, v[20:23] offset:9216
    s_waitcnt vmcnt(30) lgkmcnt(0)
    s_barrier
    ds_write_b128 v244, v[24:27] offset:16384
    ds_write_b128 v244, v[28:31] offset:17408
    s_waitcnt vmcnt(28) lgkmcnt(0)
    s_barrier
    ds_write_b128 v244, v[32:35] offset:24576
    ds_write_b128 v244, v[36:39] offset:25600
    s_waitcnt lgkmcnt(0)
    s_barrier
    ds_write_b128 v244, v[40:43] offset:32768
    ds_write_b128 v244, v[44:47] offset:33792
    s_waitcnt lgkmcnt(0)
    s_barrier
    ds_write_b128 v244, v[48:51] offset:40960
    ds_write_b128 v244, v[52:55] offset:41984
    s_waitcnt lgkmcnt(0)
    s_barrier
    ds_write_b128 v244, v[56:59] offset:0
    ds_write_b128 v244, v[60:63] offset:1024
    s_waitcnt lgkmcnt(0)
    s_barrier
    ds_write_b128 v244, v[64:67] offset:8192
    ds_write_b128 v244, v[68:71] offset:9216
    s_waitcnt lgkmcnt(0)
    s_barrier
    ds_write_b128 v244, v[72:75] offset:16384
    ds_write_b128 v244, v[76:79] offset:17408
    s_waitcnt lgkmcnt(0)
    s_barrier
    ds_write_b128 v244, v[80:83] offset:24576
    ds_write_b128 v244, v[84:87] offset:25600
    s_waitcnt lgkmcnt(0)
    s_barrier
    ds_write_b128 v244, v[88:91] offset:32768
    ds_write_b128 v244, v[92:95] offset:33792
    s_waitcnt lgkmcnt(0)
    s_barrier
    ds_write_b128 v244, v[96:99] offset:40960
    ds_write_b128 v244, v[100:103] offset:41984
    s_waitcnt lgkmcnt(0)
    s_barrier
    ds_write_b128 v244, v[104:107] offset:0
    ds_write_b128 v244, v[108:111] offset:1024
    s_waitcnt lgkmcnt(0)
    s_barrier
    ds_write_b128 v244, v[112:115] offset:8192
    ds_write_b128 v244, v[116:119] offset:9216
    s_waitcnt lgkmcnt(0)
    s_barrier
    ds_write_b128 v244, v[120:123] offset:16384
    ds_write_b128 v244, v[124:127] offset:17408
    s_waitcnt lgkmcnt(0)
    s_barrier
    ds_write_b128 v244, v[128:131] offset:24576
    ds_write_b128 v244, v[132:135] offset:25600
    s_waitcnt lgkmcnt(0)
    s_barrier
    ds_write_b128 v244, v[136:139] offset:32768
    ds_write_b128 v244, v[140:143] offset:33792
    s_waitcnt lgkmcnt(0)
    s_barrier
    ds_write_b128 v244, v[144:147] offset:40960
    ds_write_b128 v244, v[148:151] offset:41984
    s_waitcnt lgkmcnt(0)
    s_barrier
    ds_write_b128 v244, v[152:155] offset:0
    ds_write_b128 v244, v[156:159] offset:1024
    s_waitcnt lgkmcnt(0)
    s_barrier
    ds_write_b128 v244, v[160:163] offset:8192
    ds_write_b128 v244, v[164:167] offset:9216
    s_waitcnt lgkmcnt(0)
    s_barrier
    ds_write_b128 v244, v[168:171] offset:16384
    ds_write_b128 v244, v[172:175] offset:17408
    s_waitcnt lgkmcnt(0)
    s_barrier
    ds_write_b128 v244, v[176:179] offset:24576
    ds_write_b128 v244, v[180:183] offset:25600
    s_waitcnt lgkmcnt(0)
    s_cmp_lg_u32 s3, 4
    s_cbranch_scc1 L_p5q_91
    s_lshl_b32 s47, s44, 8
    s_add_u32 s47, s47, 12288
    v_lshlrev_b32 v254, 8, v1
    v_add_u32 v254, s47, v254
    s_mov_b64 exec, 1
    s_mov_b32 s60, 0x200000
L_poll_92:
    global_load_dword v255, v254, s[40:41] sc1
    s_sub_u32 s60, s60, 1
    s_cbranch_scc1 L_poll_92_out
    s_waitcnt vmcnt(0)
    v_cmp_gt_u32 vcc, 8, v255
    s_cbranch_vccnz L_poll_92
L_poll_92_out:
    s_waitcnt vmcnt(0)
    s_mov_b64 exec, -1
L_p5q_91:
    s_barrier
    s_add_u32 m0, s54, 32768
    s_mov_b32 s56, 3584
    buffer_load_dwordx4 v240, s[8:11], s56 offen lds
    s_add_u32 m0, s54, 33792
    s_nop 0
    buffer_load_dwordx4 v241, s[8:11], s56 offen lds
    s_waitcnt lgkmcnt(0)
    s_barrier
    s_add_u32 m0, s54, 40960
    s_mov_b32 s56, 3712
    buffer_load_dwordx4 v240, s[8:11], s56 offen lds
    s_add_u32 m0, s54, 41984
    s_nop 0
    buffer_load_dwordx4 v241, s[8:11], s56 offen lds
    s_waitcnt lgkmcnt(0)
    s_barrier
    s_add_u32 m0, s54, 0
    s_mov_b32 s56, 3840
    buffer_load_dwordx4 v240, s[8:11], s56 offen lds
    s_add_u32 m0, s54, 1024
    s_nop 0
    buffer_load_dwordx4 v241, s[8:11], s56 offen lds
    s_waitcnt lgkmcnt(0)
    s_barrier
    s_add_u32 m0, s54, 8192
    s_mov_b32 s56, 3968
    buffer_load_dwordx4 v240, s[8:11], s56 offen lds
    s_add_u32 m0, s54, 9216
    s_nop 0
    buffer_load_dwordx4 v241, s[8:11], s56 offen lds
    s_waitcnt vmcnt(6) lgkmcnt(0)
    s_barrier
    s_waitcnt vmcnt(4) lgkmcnt(0)
    s_barrier
    s_waitcnt vmcnt(2) lgkmcnt(0)
    s_barrier
    s_waitcnt vmcnt(0) lgkmcnt(0)
    s_barrier
    s_barrier
    s_barrier
    s_getpc_b64 s[62:63]
L_pc_93:
    s_add_u32 s62, s62, (L_P6 - L_pc_93)
    s_addc_u32 s63, s63, 0
    v_lshlrev_b32 v252, 7, v1
    v_min_u32 v253, (L_end - L_P6 - 4), v252
    global_load_dword v251, v253, s[62:63]
L_p5done_90:
    s_lshl_b32 s58, s44, 8
    s_add_u32 s58, s58, 24576
    s_barrier
    s_cmp_lg_u32 s3, 0
    s_cbranch_scc1 L_sig_94
    v_mov_b32 v254, s58
    v_mov_b32 v255, 1
    s_mov_b64 exec, 1
    global_atomic_add v254, v255, s[40:41] sc1
    s_mov_b64 exec, -1
L_sig_94:
    s_branch L_p5end_84
L_p5skip_83:
    s_cmp_lt_u32 s3, 4
    s_cbranch_scc1 L_p5end_84
    v_lshrrev_b32 v5, 3, v1
    v_lshlrev_b32 v5, 10, v5
    v_bfe_u32 v6, v1, 4, 1
    v_lshlrev_b32 v6, 2, v6
    v_and_b32 v7, 7, v1
    v_xor_b32 v6, v6, v7
    v_lshl_add_u32 v243, v6, 4, v5
    s_bfe_u32 s46, s2, 0x30003
    s_lshl_b32 s46, s46, 7
    s_add_u32 s4, s30, s46
    s_addc_u32 s5, s31, 0
    s_sub_u32 s6, 917504, s46
    s_mov_b32 s7, 0x20000
    s_and_b32 s46, s3, 3
    s_lshl_b32 s53, s46, 10
    s_lshl_b32 s52, s46, 13
    s_add_u32 m0, s53, 0
    s_add_u32 s49, s52, 0
    buffer_load_dwordx4 v243, s[4:7], s49 offen lds
    s_add_u32 m0, s53, 4096
    s_add_u32 s49, s52, 32768
    buffer_load_dwordx4 v243, s[4:7], s49 offen lds
    s_add_u32 m0, s53, 8192
    s_add_u32 s49, s52, 65536
    buffer_load_dwordx4 v243, s[4:7], s49 offen lds
    s_add_u32 m0, s53, 12288
    s_add_u32 s49, s52, 98304
    buffer_load_dwordx4 v243, s[4:7], s49 offen lds
L_p5end_84:
L_P6:
    s_and_b32 s42, s2, 7
    s_lshl_b32 s42, s42, 2
    s_lshr_b32 s43, s2, 6
    s_add_u32 s42, s42, s43
    s_bfe_u32 s43, s2, 0x30003
    s_and_b32 s51, s3, 1
    s_bfe_u32 s52, s3, 0x10001
    s_lshl_b32 s53, s43, 6
    s_lshl_b32 s46, s52, 5
    s_add_u32 s53, s53, s46
    s_cmp_lt_u32 s3, 4
    s_cbranch_scc1 L_p6c_95
    s_and_b32 s49, s3, 3
    s_lshr_b32 s46, s49, 1
    s_lshl_b32 s47, s42, 1
    s_add_u32 s47, s47, s46
    s_mul_i32 s47, s47, 56
    s_and_b32 s48, s49, 1
    s_lshl_b32 s48, s48, 2
    s_add_u32 s47, s47, s48
    s_lshl_b32 s47, s47, 10
    s_add_u32 s47, s47, 19922944
    s_add_u32 s4, s40, s47
    s_addc_u32 s5, s41, 0
    s_mov_b32 s6, 57344
    s_mov_b32 s7, 0x20000
    s_lshl_b32 s54, s49, 12
    s_add_u32 s54, s54, 114688
    v_lshlrev_b32 v10, 4, v1
    s_branch L_p6w_96
L_p6c_95:
    s_lshl_b32 s46, s42, 1
    s_add_u32 s46, s46, s51
    s_lshl_b32 s46, s46, 5
    s_lshr_b32 s47, s53, 4
    s_add_u32 s46, s46, s47
    s_lshl_b32 s46, s46, 10
    s_add_u32 s46, s46, 9437184
    v_lshlrev_b32 v12, 4, v1
    v_add_u32 v12, s46, v12
    global_load_dwordx4 v[208:211], v12, s[40:41] sc1
    global_load_dwordx4 v[212:215], v12, s[40:41] offset:1024 sc1
    s_lshl_b32 s47, s53, 2
    s_add_u32 s47, s47, 75776
    v_lshlrev_b32 v12, 4, v3
    v_add_u32 v12, s47, v12
    global_load_dwordx4 v[216:219], v12, s[40:41] offset:0 sc1
    global_load_dwordx4 v[220:223], v12, s[40:41] offset:32 sc1
    global_load_dwordx4 v[224:227], v12, s[40:41] offset:64 sc1
    global_load_dwordx4 v[228:231], v12, s[40:41] offset:96 sc1
    v_bfe_u32 v11, v1, 2, 2
    v_lshl_add_u32 v11, v3, 2, v11
    v_lshlrev_b32 v11, 7, v11
    v_bfe_u32 v12, v1, 3, 1
    v_xor_b32 v12, s52, v12
    v_lshl_add_u32 v11, v12, 6, v11
    v_bfe_u32 v12, v1, 4, 1
    v_lshl_add_u32 v11, v12, 5, v11
    v_and_b32 v12, 3, v1
    v_lshl_add_u32 v112, v12, 3, v11
    v_add_u32 v113, 65536, v112
    s_lshl_b32 s46, s51, 13
    s_add_u32 s46, s46, 114688
    v_lshlrev_b32 v114, 4, v1
    v_add_u32 v114, s46, v114
    v_mov_b32 v192, 0
    v_mov_b32 v193, 0
    v_mov_b32 v194, 0
    v_mov_b32 v195, 0
    v_mov_b32 v196, 0
    v_mov_b32 v197, 0
    v_mov_b32 v198, 0
    v_mov_b32 v199, 0
    v_mov_b32 v200, 0
    v_mov_b32 v201, 0
    v_mov_b32 v202, 0
    v_mov_b32 v203, 0
    v_mov_b32 v204, 0
    v_mov_b32 v205, 0
    v_mov_b32 v206, 0
    v_mov_b32 v207, 0
L_p6w_96:
    s_lshl_b32 s46, s42, 8
    s_add_u32 s46, s46, 24576
    s_cmp_lg_u32 s3, 0
    s_cbranch_scc1 L_wait_97
    v_lshlrev_b32 v254, 8, v1
    v_add_u32 v254, s46, v254
    s_mov_b64 exec, 1
    s_mov_b32 s60, 0x200000
L_poll_98:
    global_load_dword v255, v254, s[40:41] sc1
    s_sub_u32 s60, s60, 1
    s_cbranch_scc1 L_poll_98_out
    s_waitcnt vmcnt(0)
    v_cmp_gt_u32 vcc, 7, v255
    s_cbranch_vccnz L_poll_98
L_poll_98_out:
    s_waitcnt vmcnt(0)
    s_mov_b64 exec, -1
L_wait_97:
    s_barrier
    s_cmp_lt_u32 s3, 4
    s_cbranch_scc1 L_p6c2_101
    s_add_u32 m0, s54, 0
    s_mov_b32 s49, 0
    buffer_load_dwordx4 v10, s[4:7], s49 offen offset:0 sc1 lds
    buffer_load_dwordx4 v10, s[4:7], s49 offen offset:1024 sc1 lds
    buffer_load_dwordx4 v10, s[4:7], s49 offen offset:2048 sc1 lds
    buffer_load_dwordx4 v10, s[4:7], s49 offen offset:3072 sc1 lds
    s_add_u32 m0, s54, 16384
    s_mov_b32 s49, 8192
    buffer_load_dwordx4 v10, s[4:7], s49 offen offset:0 sc1 lds
    buffer_load_dwordx4 v10, s[4:7], s49 offen offset:1024 sc1 lds
    buffer_load_dwordx4 v10, s[4:7], s49 offen offset:2048 sc1 lds
    buffer_load_dwordx4 v10, s[4:7], s49 offen offset:3072 sc1 lds
    s_add_u32 m0, s54, 32768
    s_mov_b32 s49, 16384
    buffer_load_dwordx4 v10, s[4:7], s49 offen offset:0 sc1 lds
    buffer_load_dwordx4 v10, s[4:7], s49 offen offset:1024 sc1 lds
    buffer_load_dwordx4 v10, s[4:7], s49 offen offset:2048 sc1 lds
    buffer_load_dwordx4 v10, s[4:7], s49 offen offset:3072 sc1 lds
    s_waitcnt vmcnt(8)
L_p6c2_101:
    s_barrier
    s_cmp_ge_u32 s3, 4
    s_cbranch_scc1 L_p6load_99
    ds_read_b128 v[8:11], v114 offset:0
    ds_read_b64_tr_b16 v[12:13], v112 offset:0
    ds_read_b64_tr_b16 v[14:15], v112 offset:1024
    ds_read_b128 v[20:23], v114 offset:1024
    ds_read_b64_tr_b16 v[24:25], v112 offset:2048
    ds_read_b64_tr_b16 v[26:27], v112 offset:3072
    ds_read_b128 v[32:35], v114 offset:2048
    ds_read_b64_tr_b16 v[36:37], v112 offset:4096
    ds_read_b64_tr_b16 v[38:39], v112 offset:5120
    ds_read_b128 v[44:47], v114 offset:3072
    ds_read_b64_tr_b16 v[48:49], v112 offset:6144
    ds_read_b64_tr_b16 v[50:51], v112 offset:7168
    s_waitcnt lgkmcnt(6)
    v_mfma_f32_32x32x16_bf16 v[192:207], v[12:15], v[8:11], v[192:207]
    ds_read_b128 v[56:59], v114 offset:4096
    ds_read_b64_tr_b16 v[60:61], v112 offset:8192
    ds_read_b64_tr_b16 v[62:63], v112 offset:9216
    v_mfma_f32_32x32x16_bf16 v[192:207], v[24:27], v[20:23], v[192:207]
    ds_read_b128 v[68:71], v114 offset:5120
    ds_read_b64_tr_b16 v[72:73], v112 offset:10240
    ds_read_b64_tr_b16 v[74:75], v112 offset:11264
    s_waitcnt lgkmcnt(6)
    v_mfma_f32_32x32x16_bf16 v[192:207], v[36:39], v[32:35], v[192:207]
    ds_read_b128 v[80:83], v114 offset:6144
    ds_read_b64_tr_b16 v[84:85], v112 offset:12288
    ds_read_b64_tr_b16 v[86:87], v112 offset:13312
    v_mfma_f32_32x32x16_bf16 v[192:207], v[48:51], v[44:47], v[192:207]
    ds_read_b128 v[92:95], v114 offset:7168
    ds_read_b64_tr_b16 v[96:97], v112 offset:14336
    ds_read_b64_tr_b16 v[98:99], v112 offset:15360
    s_waitcnt lgkmcnt(0)
    s_barrier
    v_mfma_f32_32x32x16_bf16 v[192:207], v[60:63], v[56:59], v[192:207]
    ds_read_b128 v[8:11], v114 offset:16384
    ds_read_b64_tr_b16 v[12:13], v112 offset:16384
    ds_read_b64_tr_b16 v[14:15], v112 offset:17408
    v_mfma_f32_32x32x16_bf16 v[192:207], v[72:75], v[68:71], v[192:207]
    ds_read_b128 v[20:23], v114 offset:17408
    ds_read_b64_tr_b16 v[24:25], v112 offset:18432
    ds_read_b64_tr_b16 v[26:27], v112 offset:19456
    s_waitcnt lgkmcnt(6)
    v_mfma_f32_32x32x16_bf16 v[192:207], v[84:87], v[80:83], v[192:207]
    ds_read_b128 v[32:35], v114 offset:18432
    ds_read_b64_tr_b16 v[36:37], v112 offset:20480
    ds_read_b64_tr_b16 v[38:39], v112 offset:21504
    v_mfma_f32_32x32x16_bf16 v[192:207], v[96:99], v[92:95], v[192:207]
    ds_read_b128 v[44:47], v114 offset:19456
    ds_read_b64_tr_b16 v[48:49], v112 offset:22528
    ds_read_b64_tr_b16 v[50:51], v112 offset:23552
    s_waitcnt lgkmcnt(6)
    v_mfma_f32_32x32x16_bf16 v[192:207], v[12:15], v[8:11], v[192:207]
    ds_read_b128 v[56:59], v114 offset:20480
    ds_read_b64_tr_b16 v[60:61], v112 offset:24576
    ds_read_b64_tr_b16 v[62:63], v112 offset:25600
    v_mfma_f32_32x32x16_bf16 v[192:207], v[24:27], v[20:23], v[192:207]
    ds_read_b128 v[68:71], v114 offset:21504
    ds_read_b64_tr_b16 v[72:73], v112 offset:26624
    ds_read_b64_tr_b16 v[74:75], v112 offset:27648
    s_waitcnt lgkmcnt(6)
    v_mfma_f32_32x32x16_bf16 v[192:207], v[36:39], v[32:35], v[192:207]
    ds_read_b128 v[80:83], v114 offset:22528
    ds_read_b64_tr_b16 v[84:85], v112 offset:28672
    ds_read_b64_tr_b16 v[86:87], v112 offset:29696
    v_mfma_f32_32x32x16_bf16 v[192:207], v[48:51], v[44:47], v[192:207]
    ds_read_b128 v[92:95], v114 offset:23552
    ds_read_b64_tr_b16 v[96:97], v112 offset:30720
    ds_read_b64_tr_b16 v[98:99], v112 offset:31744
    s_waitcnt lgkmcnt(0)
    s_barrier
    v_mfma_f32_32x32x16_bf16 v[192:207], v[60:63], v[56:59], v[192:207]
    ds_read_b128 v[8:11], v114 offset:32768
    ds_read_b64_tr_b16 v[12:13], v112 offset:32768
    ds_read_b64_tr_b16 v[14:15], v112 offset:33792
    v_mfma_f32_32x32x16_bf16 v[192:207], v[72:75], v[68:71], v[192:207]
    ds_read_b128 v[20:23], v114 offset:33792
    ds_read_b64_tr_b16 v[24:25], v112 offset:34816
    ds_read_b64_tr_b16 v[26:27], v112 offset:35840
    s_waitcnt lgkmcnt(6)
    v_mfma_f32_32x32x16_bf16 v[192:207], v[84:87], v[80:83], v[192:207]
    ds_read_b128 v[32:35], v114 offset:34816
    ds_read_b64_tr_b16 v[36:37], v112 offset:36864
    ds_read_b64_tr_b16 v[38:39], v112 offset:37888
    v_mfma_f32_32x32x16_bf16 v[192:207], v[96:99], v[92:95], v[192:207]
    ds_read_b128 v[44:47], v114 offset:35840
    ds_read_b64_tr_b16 v[48:49], v112 offset:38912
    ds_read_b64_tr_b16 v[50:51], v112 offset:39936
    s_waitcnt lgkmcnt(6)
    v_mfma_f32_32x32x16_bf16 v[192:207], v[12:15], v[8:11], v[192:207]
    ds_read_b128 v[56:59], v114 offset:36864
    ds_read_b64_tr_b16 v[60:61], v112 offset:40960
    ds_read_b64_tr_b16 v[62:63], v112 offset:41984
    v_mfma_f32_32x32x16_bf16 v[192:207], v[24:27], v[20:23], v[192:207]
    ds_read_b128 v[68:71], v114 offset:37888
    ds_read_b64_tr_b16 v[72:73], v112 offset:43008
    ds_read_b64_tr_b16 v[74:75], v112 offset:44032
    s_waitcnt lgkmcnt(6)
    v_mfma_f32_32x32x16_bf16 v[192:207], v[36:39], v[32:35], v[192:207]
    ds_read_b128 v[80:83], v114 offset:38912
    ds_read_b64_tr_b16 v[84:85], v112 offset:45056
    ds_read_b64_tr_b16 v[86:87], v112 offset:46080
    v_mfma_f32_32x32x16_bf16 v[192:207], v[48:51], v[44:47], v[192:207]
    ds_read_b128 v[92:95], v114 offset:39936
    ds_read_b64_tr_b16 v[96:97], v112 offset:47104
    ds_read_b64_tr_b16 v[98:99], v112 offset:48128
    s_waitcnt lgkmcnt(0)
    s_barrier
    v_mfma_f32_32x32x16_bf16 v[192:207], v[60:63], v[56:59], v[192:207]
    ds_read_b128 v[8:11], v114 offset:0
    ds_read_b64_tr_b16 v[12:13], v112 offset:49152
    ds_read_b64_tr_b16 v[14:15], v112 offset:50176
    v_mfma_f32_32x32x16_bf16 v[192:207], v[72:75], v[68:71], v[192:207]
    ds_read_b128 v[20:23], v114 offset:1024
    ds_read_b64_tr_b16 v[24:25], v112 offset:51200
    ds_read_b64_tr_b16 v[26:27], v112 offset:52224
    s_waitcnt lgkmcnt(6)
    v_mfma_f32_32x32x16_bf16 v[192:207], v[84:87], v[80:83], v[192:207]
    ds_read_b128 v[32:35], v114 offset:2048
    ds_read_b64_tr_b16 v[36:37], v112 offset:53248
    ds_read_b64_tr_b16 v[38:39], v112 offset:54272
    v_mfma_f32_32x32x16_bf16 v[192:207], v[96:99], v[92:95], v[192:207]
    ds_read_b128 v[44:47], v114 offset:3072
    ds_read_b64_tr_b16 v[48:49], v112 offset:55296
    ds_read_b64_tr_b16 v[50:51], v112 offset:56320
    s_waitcnt lgkmcnt(6)
    v_mfma_f32_32x32x16_bf16 v[192:207], v[12:15], v[8:11], v[192:207]
    ds_read_b128 v[56:59], v114 offset:4096
    ds_read_b64_tr_b16 v[60:61], v112 offset:57344
    ds_read_b64_tr_b16 v[62:63], v112 offset:58368
    v_mfma_f32_32x32x16_bf16 v[192:207], v[24:27], v[20:23], v[192:207]
    ds_read_b128 v[68:71], v114 offset:5120
    ds_read_b64_tr_b16 v[72:73], v112 offset:59392
    ds_read_b64_tr_b16 v[74:75], v112 offset:60416
    s_waitcnt lgkmcnt(6)
    v_mfma_f32_32x32x16_bf16 v[192:207], v[36:39], v[32:35], v[192:207]
    ds_read_b128 v[80:83], v114 offset:6144
    ds_read_b64_tr_b16 v[84:85], v112 offset:61440
    ds_read_b64_tr_b16 v[86:87], v112 offset:62464
    v_mfma_f32_32x32x16_bf16 v[192:207], v[48:51], v[44:47], v[192:207]
    ds_read_b128 v[92:95], v114 offset:7168
    ds_read_b64_tr_b16 v[96:97], v112 offset:63488
    ds_read_b64_tr_b16 v[98:99], v112 offset:64512
    s_waitcnt lgkmcnt(0)
    s_barrier
    v_mfma_f32_32x32x16_bf16 v[192:207], v[60:63], v[56:59], v[192:207]
    ds_read_b128 v[8:11], v114 offset:16384
    ds_read_b64_tr_b16 v[12:13], v113 offset:0
    ds_read_b64_tr_b16 v[14:15], v113 offset:1024
    v_mfma_f32_32x32x16_bf16 v[192:207], v[72:75], v[68:71], v[192:207]
    ds_read_b128 v[20:23], v114 offset:17408
    ds_read_b64_tr_b16 v[24:25], v113 offset:2048
    ds_read_b64_tr_b16 v[26:27], v113 offset:3072
    s_waitcnt lgkmcnt(6)
    v_mfma_f32_32x32x16_bf16 v[192:207], v[84:87], v[80:83], v[192:207]
    ds_read_b128 v[32:35], v114 offset:18432
    ds_read_b64_tr_b16 v[36:37], v113 offset:4096
    ds_read_b64_tr_b16 v[38:39], v113 offset:5120
    v_mfma_f32_32x32x16_bf16 v[192:207], v[96:99], v[92:95], v[192:207]
    ds_read_b128 v[44:47], v114 offset:19456
    ds_read_b64_tr_b16 v[48:49], v113 offset:6144
    ds_read_b64_tr_b16 v[50:51], v113 offset:7168
    s_waitcnt lgkmcnt(6)
    v_mfma_f32_32x32x16_bf16 v[192:207], v[12:15], v[8:11], v[192:207]
    ds_read_b128 v[56:59], v114 offset:20480
    ds_read_b64_tr_b16 v[60:61], v113 offset:8192
    ds_read_b64_tr_b16 v[62:63], v113 offset:9216
    v_mfma_f32_32x32x16_bf16 v[192:207], v[24:27], v[20:23], v[192:207]
    ds_read_b128 v[68:71], v114 offset:21504
    ds_read_b64_tr_b16 v[72:73], v113 offset:10240
    ds_read_b64_tr_b16 v[74:75], v113 offset:11264
    s_waitcnt lgkmcnt(6)
    v_mfma_f32_32x32x16_bf16 v[192:207], v[36:39], v[32:35], v[192:207]
    ds_read_b128 v[80:83], v114 offset:22528
    ds_read_b64_tr_b16 v[84:85], v113 offset:12288
    ds_read_b64_tr_b16 v[86:87], v113 offset:13312
    v_mfma_f32_32x32x16_bf16 v[192:207], v[48:51], v[44:47], v[192:207]
    ds_read_b128 v[92:95], v114 offset:23552
    ds_read_b64_tr_b16 v[96:97], v113 offset:14336
    ds_read_b64_tr_b16 v[98:99], v113 offset:15360
    s_waitcnt lgkmcnt(0)
    s_barrier
    v_mfma_f32_32x32x16_bf16 v[192:207], v[60:63], v[56:59], v[192:207]
    ds_read_b128 v[8:11], v114 offset:32768
    ds_read_b64_tr_b16 v[12:13], v113 offset:16384
    ds_read_b64_tr_b16 v[14:15], v113 offset:17408
    v_mfma_f32_32x32x16_bf16 v[192:207], v[72:75], v[68:71], v[192:207]
    ds_read_b128 v[20:23], v114 offset:33792
    ds_read_b64_tr_b16 v[24:25], v113 offset:18432
    ds_read_b64_tr_b16 v[26:27], v113 offset:19456
    s_waitcnt lgkmcnt(6)
    v_mfma_f32_32x32x16_bf16 v[192:207], v[84:87], v[80:83], v[192:207]
    ds_read_b128 v[32:35], v114 offset:34816
    ds_read_b64_tr_b16 v[36:37], v113 offset:20480
    ds_read_b64_tr_b16 v[38:39], v113 offset:21504
    v_mfma_f32_32x32x16_bf16 v[192:207], v[96:99], v[92:95], v[192:207]
    ds_read_b128 v[44:47], v114 offset:35840
    ds_read_b64_tr_b16 v[48:49], v113 offset:22528
    ds_read_b64_tr_b16 v[50:51], v113 offset:23552
    s_waitcnt lgkmcnt(6)
    v_mfma_f32_32x32x16_bf16 v[192:207], v[12:15], v[8:11], v[192:207]
    ds_read_b128 v[56:59], v114 offset:36864
    ds_read_b64_tr_b16 v[60:61], v113 offset:24576
    ds_read_b64_tr_b16 v[62:63], v113 offset:25600
    v_mfma_f32_32x32x16_bf16 v[192:207], v[24:27], v[20:23], v[192:207]
    ds_read_b128 v[68:71], v114 offset:37888
    ds_read_b64_tr_b16 v[72:73], v113 offset:26624
    ds_read_b64_tr_b16 v[74:75], v113 offset:27648
    s_waitcnt lgkmcnt(6)
    v_mfma_f32_32x32x16_bf16 v[192:207], v[36:39], v[32:35], v[192:207]
    ds_read_b128 v[80:83], v114 offset:38912
    ds_read_b64_tr_b16 v[84:85], v113 offset:28672
    ds_read_b64_tr_b16 v[86:87], v113 offset:29696
    v_mfma_f32_32x32x16_bf16 v[192:207], v[48:51], v[44:47], v[192:207]
    ds_read_b128 v[92:95], v114 offset:39936
    ds_read_b64_tr_b16 v[96:97], v113 offset:30720
    ds_read_b64_tr_b16 v[98:99], v113 offset:31744
    s_waitcnt lgkmcnt(0)
    s_barrier
    v_mfma_f32_32x32x16_bf16 v[192:207], v[60:63], v[56:59], v[192:207]
    ds_read_b128 v[8:11], v114 offset:0
    ds_read_b64_tr_b16 v[12:13], v113 offset:32768
    ds_read_b64_tr_b16 v[14:15], v113 offset:33792
    v_mfma_f32_32x32x16_bf16 v[192:207], v[72:75], v[68:71], v[192:207]
    ds_read_b128 v[20:23], v114 offset:1024
    ds_read_b64_tr_b16 v[24:25], v113 offset:34816
    ds_read_b64_tr_b16 v[26:27], v113 offset:35840
    s_waitcnt lgkmcnt(6)
    v_mfma_f32_32x32x16_bf16 v[192:207], v[84:87], v[80:83], v[192:207]
    ds_read_b128 v[32:35], v114 offset:2048
    ds_read_b64_tr_b16 v[36:37], v113 offset:36864
    ds_read_b64_tr_b16 v[38:39], v113 offset:37888
    v_mfma_f32_32x32x16_bf16 v[192:207], v[96:99], v[92:95], v[192:207]
    ds_read_b128 v[44:47], v114 offset:3072
    ds_read_b64_tr_b16 v[48:49], v113 offset:38912
    ds_read_b64_tr_b16 v[50:51], v113 offset:39936
    s_waitcnt lgkmcnt(6)
    v_mfma_f32_32x32x16_bf16 v[192:207], v[12:15], v[8:11], v[192:207]
    ds_read_b128 v[56:59], v114 offset:4096
    ds_read_b64_tr_b16 v[60:61], v113 offset:40960
    ds_read_b64_tr_b16 v[62:63], v113 offset:41984
    v_mfma_f32_32x32x16_bf16 v[192:207], v[24:27], v[20:23], v[192:207]
    ds_read_b128 v[68:71], v114 offset:5120
    ds_read_b64_tr_b16 v[72:73], v113 offset:43008
    ds_read_b64_tr_b16 v[74:75], v113 offset:44032
    s_waitcnt lgkmcnt(6)
    v_mfma_f32_32x32x16_bf16 v[192:207], v[36:39], v[32:35], v[192:207]
    ds_read_b128 v[80:83], v114 offset:6144
    ds_read_b64_tr_b16 v[84:85], v113 offset:45056
    ds_read_b64_tr_b16 v[86:87], v113 offset:46080
    v_mfma_f32_32x32x16_bf16 v[192:207], v[48:51], v[44:47], v[192:207]
    ds_read_b128 v[92:95], v114 offset:7168
    ds_read_b64_tr_b16 v[96:97], v113 offset:47104
    ds_read_b64_tr_b16 v[98:99], v113 offset:48128
    s_waitcnt lgkmcnt(6)
    v_mfma_f32_32x32x16_bf16 v[192:207], v[60:63], v[56:59], v[192:207]
    v_mfma_f32_32x32x16_bf16 v[192:207], v[72:75], v[68:71], v[192:207]
    s_waitcnt lgkmcnt(0)
    v_mfma_f32_32x32x16_bf16 v[192:207], v[84:87], v[80:83], v[192:207]
    v_mfma_f32_32x32x16_bf16 v[192:207], v[96:99], v[92:95], v[192:207]
    s_waitcnt vmcnt(0)
    s_nop 11
    v_lshlrev_b32 v16, 16, v208
    v_and_b32 v17, 0xffff0000, v208
    v_lshlrev_b32 v18, 16, v209
    v_and_b32 v19, 0xffff0000, v209
    v_lshlrev_b32 v20, 16, v210
    v_and_b32 v21, 0xffff0000, v210
    v_lshlrev_b32 v22, 16, v211
    v_and_b32 v23, 0xffff0000, v211
    v_lshlrev_b32 v24, 16, v212
    v_and_b32 v25, 0xffff0000, v212
    v_lshlrev_b32 v26, 16, v213
    v_and_b32 v27, 0xffff0000, v213
    v_lshlrev_b32 v28, 16, v214
    v_and_b32 v29, 0xffff0000, v214
    v_lshlrev_b32 v30, 16, v215
    v_and_b32 v31, 0xffff0000, v215
    v_fma_f32 v192, v192, v216, v16
    v_fma_f32 v193, v193, v217, v17
    v_fma_f32 v194, v194, v218, v18
    v_fma_f32 v195, v195, v219, v19
    v_fma_f32 v196, v196, v220, v20
    v_fma_f32 v197, v197, v221, v21
    v_fma_f32 v198, v198, v222, v22
    v_fma_f32 v199, v199, v223, v23
    v_fma_f32 v200, v200, v224, v24
    v_fma_f32 v201, v201, v225, v25
    v_fma_f32 v202, v202, v226, v26
    v_fma_f32 v203, v203, v227, v27
    v_fma_f32 v204, v204, v228, v28
    v_fma_f32 v205, v205, v229, v29
    v_fma_f32 v206, v206, v230, v30
    v_fma_f32 v207, v207, v231, v31
    v_cvt_pk_bf16_f32 v8, v192, v193
    v_cvt_pk_bf16_f32 v9, v194, v195
    v_cvt_pk_bf16_f32 v10, v196, v197
    v_cvt_pk_bf16_f32 v11, v198, v199
    v_cvt_pk_bf16_f32 v12, v200, v201
    v_cvt_pk_bf16_f32 v13, v202, v203
    v_cvt_pk_bf16_f32 v14, v204, v205
    v_cvt_pk_bf16_f32 v15, v206, v207
    s_lshl_b32 s46, s42, 16
    s_lshl_b32 s47, s51, 15
    s_add_u32 s46, s46, s47
    s_lshl_b32 s47, s53, 1
    s_add_u32 s46, s46, s47
    v_permlane32_swap_b32 v8, v10
    v_permlane32_swap_b32 v9, v11
    v_permlane32_swap_b32 v12, v14
    v_permlane32_swap_b32 v13, v15
    v_lshlrev_b32 v16, 10, v2
    v_lshl_add_u32 v16, v3, 4, v16
    v_add_u32 v16, s46, v16
    global_store_dwordx4 v16, v[8:11], s[36:37]
    global_store_dwordx4 v16, v[12:15], s[36:37] offset:32
    s_branch L_p6done_100
L_p6load_99:
    s_waitcnt vmcnt(4)
    s_barrier
    s_add_u32 m0, s54, 0
    s_mov_b32 s49, 24576
    buffer_load_dwordx4 v10, s[4:7], s49 offen offset:0 sc1 lds
    buffer_load_dwordx4 v10, s[4:7], s49 offen offset:1024 sc1 lds
    buffer_load_dwordx4 v10, s[4:7], s49 offen offset:2048 sc1 lds
    buffer_load_dwordx4 v10, s[4:7], s49 offen offset:3072 sc1 lds
    s_waitcnt vmcnt(4)
    s_barrier
    s_add_u32 m0, s54, 16384
    s_mov_b32 s49, 32768
    buffer_load_dwordx4 v10, s[4:7], s49 offen offset:0 sc1 lds
    buffer_load_dwordx4 v10, s[4:7], s49 offen offset:1024 sc1 lds
    buffer_load_dwordx4 v10, s[4:7], s49 offen offset:2048 sc1 lds
    buffer_load_dwordx4 v10, s[4:7], s49 offen offset:3072 sc1 lds
    s_waitcnt vmcnt(4)
    s_barrier
    s_add_u32 m0, s54, 32768
    s_mov_b32 s49, 40960
    buffer_load_dwordx4 v10, s[4:7], s49 offen offset:0 sc1 lds
    buffer_load_dwordx4 v10, s[4:7], s49 offen offset:1024 sc1 lds
    buffer_load_dwordx4 v10, s[4:7], s49 offen offset:2048 sc1 lds
    buffer_load_dwordx4 v10, s[4:7], s49 offen offset:3072 sc1 lds
    s_waitcnt vmcnt(4)
    s_barrier
    s_add_u32 m0, s54, 0
    s_mov_b32 s49, 49152
    buffer_load_dwordx4 v10, s[4:7], s49 offen offset:0 sc1 lds
    buffer_load_dwordx4 v10, s[4:7], s49 offen offset:1024 sc1 lds
    buffer_load_dwordx4 v10, s[4:7], s49 offen offset:2048 sc1 lds
    buffer_load_dwordx4 v10, s[4:7], s49 offen offset:3072 sc1 lds
    s_waitcnt vmcnt(4)
    s_barrier
    s_waitcnt vmcnt(0)
    s_barrier
L_p6done_100:
L_end:
L_exit:
    s_endpgm
L_code_end:
.section .rodata,"a"
.p2align 6
.amdhsa_kernel adaLN_cond__softmax_full_mha__mixer_gmlp__prompt_kernel
  .amdhsa_next_free_vgpr 256
  .amdhsa_next_free_sgpr 102
  .amdhsa_accum_offset 256
  .amdhsa_group_segment_fixed_size 0
  .amdhsa_kernarg_size 104
  .amdhsa_user_sgpr_count 2
  .amdhsa_user_sgpr_kernarg_segment_ptr 1
  .amdhsa_system_sgpr_workgroup_id_x 1
.end_amdhsa_kernel
```
